```python
import torch

def _softmax(x, axis=-1):
    return torch.softmax(x, dim=axis)
def _gelu(x):
    return torch.nn.functional.gelu(x, approximate="tanh")
def _silu(x):
    return torch.nn.functional.silu(x)
def _sigmoid(x):
    return torch.sigmoid(x)
def _layernorm(x, axis=-1, eps=1e-5):
    m = x.mean(dim=axis, keepdim=True)
    v = x.var(dim=axis, keepdim=True, unbiased=False)
    return (x - m) / torch.sqrt(v + eps)
def _scatter_add(tgt, idx, src, axis=0):
    return tgt.clone().index_add_(axis, idx, src)
def _segment_sum(src, seg, n):
    out = torch.zeros((n,) + src.shape[1:], dtype=src.dtype)
    return out.index_add_(0, seg, src)
def _pad(x, pw):
    flat = tuple(v for pair in reversed(pw) for v in pair)
    return torch.nn.functional.pad(x, flat)

kernel_name = 'sequential_preLN__linear_attn_block__dense_activation_relu__prompt'

def setup_inputs():

    _w = (lambda a: (lambda t: t.to(torch.bfloat16) if t.is_floating_point() else t)(torch.as_tensor(a)))
    def _A_setup():
        B, S, D = 1, 2048, 576
        return {
            "x": _w((lambda *s: torch.randn(*s, dtype=torch.bfloat16) * 0.05)(B, S, D)),
            "wqkv": _w((lambda *s: torch.randn(*s, dtype=torch.bfloat16) * 0.05)(D, 3 * D)),
            "wo": _w((lambda *s: torch.randn(*s, dtype=torch.bfloat16) * 0.05)(D, D)),
        }
    _A_in = _A_setup()

    def _B_setup():
        B, S, D, Dff = 1, 2048, 576, 4608
        return {
            "x": _w((lambda *s: torch.randn(*s, dtype=torch.bfloat16) * 0.05)(B, S, D)),
            "w1": _w((lambda *s: torch.randn(*s, dtype=torch.bfloat16) * 0.05)(D, Dff)),
            "w2": _w((lambda *s: torch.randn(*s, dtype=torch.bfloat16) * 0.05)(Dff, D)),
        }
    _B_in = _B_setup()

    return {
        "A_x": _A_in["x"],
        "A_wqkv": _A_in["wqkv"],
        "A_wo": _A_in["wo"],
        "B_x": _B_in["x"],
        "B_w1": _B_in["w1"],
        "B_w2": _B_in["w2"],
    }

def reference(A_x, A_wqkv, A_wo, B_x, B_w1, B_w2):
    def _A_ref(x, wqkv, wo):
        B, S, D = x.shape
        H = 32; Dh = D // H
        qkv = (lambda x, *d: x.permute(*d))((x @ wqkv).reshape(B, S, 3, H, Dh), 2, 0, 3, 1, 4)
        q, k, v = qkv[0], qkv[1], qkv[2]
        phi = lambda t: torch.where(t > 0, t + 1, torch.exp(t)) + 1e-6
        pq, pk = phi(q), phi(k)
        kv = torch.einsum("bhsd,bhse->bhde", pk, v)
        z = torch.einsum("bhsd->bhd", pk)
        num = torch.einsum("bhqd,bhde->bhqe", pq, kv)
        den = torch.einsum("bhqd,bhd->bhq", pq, z)[..., None] + 1e-6
        o = num / den
        return (lambda x, *d: x.permute(*d))(o, 0, 2, 1, 3).reshape(B, S, D) @ wo

    def _B_ref(x, w1, w2):
        h = torch.einsum("bsd,df->bsf", x, w1)
        zero = torch.zeros_like(h)
        h = torch.maximum(h, zero)
        return torch.einsum("bsf,fd->bsd", h, w2)

    x = A_x
    h = x + _A_ref(_layernorm(x, axis=-1), A_wqkv, A_wo)
    h2 = h + _B_ref(_layernorm(h, axis=-1), B_w1, B_w2)
    return h2
```

```asm
; @launch grid=(256,1,1) block=(256,1,1) lds=163840
.amdgcn_target "amdgcn-amd-amdhsa--gfx950"
.text
.globl sequential_preLN__linear_attn_block__dense_activation_relu__prompt_kernel
.p2align 8
.type sequential_preLN__linear_attn_block__dense_activation_relu__prompt_kernel,@function
sequential_preLN__linear_attn_block__dense_activation_relu__prompt_kernel:
    s_cmp_ge_u32 s2, 256
    s_cbranch_scc1 L_end
    s_load_dwordx2 s[8:9], s[0:1], 0
    s_load_dwordx2 s[12:13], s[0:1], 8
    s_load_dwordx2 s[4:5], s[0:1], 64
    s_load_dwordx2 s[36:37], s[0:1], 16
    s_load_dwordx2 s[16:17], s[0:1], 32
    s_load_dwordx2 s[20:21], s[0:1], 40
    s_load_dwordx2 s[32:33], s[0:1], 48
    s_load_dwordx2 s[28:29], s[0:1], 56
    v_lshrrev_b32 v1, 6, v0
    v_lshlrev_b32 v15, 4, v0
    v_and_b32 v0, 63, v0
    v_readfirstlane_b32 s40, v1
    v_lshlrev_b32 v1, 4, v0
    v_and_b32 v2, 15, v0
    v_lshrrev_b32 v3, 4, v0
    s_and_b32 s38, s2, 7
    s_lshr_b32 s39, s2, 3
    s_and_b32 s44, s38, 1
    s_lshl_b32 s44, s44, 3
    s_and_b32 s45, s39, 7
    s_add_u32 s41, s44, s45
    s_lshr_b32 s44, s38, 1
    s_lshl_b32 s44, s44, 2
    s_lshr_b32 s45, s39, 3
    s_add_u32 s42, s44, s45
    s_and_b32 s43, s42, 1
    s_lshl_b32 s43, s43, 3
    s_getpc_b64 s[46:47]
L_pc:
    s_lshl_b32 s44, s39, 2
    s_add_u32 s44, s44, s40
    s_and_b32 s44, s44, 7
    s_lshl_b32 s44, s44, 13
    v_lshl_add_u32 v146, v0, 7, s44
    v_min_u32 v146, L_end-L_pc, v146
    v_mov_b32 v147, s47
    v_add_co_u32 v146, vcc, s46, v146
    s_nop 1
    v_addc_co_u32 v147, vcc, 0, v147, vcc
    global_load_dword v146, v[146:147], off
    s_mov_b32 s6, 67108864
    s_mov_b32 s7, 0x20000
    s_mov_b32 s10, 2359296
    s_mov_b32 s11, 0x20000
    s_mov_b32 s14, 1990656
    s_mov_b32 s15, 0x20000
    s_mov_b32 s18, 5308416
    s_mov_b32 s19, 0x20000
    s_mov_b32 s22, 5308416
    s_mov_b32 s23, 0x20000
    s_mov_b32 s30, 256
    s_mov_b32 s31, 0x20000
    s_mov_b32 s34, 2359296
    s_mov_b32 s35, 0x20000
    s_lshl_b32 s44, s41, 7
    s_lshl_b32 s45, s40, 5
    s_add_u32 s44, s44, s45
    s_mul_i32 s90, s44, 1152
    s_lshr_b32 s45, s39, 3
    s_lshl_b32 s45, s45, 1
    s_and_b32 s54, s39, 7
    s_add_u32 s54, s54, s45
    s_mul_i32 s45, s54, 29
    s_lshr_b32 s45, s45, 8
    s_mul_i32 s45, s45, 9
    s_sub_u32 s54, s54, s45
    s_mul_i32 s54, s54, 1
    s_mul_i32 s55, s54, 221184
    s_lshl_b32 s45, s54, 7
    s_add_u32 s90, s90, s45
    s_add_u32 s91, s90, 9216
    s_add_u32 s92, s90, 18432
    s_add_u32 s93, s90, 27648
    v_lshrrev_b32 v16, 3, v0
    v_and_b32 v17, 6, v16
    v_xor_b32 v17, v17, v0
    v_and_b32 v17, 7, v17
    s_movk_i32 s45, 1152
    v_mul_u32_u24 v12, s45, v16
    v_lshl_add_u32 v12, v17, 4, v12
    s_and_b32 s44, s40, 1
    s_lshl_b32 s44, s44, 3
    v_lshl_add_u32 v16, v3, 1, s44
    v_sub_u32 v16, v2, v16
    v_and_b32 v16, 15, v16
    v_cmp_ne_u32 s[72:73], 15, v16
    v_mul_u32_u24 v17, 52, v16
    v_lshrrev_b32 v17, 8, v17
    s_movk_i32 s45, 1072
    v_mul_u32_u24 v17, s45, v17
    v_lshl_add_u32 v17, v16, 4, v17
    s_movk_i32 s45, 3456
    v_mul_u32_u24 v13, s45, v3
    s_mul_i32 s44, s40, 27648
    s_mul_i32 s45, s42, 72
    s_add_u32 s44, s44, s45
    s_sub_u32 s44, s44, s43
    v_add3_u32 v13, v13, v17, s44
    s_lshl_b32 s51, s40, 11
    s_waitcnt lgkmcnt(0)
    s_cmp_lg_u32 s2, 0
    s_cbranch_scc1 nz_1
    v_mov_b32 v20, 0
    v_mov_b32 v21, 0
    v_mov_b32 v22, 0
    v_mov_b32 v23, 0
    s_movk_i32 s44, 0
    buffer_store_dwordx4 v[20:23], v15, s[4:7], s44 offen sc1
    s_movk_i32 s44, 4096
    buffer_store_dwordx4 v[20:23], v15, s[4:7], s44 offen sc1
    s_movk_i32 s44, 8192
    buffer_store_dwordx4 v[20:23], v15, s[4:7], s44 offen sc1
    s_movk_i32 s44, 12288
    buffer_store_dwordx4 v[20:23], v15, s[4:7], s44 offen sc1
    s_movk_i32 s44, 16384
    buffer_store_dwordx4 v[20:23], v15, s[4:7], s44 offen sc1
    s_movk_i32 s44, 20480
    buffer_store_dwordx4 v[20:23], v15, s[4:7], s44 offen sc1
    s_movk_i32 s44, 24576
    buffer_store_dwordx4 v[20:23], v15, s[4:7], s44 offen sc1
    s_movk_i32 s44, 28672
    buffer_store_dwordx4 v[20:23], v15, s[4:7], s44 offen sc1
    s_mov_b32 s44, 32768
    buffer_store_dwordx4 v[20:23], v15, s[4:7], s44 offen sc1
    s_mov_b32 s44, 36864
    buffer_store_dwordx4 v[20:23], v15, s[4:7], s44 offen sc1
    s_mov_b32 s44, 40960
    buffer_store_dwordx4 v[20:23], v15, s[4:7], s44 offen sc1
    s_mov_b32 s44, 45056
    buffer_store_dwordx4 v[20:23], v15, s[4:7], s44 offen sc1
    s_mov_b32 s44, 49152
    buffer_store_dwordx4 v[20:23], v15, s[4:7], s44 offen sc1
nz_1:
    s_mov_b64 exec, s[72:73]
    s_add_u32 m0, s51, 0
    s_add_u32 s100, s55, 12800
    buffer_load_dwordx4 v13, s[12:15], s55 offen lds
    buffer_load_dwordx4 v13, s[12:15], s100 offen offset:1024 lds
    s_add_u32 s55, s55, 110592
    s_mov_b64 exec, -1
    s_mov_b64 exec, s[72:73]
    s_add_u32 m0, s51, 8192
    s_add_u32 s100, s55, 12800
    buffer_load_dwordx4 v13, s[12:15], s55 offen lds
    buffer_load_dwordx4 v13, s[12:15], s100 offen offset:1024 lds
    s_add_u32 s55, s55, 110592
    s_cmp_eq_u32 s55, 1990656
    s_cselect_b32 s55, 0, s55
    s_mov_b64 exec, -1
    s_cmp_eq_u32 s54, 8
    s_cselect_b32 s89, -8, 1
    s_cselect_b32 s54, -1, s54
    s_add_u32 s54, s54, 1
    s_lshl_b32 s89, s89, 7
    s_add_u32 m0, s51, 114688
    s_nop 0
    buffer_load_dwordx4 v12, s[8:11], s90 offen lds
    s_add_u32 s90, s90, s89
    s_add_u32 m0, s51, 115712
    s_nop 0
    buffer_load_dwordx4 v12, s[8:11], s91 offen lds
    s_add_u32 s91, s91, s89
    s_add_u32 m0, s51, 122880
    s_nop 0
    buffer_load_dwordx4 v12, s[8:11], s92 offen lds
    s_add_u32 s92, s92, s89
    s_add_u32 m0, s51, 123904
    s_nop 0
    buffer_load_dwordx4 v12, s[8:11], s93 offen lds
    s_add_u32 s93, s93, s89
    s_lshl_b32 s49, s39, 2
    s_add_u32 s49, s49, s40
    s_cmp_lt_u32 s38, 4
    s_cselect_b32 s44, 32, 0
    s_xor_b32 s49, s49, s44
    s_mov_b32 s27, 0x20000
    s_cmp_lt_u32 s49, 107
    s_cselect_b64 s[24:25], s[16:17], s[36:37]
    s_mov_b32 s26, 663552
    s_cselect_b32 s26, 5308416, s26
    s_mov_b32 s53, 1
    s_cbranch_scc0 tb_2
    s_mul_i32 s44, s49, 205
    s_lshr_b32 s44, s44, 10
    s_mul_i32 s45, s44, 5
    s_sub_u32 s45, s49, s45
    s_cmp_eq_u32 s45, 4
    s_cselect_b32 s45, 8, s45
    s_sub_u32 s46, s49, 90
    s_and_b32 s47, s46, 3
    s_add_u32 s47, s47, 4
    s_lshr_b32 s46, s46, 2
    s_cmp_lt_u32 s49, 90
    s_cselect_b32 s44, s44, s46
    s_cselect_b32 s45, s45, s47
    s_lshr_b32 s46, s44, 1
    s_lshl_b32 s46, s46, 6
    s_and_b32 s47, s44, 1
    s_lshl_b32 s47, s47, 1
    s_add_u32 s46, s46, s47
    s_mul_i32 s46, s46, 9216
    s_lshl_b32 s45, s45, 7
    s_add_u32 s46, s46, s45
    s_mul_i32 s47, s38, 1152
    s_add_u32 s56, s46, s47
    s_mov_b32 s57, 36864
    s_mov_b32 s58, 36864
    s_mul_i32 s46, s38, 1327104
    s_lshl_b32 s47, s49, 10
    s_add_u32 s46, s46, s47
    s_add_u32 s59, s46, 8388608
    s_mov_b32 s60, 331776
    s_mov_b32 s44, 294912
    s_mov_b32 s45, 9216
    s_branch td_3
tb_2:
    s_sub_u32 s49, s49, 107
    s_lshl_b32 s49, s49, 3
    s_add_u32 s49, s49, s38
    s_cmp_lt_u32 s49, 162
    s_cselect_b32 s53, 1, 0
    s_cselect_b32 s49, s49, 0
    s_mul_i32 s44, s49, 57
    s_lshr_b32 s44, s44, 10
    s_mul_i32 s45, s44, 18
    s_sub_u32 s45, s49, s45
    s_mul_i32 s46, s44, 73728
    s_lshl_b32 s47, s45, 10
    s_add_u32 s46, s46, s47
    s_add_u32 s59, s46, 7340032
    s_mov_b32 s60, 18432
    s_mul_i32 s46, s45, 36
    s_mul_i32 s47, s45, 288
    s_sub_u32 s47, s47, 4592
    s_mov_b32 s48, 38016
    s_cmp_lt_u32 s45, 16
    s_cselect_b32 s46, s46, s47
    s_cselect_b32 s58, 19584, s48
    s_mov_b32 s48, 82944
    s_cselect_b32 s48, 4608, s48
    s_mul_i32 s46, s46, 1152
    s_lshl_b32 s44, s44, 7
    s_add_u32 s56, s46, s44
    s_mov_b32 s57, 1152
    s_mov_b32 s44, s48
    s_lshl_b32 s45, s48, 1
    s_cmp_eq_u32 s53, 0
    s_cselect_b32 s56, 0x7f000000, s56
    s_cselect_b32 s59, 0x7f000000, s59
td_3:
    v_and_b32 v16, 1, v3
    v_lshrrev_b32 v17, 1, v3
    v_mul_lo_u32 v16, v16, s44
    v_mul_lo_u32 v17, v17, s45
    v_lshlrev_b32 v18, 3, v2
    v_add3_u32 v128, v16, v17, v18
    s_cmp_eq_u32 s26, 663552
    s_cbranch_scc0 wo_4
    buffer_load_dwordx2 v[200:201], v128, s[24:27], s56 offen nt
    s_add_u32 s56, s56, s57
    buffer_load_dwordx2 v[202:203], v128, s[24:27], s56 offen nt
    s_add_u32 s56, s56, s57
    buffer_load_dwordx2 v[204:205], v128, s[24:27], s56 offen nt
    s_add_u32 s56, s56, s57
    buffer_load_dwordx2 v[206:207], v128, s[24:27], s56 offen nt
    s_add_u32 s56, s56, s58
    buffer_load_dwordx2 v[208:209], v128, s[24:27], s56 offen nt
    s_add_u32 s56, s56, s57
    buffer_load_dwordx2 v[210:211], v128, s[24:27], s56 offen nt
    s_add_u32 s56, s56, s57
    buffer_load_dwordx2 v[212:213], v128, s[24:27], s56 offen nt
    s_add_u32 s56, s56, s57
    buffer_load_dwordx2 v[214:215], v128, s[24:27], s56 offen nt
wo_4:
    s_mov_b64 exec, s[72:73]
    s_add_u32 m0, s51, 16384
    s_add_u32 s100, s55, 12800
    buffer_load_dwordx4 v13, s[12:15], s55 offen lds
    buffer_load_dwordx4 v13, s[12:15], s100 offen offset:1024 lds
    s_add_u32 s55, s55, 110592
    s_mov_b64 exec, -1
    s_mov_b64 exec, s[72:73]
    s_add_u32 m0, s51, 24576
    s_add_u32 s100, s55, 12800
    buffer_load_dwordx4 v13, s[12:15], s55 offen lds
    buffer_load_dwordx4 v13, s[12:15], s100 offen offset:1024 lds
    s_add_u32 s55, s55, 110592
    s_cmp_eq_u32 s55, 1990656
    s_cselect_b32 s55, 0, s55
    s_mov_b64 exec, -1
    s_cmp_eq_u32 s54, 8
    s_cselect_b32 s89, -8, 1
    s_cselect_b32 s54, -1, s54
    s_add_u32 s54, s54, 1
    s_lshl_b32 s89, s89, 7
    s_add_u32 m0, s51, 131072
    s_nop 0
    buffer_load_dwordx4 v12, s[8:11], s90 offen lds
    s_add_u32 s90, s90, s89
    s_add_u32 m0, s51, 132096
    s_nop 0
    buffer_load_dwordx4 v12, s[8:11], s91 offen lds
    s_add_u32 s91, s91, s89
    s_add_u32 m0, s51, 139264
    s_nop 0
    buffer_load_dwordx4 v12, s[8:11], s92 offen lds
    s_add_u32 s92, s92, s89
    s_add_u32 m0, s51, 140288
    s_nop 0
    buffer_load_dwordx4 v12, s[8:11], s93 offen lds
    s_add_u32 s93, s93, s89
    v_mov_b32 v124, 0x3f803f80
    v_mov_b32 v125, 0x3f803f80
    v_mov_b32 v126, 0x3f803f80
    v_mov_b32 v127, 0x3f803f80
    s_and_b32 s44, s40, 1
    s_lshl_b32 s44, s44, 3
    s_add_u32 s44, s44, 15
    v_and_b32 v16, 3, v0
    v_lshl_add_u32 v16, v16, 1, s44
    v_and_b32 v16, 15, v16
    v_and_b32 v17, 7, v0
    v_lshlrev_b32 v18, 8, v17
    v_lshl_add_u32 v16, v16, 4, v18
    v_bfe_u32 v18, v0, 3, 1
    v_lshl_add_u32 v16, v18, 13, v16
    v_add_u32 v142, s51, v16
    v_and_b32 v16, 6, v0
    v_xor_b32 v16, v16, v3
    v_lshlrev_b32 v16, 4, v16
    v_lshl_add_u32 v16, v17, 7, v16
    v_lshl_add_u32 v143, v18, 10, v16
    s_add_u32 s44, s51, 114688
    v_add_u32 v140, s44, v143
    v_xor_b32 v141, 64, v140
    s_mov_b64 exec, 0xffff
    ds_write_b128 v142, v[124:127]
    s_mov_b64 exec, -1
    v_add_u32 v142, 0x4000, v142
    s_mov_b64 exec, 0xffff
    ds_write_b128 v142, v[124:127]
    s_mov_b64 exec, -1
    v_add_u32 v142, 0x4000, v142
    s_mov_b64 exec, 0xffff
    ds_write_b128 v142, v[124:127]
    s_mov_b64 exec, -1
    v_add_u32 v142, 0x4000, v142
    s_mov_b64 exec, 0xffff
    ds_write_b128 v142, v[124:127]
    s_mov_b64 exec, -1
    v_add_u32 v142, 0x4000, v142
    s_mov_b64 exec, 0xffff
    ds_write_b128 v142, v[124:127]
    s_mov_b64 exec, -1
    v_add_u32 v142, 0x4000, v142
    s_mov_b64 exec, 0xffff
    ds_write_b128 v142, v[124:127]
    s_mov_b64 exec, -1
    v_add_u32 v142, 0x4000, v142
    s_mov_b64 exec, 0xffff
    ds_write_b128 v142, v[124:127]
    s_mov_b64 exec, -1
    v_add_u32 v142, 0x4000, v142
    v_lshrrev_b32 v16, 2, v2
    v_and_b32 v17, 3, v0
    v_and_b32 v18, 1, v3
    v_lshl_add_u32 v18, v18, 2, v16
    v_lshlrev_b32 v18, 5, v18
    v_add_u32 v18, s43, v18
    v_lshl_add_u32 v19, v3, 3, v16
    v_lshlrev_b32 v19, 8, v19
    v_lshl_add_u32 v20, v17, 3, v18
    s_movk_i32 s44, 255
    v_add_u32 v21, 80, v20
    v_and_or_b32 v4, v21, s44, v19
    v_add_u32 v21, 120, v20
    v_and_or_b32 v5, v21, s44, v19
    v_add_u32 v21, 160, v20
    v_and_or_b32 v6, v21, s44, v19
    v_add_u32 v21, 200, v20
    v_and_or_b32 v7, v21, s44, v19
    v_add_u32 v21, 0, v20
    v_and_or_b32 v9, v21, s44, v19
    v_add_u32 v21, 40, v20
    v_and_or_b32 v10, v21, s44, v19
    v_add_u32 v21, 32, v18
    v_and_or_b32 v11, v21, s44, v19
    v_mov_b32 v21, 112
    v_mov_b32 v22, 192
    v_cmp_eq_u32 vcc, 3, v17
    s_nop 1
    v_cndmask_b32 v21, v21, v22, vcc
    s_sub_u32 s45, 248, s43
    v_mov_b32 v22, s45
    v_cmp_eq_u32 vcc, 0, v17
    s_nop 1
    v_cndmask_b32 v21, v21, v22, vcc
    v_add_u32 v21, v21, v18
    v_and_or_b32 v8, v21, s44, v19
    s_cmp_eq_u32 s54, 8
    s_cselect_b32 s89, -8, 1
    s_cselect_b32 s54, -1, s54
    s_add_u32 s54, s54, 1
    s_lshl_b32 s89, s89, 7
    s_add_u32 m0, s51, 147456
    s_nop 0
    buffer_load_dwordx4 v12, s[8:11], s90 offen lds
    s_add_u32 s90, s90, s89
    s_add_u32 m0, s51, 148480
    s_nop 0
    buffer_load_dwordx4 v12, s[8:11], s91 offen lds
    s_add_u32 s91, s91, s89
    s_add_u32 m0, s51, 155648
    s_nop 0
    buffer_load_dwordx4 v12, s[8:11], s92 offen lds
    s_add_u32 s92, s92, s89
    s_add_u32 m0, s51, 156672
    s_nop 0
    buffer_load_dwordx4 v12, s[8:11], s93 offen lds
    s_add_u32 s93, s93, s89
    s_mov_b32 s45, 0x111
    v_bfe_i32 v248, s45, v2, 1
    v_and_b32 v248, 0x3f803f80, v248
    s_mov_b32 s45, 0x3000
    v_bfe_i32 v249, s45, v2, 1
    s_mov_b32 s45, 0x222
    v_bfe_i32 v250, s45, v2, 1
    v_and_b32 v250, 0x3f803f80, v250
    s_mov_b32 s45, 0xc000
    v_bfe_i32 v251, s45, v2, 1
    s_mov_b32 s45, 0x30
    v_bfe_i32 v252, s45, v2, 1
    s_mov_b32 s45, 0xc00
    v_bfe_i32 v253, s45, v2, 1
    s_mov_b32 s45, 0x300
    v_bfe_i32 v254, s45, v2, 1
    s_mov_b32 s45, 0xc0
    v_bfe_i32 v131, s45, v2, 1
    s_mov_b32 s74, 0x05040100
    s_mov_b32 s75, 0x07060302
    s_lshl_b32 s49, s39, 2
    s_add_u32 s49, s49, s40
    s_cmp_ge_u32 s49, 54
    s_cselect_b32 s44, 54, 0
    s_cselect_b32 s45, 3, 0
    s_sub_u32 s44, s49, s44
    s_mul_i32 s46, s44, 171
    s_lshr_b32 s46, s46, 9
    s_mul_i32 s47, s46, 3
    s_sub_u32 s44, s44, s47
    s_add_u32 s45, s45, s44
    s_sub_u32 s44, s49, 108
    s_and_b32 s47, s44, 1
    s_add_u32 s47, s47, 6
    s_lshr_b32 s44, s44, 1
    s_cmp_ge_u32 s49, 108
    s_cselect_b32 s46, s44, s46
    s_cselect_b32 s45, s47, s45
    s_sub_u32 s44, s49, 144
    s_cmp_ge_u32 s49, 144
    s_cselect_b32 s46, s44, s46
    s_cselect_b32 s45, 8, s45
    s_add_u32 s44, s38, s45
    s_and_b32 s44, s44, 7
    s_cmp_eq_u32 s45, 0
    s_cselect_b32 s44, 8, s44
    s_lshl_b32 s44, s44, 7
    s_add_u32 s45, s46, 8
    s_sub_u32 s47, s46, 2
    s_cmp_lt_u32 s46, 10
    s_cselect_b32 s45, s45, s47
    s_cmp_lt_u32 s46, 8
    s_cselect_b32 s46, s46, s45
    s_lshr_b32 s45, s46, 2
    s_lshl_b32 s45, s45, 7
    s_and_b32 s47, s46, 3
    s_add_u32 s45, s45, s47
    s_lshl_b32 s47, s46, 1
    s_add_u32 s47, s47, 480
    s_mov_b32 s48, 4294954624
    s_cmp_lt_u32 s46, 16
    s_cselect_b32 s45, s45, s47
    s_cselect_b32 s63, 59904, s48
    s_mul_i32 s47, s38, 576
    s_add_u32 s45, s45, s47
    s_mul_i32 s45, s45, 1152
    s_add_u32 s61, s45, s44
    s_mov_b32 s62, 4608
    s_mul_i32 s46, s38, 1327104
    s_lshl_b32 s47, s49, 10
    s_add_u32 s46, s46, s47
    s_add_u32 s64, s46, 8554496
    s_mov_b32 s65, 331776
    s_mov_b32 s44, 18432
    s_mov_b32 s45, 36864
    v_and_b32 v16, 1, v3
    v_lshrrev_b32 v17, 1, v3
    v_mul_lo_u32 v16, v16, s44
    v_mul_lo_u32 v17, v17, s45
    v_lshlrev_b32 v18, 3, v2
    v_add3_u32 v129, v16, v17, v18
    s_lshl_b32 s49, s39, 2
    s_add_u32 s49, s49, s40
    s_mov_b32 s99, 0x20000
    s_cmp_lt_u32 s49, 89
    s_cselect_b32 s50, 1, 0
    s_cmp_lt_u32 s49, 55
    s_cselect_b64 s[96:97], s[16:17], s[20:21]
    s_mov_b32 s98, 5308416
    s_cbranch_scc0 tb_7
    s_add_u32 s49, s49, 107
    s_mul_i32 s44, s49, 205
    s_lshr_b32 s44, s44, 10
    s_mul_i32 s45, s44, 5
    s_sub_u32 s45, s49, s45
    s_cmp_eq_u32 s45, 4
    s_cselect_b32 s45, 8, s45
    s_sub_u32 s46, s49, 90
    s_and_b32 s47, s46, 3
    s_add_u32 s47, s47, 4
    s_lshr_b32 s46, s46, 2
    s_cmp_lt_u32 s49, 90
    s_cselect_b32 s44, s44, s46
    s_cselect_b32 s45, s45, s47
    s_lshr_b32 s46, s44, 1
    s_lshl_b32 s46, s46, 6
    s_and_b32 s47, s44, 1
    s_lshl_b32 s47, s47, 1
    s_add_u32 s46, s46, s47
    s_mul_i32 s46, s46, 9216
    s_lshl_b32 s45, s45, 7
    s_add_u32 s46, s46, s45
    s_mul_i32 s47, s38, 1152
    s_add_u32 s66, s46, s47
    s_mov_b32 s67, 36864
    s_mov_b32 s68, 36864
    s_mul_i32 s46, s38, 1327104
    s_lshl_b32 s47, s49, 10
    s_add_u32 s46, s46, s47
    s_add_u32 s69, s46, 8388608
    s_mov_b32 s70, 331776
    s_mov_b32 s44, 294912
    s_mov_b32 s45, 9216
    s_branch td_8
tb_7:
    s_add_u32 s49, s49, 73
    s_min_u32 s49, s49, 161
    s_cmp_ge_u32 s49, 54
    s_cselect_b32 s44, 54, 0
    s_cselect_b32 s45, 3, 0
    s_sub_u32 s44, s49, s44
    s_mul_i32 s46, s44, 171
    s_lshr_b32 s46, s46, 9
    s_mul_i32 s47, s46, 3
    s_sub_u32 s44, s44, s47
    s_add_u32 s45, s45, s44
    s_sub_u32 s44, s49, 108
    s_and_b32 s47, s44, 1
    s_add_u32 s47, s47, 6
    s_lshr_b32 s44, s44, 1
    s_cmp_ge_u32 s49, 108
    s_cselect_b32 s46, s44, s46
    s_cselect_b32 s45, s47, s45
    s_sub_u32 s44, s49, 144
    s_cmp_ge_u32 s49, 144
    s_cselect_b32 s46, s44, s46
    s_cselect_b32 s45, 8, s45
    s_add_u32 s44, s38, s45
    s_and_b32 s44, s44, 7
    s_cmp_eq_u32 s45, 0
    s_cselect_b32 s44, 8, s44
    s_lshl_b32 s44, s44, 7
    s_add_u32 s45, s46, 8
    s_sub_u32 s47, s46, 2
    s_cmp_lt_u32 s46, 10
    s_cselect_b32 s45, s45, s47
    s_cmp_lt_u32 s46, 8
    s_cselect_b32 s46, s46, s45
    s_lshr_b32 s45, s46, 2
    s_lshl_b32 s45, s45, 7
    s_and_b32 s47, s46, 3
    s_add_u32 s45, s45, s47
    s_lshl_b32 s47, s46, 1
    s_add_u32 s47, s47, 480
    s_mov_b32 s48, 4294954624
    s_cmp_lt_u32 s46, 16
    s_cselect_b32 s45, s45, s47
    s_cselect_b32 s68, 59904, s48
    s_mul_i32 s47, s38, 576
    s_add_u32 s45, s45, s47
    s_mul_i32 s45, s45, 1152
    s_add_u32 s66, s45, s44
    s_mov_b32 s67, 4608
    s_mul_i32 s46, s38, 1327104
    s_lshl_b32 s47, s49, 10
    s_add_u32 s46, s46, s47
    s_add_u32 s69, s46, 8554496
    s_mov_b32 s70, 331776
    s_mov_b32 s44, 18432
    s_mov_b32 s45, 36864
    s_cmp_eq_u32 s50, 0
    s_cselect_b32 s66, 0x7f000000, s66
    s_cselect_b32 s69, 0x7f000000, s69
td_8:
    v_and_b32 v16, 1, v3
    v_lshrrev_b32 v17, 1, v3
    v_mul_lo_u32 v16, v16, s44
    v_mul_lo_u32 v17, v17, s45
    v_lshlrev_b32 v18, 3, v2
    v_add3_u32 v130, v16, v17, v18
    s_waitcnt vmcnt(12) lgkmcnt(0)
    s_cmp_lg_u32 s2, 0
    s_cbranch_scc1 ng_9
    s_barrier
    v_mov_b32 v16, 1
    v_mov_b32 v17, 0
    s_mov_b64 exec, 1
    buffer_store_dword v16, v17, s[28:31], 0 offen sc1
    s_mov_b64 exec, -1
ng_9:
    ds_read_b128 a[0:3], v140 offset:0
    ds_read_b128 a[4:7], v140 offset:8192
    ds_read_b128 a[8:11], v141 offset:0
    ds_read_b128 a[12:15], v141 offset:8192
    s_barrier
    ds_read_b64_tr_b16 v[64:65], v4 offset:0
    ds_read_b64_tr_b16 v[66:67], v4 offset:1024
    ds_read_b64_tr_b16 v[68:69], v5 offset:0
    ds_read_b64_tr_b16 v[70:71], v5 offset:1024
    ds_read_b64_tr_b16 v[72:73], v6 offset:0
    ds_read_b64_tr_b16 v[74:75], v6 offset:1024
    ds_read_b64_tr_b16 v[76:77], v7 offset:0
    ds_read_b64_tr_b16 v[78:79], v7 offset:1024
    ds_read_b64_tr_b16 v[80:81], v8 offset:0
    ds_read_b64_tr_b16 v[82:83], v8 offset:1024
    s_waitcnt lgkmcnt(10)
    s_mov_b64 exec, s[72:73]
    s_add_u32 m0, s51, 32768
    s_add_u32 s100, s55, 12800
    buffer_load_dwordx4 v13, s[12:15], s55 offen lds
    buffer_load_dwordx4 v13, s[12:15], s100 offen offset:1024 lds
    s_add_u32 s55, s55, 110592
    s_mov_b64 exec, -1
    s_mov_b64 exec, s[72:73]
    s_add_u32 m0, s51, 40960
    s_add_u32 s100, s55, 12800
    buffer_load_dwordx4 v13, s[12:15], s55 offen lds
    buffer_load_dwordx4 v13, s[12:15], s100 offen offset:1024 lds
    s_add_u32 s55, s55, 110592
    s_cmp_eq_u32 s55, 1990656
    s_cselect_b32 s55, 0, s55
    s_mov_b64 exec, -1
    s_cmp_eq_u32 s54, 8
    s_cselect_b32 s89, -8, 1
    s_cselect_b32 s54, -1, s54
    s_add_u32 s54, s54, 1
    s_lshl_b32 s89, s89, 7
    s_add_u32 m0, s51, 114688
    s_nop 0
    buffer_load_dwordx4 v12, s[8:11], s90 offen lds
    s_add_u32 s90, s90, s89
    s_add_u32 m0, s51, 115712
    s_nop 0
    buffer_load_dwordx4 v12, s[8:11], s91 offen lds
    s_add_u32 s91, s91, s89
    s_add_u32 m0, s51, 122880
    s_nop 0
    buffer_load_dwordx4 v12, s[8:11], s92 offen lds
    s_add_u32 s92, s92, s89
    s_add_u32 m0, s51, 123904
    s_nop 0
    buffer_load_dwordx4 v12, s[8:11], s93 offen lds
    s_add_u32 s93, s93, s89
    s_waitcnt lgkmcnt(0)
    v_mfma_f32_16x16x32_bf16 v[16:19], a[0:3], v[64:67], 0
    s_waitcnt vmcnt(12)
    ds_read_b128 a[16:19], v140 offset:16384
    ds_read_b128 a[20:23], v140 offset:24576
    ds_read_b128 a[24:27], v141 offset:16384
    ds_read_b128 a[28:31], v141 offset:24576
    ds_read_b64_tr_b16 v[84:85], v4 offset:8192
    v_mfma_f32_16x16x32_bf16 v[20:23], a[4:7], v[64:67], 0
    ds_read_b64_tr_b16 v[86:87], v4 offset:9216
    s_mov_b64 exec, s[72:73]
    s_add_u32 m0, s51, 49152
    s_add_u32 s100, s55, 12800
    buffer_load_dwordx4 v13, s[12:15], s55 offen lds
    buffer_load_dwordx4 v13, s[12:15], s100 offen offset:1024 lds
    s_add_u32 s55, s55, 110592
    s_mov_b64 exec, -1
    v_mfma_f32_16x16x32_bf16 v[24:27], a[0:3], v[68:71], 0
    ds_read_b64_tr_b16 v[88:89], v5 offset:8192
    s_waitcnt lgkmcnt(3)
    s_cmp_eq_u32 s54, 8
    s_cselect_b32 s89, -8, 1
    s_cselect_b32 s54, -1, s54
    s_add_u32 s54, s54, 1
    s_lshl_b32 s89, s89, 7
    s_add_u32 m0, s51, 131072
    s_nop 0
    buffer_load_dwordx4 v12, s[8:11], s90 offen lds
    s_add_u32 s90, s90, s89
    v_mfma_f32_16x16x32_bf16 v[28:31], a[4:7], v[68:71], 0
    ds_read_b64_tr_b16 v[90:91], v5 offset:9216
    s_add_u32 m0, s51, 132096
    s_nop 0
    buffer_load_dwordx4 v12, s[8:11], s91 offen lds
    s_add_u32 s91, s91, s89
    v_mfma_f32_16x16x32_bf16 v[32:35], a[0:3], v[72:75], 0
    ds_read_b64_tr_b16 v[92:93], v6 offset:8192
    v_mfma_f32_16x16x32_bf16 v[36:39], a[4:7], v[72:75], 0
    s_add_u32 m0, s51, 139264
    s_nop 0
    buffer_load_dwordx4 v12, s[8:11], s92 offen lds
    s_add_u32 s92, s92, s89
    v_mfma_f32_16x16x32_bf16 v[40:43], a[0:3], v[76:79], 0
    ds_read_b64_tr_b16 v[94:95], v6 offset:9216
    v_mfma_f32_16x16x32_bf16 v[44:47], a[4:7], v[76:79], 0
    s_add_u32 m0, s51, 140288
    s_nop 0
    buffer_load_dwordx4 v12, s[8:11], s93 offen lds
    s_add_u32 s93, s93, s89
    v_mfma_f32_16x16x32_bf16 v[48:51], a[0:3], v[80:83], 0
    ds_read_b64_tr_b16 v[96:97], v7 offset:8192
    v_mfma_f32_16x16x32_bf16 v[52:55], a[4:7], v[80:83], 0
    ds_read_b64_tr_b16 v[98:99], v7 offset:9216
    v_mfma_f32_16x16x32_bf16 v[56:59], a[0:3], a[0:3], 0
    ds_read_b64_tr_b16 v[100:101], v8 offset:8192
    v_mfma_f32_16x16x32_bf16 v[60:63], a[4:7], a[4:7], 0
    ds_read_b64_tr_b16 v[102:103], v8 offset:9216
    s_cmp_lg_u32 s40, 0
    s_cbranch_scc1 cs_10
    v_mfma_f32_16x16x32_bf16 v[104:107], v[124:127], v[64:67], 0
    v_mfma_f32_16x16x32_bf16 v[108:111], v[124:127], v[68:71], 0
    v_mfma_f32_16x16x32_bf16 v[112:115], v[124:127], v[72:75], 0
    v_mfma_f32_16x16x32_bf16 v[116:119], v[124:127], v[76:79], 0
    v_mfma_f32_16x16x32_bf16 v[120:123], v[124:127], v[80:83], 0
cs_10:
    s_waitcnt lgkmcnt(0)
    v_mfma_f32_16x16x32_bf16 v[16:19], a[8:11], v[84:87], v[16:19]
    s_waitcnt vmcnt(14)
    ds_read_b128 a[32:35], v140 offset:32768
    ds_read_b128 a[36:39], v140 offset:40960
    ds_read_b128 a[40:43], v141 offset:32768
    ds_read_b128 a[44:47], v141 offset:40960
    s_barrier
    v_mfma_f32_16x16x32_bf16 v[20:23], a[12:15], v[84:87], v[20:23]
    ds_read_b64_tr_b16 v[64:65], v4 offset:16384
    s_mov_b64 exec, s[72:73]
    s_add_u32 m0, s51, 57344
    s_add_u32 s100, s55, 12800
    buffer_load_dwordx4 v13, s[12:15], s55 offen lds
    buffer_load_dwordx4 v13, s[12:15], s100 offen offset:1024 lds
    s_add_u32 s55, s55, 110592
    s_cmp_eq_u32 s55, 1990656
    s_cselect_b32 s55, 0, s55
    s_mov_b64 exec, -1
    v_mfma_f32_16x16x32_bf16 v[24:27], a[8:11], v[88:91], v[24:27]
    ds_read_b64_tr_b16 v[66:67], v4 offset:17408
    s_waitcnt lgkmcnt(2)
    s_cmp_eq_u32 s54, 8
    s_cselect_b32 s89, -8, 1
    s_cselect_b32 s54, -1, s54
    s_add_u32 s54, s54, 1
    s_lshl_b32 s89, s89, 7
    s_add_u32 m0, s51, 147456
    s_nop 0
    buffer_load_dwordx4 v12, s[8:11], s90 offen lds
    s_add_u32 s90, s90, s89
    v_mfma_f32_16x16x32_bf16 v[28:31], a[12:15], v[88:91], v[28:31]
    ds_read_b64_tr_b16 v[68:69], v5 offset:16384
    s_add_u32 m0, s51, 148480
    s_nop 0
    buffer_load_dwordx4 v12, s[8:11], s91 offen lds
    s_add_u32 s91, s91, s89
    v_mfma_f32_16x16x32_bf16 v[32:35], a[8:11], v[92:95], v[32:35]
    ds_read_b64_tr_b16 v[70:71], v5 offset:17408
    s_add_u32 m0, s51, 155648
    s_nop 0
    buffer_load_dwordx4 v12, s[8:11], s92 offen lds
    s_add_u32 s92, s92, s89
    v_mfma_f32_16x16x32_bf16 v[36:39], a[12:15], v[92:95], v[36:39]
    ds_read_b64_tr_b16 v[72:73], v6 offset:16384
    v_mfma_f32_16x16x32_bf16 v[40:43], a[8:11], v[96:99], v[40:43]
    s_add_u32 m0, s51, 156672
    s_nop 0
    buffer_load_dwordx4 v12, s[8:11], s93 offen lds
    s_add_u32 s93, s93, s89
    v_mfma_f32_16x16x32_bf16 v[44:47], a[12:15], v[96:99], v[44:47]
    ds_read_b64_tr_b16 v[74:75], v6 offset:17408
    v_mfma_f32_16x16x32_bf16 v[48:51], a[8:11], v[100:103], v[48:51]
    ds_read_b64_tr_b16 v[76:77], v7 offset:16384
    v_mfma_f32_16x16x32_bf16 v[52:55], a[12:15], v[100:103], v[52:55]
    ds_read_b64_tr_b16 v[78:79], v7 offset:17408
    v_mfma_f32_16x16x32_bf16 v[56:59], a[8:11], a[8:11], v[56:59]
    ds_read_b64_tr_b16 v[80:81], v8 offset:16384
    v_mfma_f32_16x16x32_bf16 v[60:63], a[12:15], a[12:15], v[60:63]
    ds_read_b64_tr_b16 v[82:83], v8 offset:17408
    s_cmp_lg_u32 s40, 1
    s_cbranch_scc1 cs_11
    v_mfma_f32_16x16x32_bf16 v[104:107], v[124:127], v[84:87], 0
    v_mfma_f32_16x16x32_bf16 v[108:111], v[124:127], v[88:91], 0
    v_mfma_f32_16x16x32_bf16 v[112:115], v[124:127], v[92:95], 0
    v_mfma_f32_16x16x32_bf16 v[116:119], v[124:127], v[96:99], 0
    v_mfma_f32_16x16x32_bf16 v[120:123], v[124:127], v[100:103], 0
cs_11:
    s_waitcnt lgkmcnt(0)
    v_mfma_f32_16x16x32_bf16 v[16:19], a[16:19], v[64:67], v[16:19]
    ds_read_b64_tr_b16 v[84:85], v4 offset:24576
    v_mfma_f32_16x16x32_bf16 v[20:23], a[20:23], v[64:67], v[20:23]
    ds_read_b64_tr_b16 v[86:87], v4 offset:25600
    v_mfma_f32_16x16x32_bf16 v[24:27], a[16:19], v[68:71], v[24:27]
    ds_read_b64_tr_b16 v[88:89], v5 offset:24576
    v_mfma_f32_16x16x32_bf16 v[28:31], a[20:23], v[68:71], v[28:31]
    s_mov_b64 exec, s[72:73]
    s_add_u32 m0, s51, 65536
    s_add_u32 s100, s55, 12800
    buffer_load_dwordx4 v13, s[12:15], s55 offen lds
    buffer_load_dwordx4 v13, s[12:15], s100 offen offset:1024 lds
    s_add_u32 s55, s55, 110592
    s_mov_b64 exec, -1
    v_mfma_f32_16x16x32_bf16 v[32:35], a[16:19], v[72:75], v[32:35]
    ds_read_b64_tr_b16 v[90:91], v5 offset:25600
    v_mfma_f32_16x16x32_bf16 v[36:39], a[20:23], v[72:75], v[36:39]
    ds_read_b64_tr_b16 v[92:93], v6 offset:24576
    v_mfma_f32_16x16x32_bf16 v[40:43], a[16:19], v[76:79], v[40:43]
    ds_read_b64_tr_b16 v[94:95], v6 offset:25600
    v_mfma_f32_16x16x32_bf16 v[44:47], a[20:23], v[76:79], v[44:47]
    ds_read_b64_tr_b16 v[96:97], v7 offset:24576
    v_mfma_f32_16x16x32_bf16 v[48:51], a[16:19], v[80:83], v[48:51]
    ds_read_b64_tr_b16 v[98:99], v7 offset:25600
    v_mfma_f32_16x16x32_bf16 v[52:55], a[20:23], v[80:83], v[52:55]
    ds_read_b64_tr_b16 v[100:101], v8 offset:24576
    v_mfma_f32_16x16x32_bf16 v[56:59], a[16:19], a[16:19], v[56:59]
    ds_read_b64_tr_b16 v[102:103], v8 offset:25600
    v_mfma_f32_16x16x32_bf16 v[60:63], a[20:23], a[20:23], v[60:63]
    s_cmp_eq_u32 s26, 663552
    s_cbranch_scc0 wo_12
    v_perm_b32 v184, v202, v200, s74
    v_perm_b32 v185, v206, v204, s74
    v_perm_b32 v186, v210, v208, s74
    v_perm_b32 v187, v214, v212, s74
    buffer_store_dwordx4 v[184:187], v1, s[4:7], s59 offen sc1
    s_add_u32 s59, s59, s60
    v_perm_b32 v188, v202, v200, s75
    v_perm_b32 v189, v206, v204, s75
    v_perm_b32 v190, v210, v208, s75
    v_perm_b32 v191, v214, v212, s75
    buffer_store_dwordx4 v[188:191], v1, s[4:7], s59 offen sc1
    s_add_u32 s59, s59, s60
    v_perm_b32 v192, v203, v201, s74
    v_perm_b32 v193, v207, v205, s74
    v_perm_b32 v194, v211, v209, s74
    v_perm_b32 v195, v215, v213, s74
    buffer_store_dwordx4 v[192:195], v1, s[4:7], s59 offen sc1
    s_add_u32 s59, s59, s60
    v_perm_b32 v196, v203, v201, s75
    v_perm_b32 v197, v207, v205, s75
    v_perm_b32 v198, v211, v209, s75
    v_perm_b32 v199, v215, v213, s75
    buffer_store_dwordx4 v[196:199], v1, s[4:7], s59 offen sc1
    s_add_u32 s59, s59, s60
    s_mov_b32 s56, 0x7f000000
    s_mov_b32 s59, 0x7f000000
wo_12:
    s_cmp_lg_u32 s40, 2
    s_cbranch_scc1 cs_13
    v_mfma_f32_16x16x32_bf16 v[104:107], v[124:127], v[64:67], 0
    v_mfma_f32_16x16x32_bf16 v[108:111], v[124:127], v[68:71], 0
    v_mfma_f32_16x16x32_bf16 v[112:115], v[124:127], v[72:75], 0
    v_mfma_f32_16x16x32_bf16 v[116:119], v[124:127], v[76:79], 0
    v_mfma_f32_16x16x32_bf16 v[120:123], v[124:127], v[80:83], 0
cs_13:
    s_waitcnt lgkmcnt(0)
    v_mfma_f32_16x16x32_bf16 v[16:19], a[24:27], v[84:87], v[16:19]
    s_waitcnt vmcnt(14)
    ds_read_b128 a[48:51], v140 offset:0
    ds_read_b128 a[52:55], v140 offset:8192
    ds_read_b128 a[56:59], v141 offset:0
    ds_read_b128 a[60:63], v141 offset:8192
    s_barrier
    v_mfma_f32_16x16x32_bf16 v[20:23], a[28:31], v[84:87], v[20:23]
    ds_read_b64_tr_b16 v[64:65], v4 offset:32768
    s_mov_b64 exec, s[72:73]
    s_add_u32 m0, s51, 73728
    s_add_u32 s100, s55, 12800
    buffer_load_dwordx4 v13, s[12:15], s55 offen lds
    buffer_load_dwordx4 v13, s[12:15], s100 offen offset:1024 lds
    s_add_u32 s55, s55, 110592
    s_cmp_eq_u32 s55, 1990656
    s_cselect_b32 s55, 0, s55
    s_mov_b64 exec, -1
    v_mfma_f32_16x16x32_bf16 v[24:27], a[24:27], v[88:91], v[24:27]
    ds_read_b64_tr_b16 v[66:67], v4 offset:33792
    s_waitcnt lgkmcnt(2)
    s_cmp_eq_u32 s54, 8
    s_cselect_b32 s89, -8, 1
    s_cselect_b32 s54, -1, s54
    s_add_u32 s54, s54, 1
    s_lshl_b32 s89, s89, 7
    s_add_u32 m0, s51, 114688
    s_nop 0
    buffer_load_dwordx4 v12, s[8:11], s90 offen lds
    s_add_u32 s90, s90, s89
    v_mfma_f32_16x16x32_bf16 v[28:31], a[28:31], v[88:91], v[28:31]
    ds_read_b64_tr_b16 v[68:69], v5 offset:32768
    s_add_u32 m0, s51, 115712
    s_nop 0
    buffer_load_dwordx4 v12, s[8:11], s91 offen lds
    s_add_u32 s91, s91, s89
    v_mfma_f32_16x16x32_bf16 v[32:35], a[24:27], v[92:95], v[32:35]
    ds_read_b64_tr_b16 v[70:71], v5 offset:33792
    s_add_u32 m0, s51, 122880
    s_nop 0
    buffer_load_dwordx4 v12, s[8:11], s92 offen lds
    s_add_u32 s92, s92, s89
    v_mfma_f32_16x16x32_bf16 v[36:39], a[28:31], v[92:95], v[36:39]
    ds_read_b64_tr_b16 v[72:73], v6 offset:32768
    v_mfma_f32_16x16x32_bf16 v[40:43], a[24:27], v[96:99], v[40:43]
    s_add_u32 m0, s51, 123904
    s_nop 0
    buffer_load_dwordx4 v12, s[8:11], s93 offen lds
    s_add_u32 s93, s93, s89
    v_mfma_f32_16x16x32_bf16 v[44:47], a[28:31], v[96:99], v[44:47]
    ds_read_b64_tr_b16 v[74:75], v6 offset:33792
    v_mfma_f32_16x16x32_bf16 v[48:51], a[24:27], v[100:103], v[48:51]
    ds_read_b64_tr_b16 v[76:77], v7 offset:32768
    v_mfma_f32_16x16x32_bf16 v[52:55], a[28:31], v[100:103], v[52:55]
    ds_read_b64_tr_b16 v[78:79], v7 offset:33792
    v_mfma_f32_16x16x32_bf16 v[56:59], a[24:27], a[24:27], v[56:59]
    ds_read_b64_tr_b16 v[80:81], v8 offset:32768
    v_mfma_f32_16x16x32_bf16 v[60:63], a[28:31], a[28:31], v[60:63]
    ds_read_b64_tr_b16 v[82:83], v8 offset:33792
    s_cmp_lg_u32 s40, 3
    s_cbranch_scc1 cs_14
    v_mfma_f32_16x16x32_bf16 v[104:107], v[124:127], v[84:87], 0
    v_mfma_f32_16x16x32_bf16 v[108:111], v[124:127], v[88:91], 0
    v_mfma_f32_16x16x32_bf16 v[112:115], v[124:127], v[92:95], 0
    v_mfma_f32_16x16x32_bf16 v[116:119], v[124:127], v[96:99], 0
    v_mfma_f32_16x16x32_bf16 v[120:123], v[124:127], v[100:103], 0
cs_14:
    s_waitcnt lgkmcnt(0)
    v_mfma_f32_16x16x32_bf16 v[16:19], a[32:35], v[64:67], v[16:19]
    s_waitcnt vmcnt(14)
    ds_read_b128 a[64:67], v140 offset:16384
    ds_read_b128 a[68:71], v140 offset:24576
    ds_read_b128 a[72:75], v141 offset:16384
    ds_read_b128 a[76:79], v141 offset:24576
    ds_read_b64_tr_b16 v[84:85], v4 offset:40960
    v_mfma_f32_16x16x32_bf16 v[20:23], a[36:39], v[64:67], v[20:23]
    ds_read_b64_tr_b16 v[86:87], v4 offset:41984
    s_mov_b64 exec, s[72:73]
    s_add_u32 m0, s51, 81920
    s_add_u32 s100, s55, 12800
    buffer_load_dwordx4 v13, s[12:15], s55 offen lds
    buffer_load_dwordx4 v13, s[12:15], s100 offen offset:1024 lds
    s_add_u32 s55, s55, 110592
    s_mov_b64 exec, -1
    v_mfma_f32_16x16x32_bf16 v[24:27], a[32:35], v[68:71], v[24:27]
    ds_read_b64_tr_b16 v[88:89], v5 offset:40960
    s_waitcnt lgkmcnt(3)
    s_cmp_eq_u32 s54, 8
    s_cselect_b32 s89, -8, 1
    s_cselect_b32 s54, -1, s54
    s_add_u32 s54, s54, 1
    s_lshl_b32 s89, s89, 7
    s_add_u32 m0, s51, 131072
    s_nop 0
    buffer_load_dwordx4 v12, s[8:11], s90 offen lds
    s_add_u32 s90, s90, s89
    v_mfma_f32_16x16x32_bf16 v[28:31], a[36:39], v[68:71], v[28:31]
    ds_read_b64_tr_b16 v[90:91], v5 offset:41984
    s_add_u32 m0, s51, 132096
    s_nop 0
    buffer_load_dwordx4 v12, s[8:11], s91 offen lds
    s_add_u32 s91, s91, s89
    v_mfma_f32_16x16x32_bf16 v[32:35], a[32:35], v[72:75], v[32:35]
    ds_read_b64_tr_b16 v[92:93], v6 offset:40960
    v_mfma_f32_16x16x32_bf16 v[36:39], a[36:39], v[72:75], v[36:39]
    s_add_u32 m0, s51, 139264
    s_nop 0
    buffer_load_dwordx4 v12, s[8:11], s92 offen lds
    s_add_u32 s92, s92, s89
    v_mfma_f32_16x16x32_bf16 v[40:43], a[32:35], v[76:79], v[40:43]
    ds_read_b64_tr_b16 v[94:95], v6 offset:41984
    v_mfma_f32_16x16x32_bf16 v[44:47], a[36:39], v[76:79], v[44:47]
    s_add_u32 m0, s51, 140288
    s_nop 0
    buffer_load_dwordx4 v12, s[8:11], s93 offen lds
    s_add_u32 s93, s93, s89
    v_mfma_f32_16x16x32_bf16 v[48:51], a[32:35], v[80:83], v[48:51]
    ds_read_b64_tr_b16 v[96:97], v7 offset:40960
    v_mfma_f32_16x16x32_bf16 v[52:55], a[36:39], v[80:83], v[52:55]
    ds_read_b64_tr_b16 v[98:99], v7 offset:41984
    v_mfma_f32_16x16x32_bf16 v[56:59], a[32:35], a[32:35], v[56:59]
    ds_read_b64_tr_b16 v[100:101], v8 offset:40960
    v_mfma_f32_16x16x32_bf16 v[60:63], a[36:39], a[36:39], v[60:63]
    ds_read_b64_tr_b16 v[102:103], v8 offset:41984
    s_cmp_lg_u32 s40, 0
    s_cbranch_scc1 cs_15
    v_mfma_f32_16x16x32_bf16 v[104:107], v[124:127], v[64:67], v[104:107]
    v_mfma_f32_16x16x32_bf16 v[108:111], v[124:127], v[68:71], v[108:111]
    v_mfma_f32_16x16x32_bf16 v[112:115], v[124:127], v[72:75], v[112:115]
    v_mfma_f32_16x16x32_bf16 v[116:119], v[124:127], v[76:79], v[116:119]
    v_mfma_f32_16x16x32_bf16 v[120:123], v[124:127], v[80:83], v[120:123]
cs_15:
    s_waitcnt lgkmcnt(0)
    v_mfma_f32_16x16x32_bf16 v[16:19], a[40:43], v[84:87], v[16:19]
    s_waitcnt vmcnt(18)
    s_barrier
    v_mfma_f32_16x16x32_bf16 v[20:23], a[44:47], v[84:87], v[20:23]
    ds_read_b64_tr_b16 v[64:65], v4 offset:49152
    v_mfma_f32_16x16x32_bf16 v[24:27], a[40:43], v[88:91], v[24:27]
    ds_read_b64_tr_b16 v[66:67], v4 offset:50176
    v_mfma_f32_16x16x32_bf16 v[28:31], a[44:47], v[88:91], v[28:31]
    s_mov_b64 exec, s[72:73]
    s_add_u32 m0, s51, 90112
    s_add_u32 s100, s55, 12800
    buffer_load_dwordx4 v13, s[12:15], s55 offen lds
    buffer_load_dwordx4 v13, s[12:15], s100 offen offset:1024 lds
    s_add_u32 s55, s55, 110592
    s_cmp_eq_u32 s55, 1990656
    s_cselect_b32 s55, 0, s55
    s_mov_b64 exec, -1
    v_mfma_f32_16x16x32_bf16 v[32:35], a[40:43], v[92:95], v[32:35]
    ds_read_b64_tr_b16 v[68:69], v5 offset:49152
    v_mfma_f32_16x16x32_bf16 v[36:39], a[44:47], v[92:95], v[36:39]
    ds_read_b64_tr_b16 v[70:71], v5 offset:50176
    v_mfma_f32_16x16x32_bf16 v[40:43], a[40:43], v[96:99], v[40:43]
    ds_read_b64_tr_b16 v[72:73], v6 offset:49152
    v_mfma_f32_16x16x32_bf16 v[44:47], a[44:47], v[96:99], v[44:47]
    ds_read_b64_tr_b16 v[74:75], v6 offset:50176
    v_mfma_f32_16x16x32_bf16 v[48:51], a[40:43], v[100:103], v[48:51]
    ds_read_b64_tr_b16 v[76:77], v7 offset:49152
    v_mfma_f32_16x16x32_bf16 v[52:55], a[44:47], v[100:103], v[52:55]
    ds_read_b64_tr_b16 v[78:79], v7 offset:50176
    v_mfma_f32_16x16x32_bf16 v[56:59], a[40:43], a[40:43], v[56:59]
    ds_read_b64_tr_b16 v[80:81], v8 offset:49152
    v_mfma_f32_16x16x32_bf16 v[60:63], a[44:47], a[44:47], v[60:63]
    ds_read_b64_tr_b16 v[82:83], v8 offset:50176
    s_cmp_lg_u32 s40, 1
    s_cbranch_scc1 cs_16
    v_mfma_f32_16x16x32_bf16 v[104:107], v[124:127], v[84:87], v[104:107]
    v_mfma_f32_16x16x32_bf16 v[108:111], v[124:127], v[88:91], v[108:111]
    v_mfma_f32_16x16x32_bf16 v[112:115], v[124:127], v[92:95], v[112:115]
    v_mfma_f32_16x16x32_bf16 v[116:119], v[124:127], v[96:99], v[116:119]
    v_mfma_f32_16x16x32_bf16 v[120:123], v[124:127], v[100:103], v[120:123]
cs_16:
    s_waitcnt lgkmcnt(0)
    v_mfma_f32_16x16x32_bf16 v[16:19], a[48:51], v[64:67], v[16:19]
    s_waitcnt vmcnt(16)
    ds_read_b128 a[80:83], v140 offset:32768
    ds_read_b128 a[84:87], v140 offset:40960
    ds_read_b128 a[88:91], v141 offset:32768
    ds_read_b128 a[92:95], v141 offset:40960
    ds_read_b64_tr_b16 v[84:85], v4 offset:57344
    v_mfma_f32_16x16x32_bf16 v[20:23], a[52:55], v[64:67], v[20:23]
    ds_read_b64_tr_b16 v[86:87], v4 offset:58368
    s_mov_b64 exec, s[72:73]
    s_add_u32 m0, s51, 98304
    s_add_u32 s100, s55, 12800
    buffer_load_dwordx4 v13, s[12:15], s55 offen lds
    buffer_load_dwordx4 v13, s[12:15], s100 offen offset:1024 lds
    s_add_u32 s55, s55, 110592
    s_mov_b64 exec, -1
    v_mfma_f32_16x16x32_bf16 v[24:27], a[48:51], v[68:71], v[24:27]
    ds_read_b64_tr_b16 v[88:89], v5 offset:57344
    s_waitcnt lgkmcnt(3)
    s_add_u32 m0, s51, 147456
    s_nop 0
    buffer_load_dwordx4 v12, s[8:11], s90 offen lds
    v_mfma_f32_16x16x32_bf16 v[28:31], a[52:55], v[68:71], v[28:31]
    ds_read_b64_tr_b16 v[90:91], v5 offset:58368
    s_add_u32 m0, s51, 148480
    s_nop 0
    buffer_load_dwordx4 v12, s[8:11], s91 offen lds
    v_mfma_f32_16x16x32_bf16 v[32:35], a[48:51], v[72:75], v[32:35]
    ds_read_b64_tr_b16 v[92:93], v6 offset:57344
    v_mfma_f32_16x16x32_bf16 v[36:39], a[52:55], v[72:75], v[36:39]
    s_add_u32 m0, s51, 155648
    s_nop 0
    buffer_load_dwordx4 v12, s[8:11], s92 offen lds
    v_mfma_f32_16x16x32_bf16 v[40:43], a[48:51], v[76:79], v[40:43]
    ds_read_b64_tr_b16 v[94:95], v6 offset:58368
    v_mfma_f32_16x16x32_bf16 v[44:47], a[52:55], v[76:79], v[44:47]
    s_add_u32 m0, s51, 156672
    s_nop 0
    buffer_load_dwordx4 v12, s[8:11], s93 offen lds
    v_mfma_f32_16x16x32_bf16 v[48:51], a[48:51], v[80:83], v[48:51]
    ds_read_b64_tr_b16 v[96:97], v7 offset:57344
    v_mfma_f32_16x16x32_bf16 v[52:55], a[52:55], v[80:83], v[52:55]
    ds_read_b64_tr_b16 v[98:99], v7 offset:58368
    v_mfma_f32_16x16x32_bf16 v[56:59], a[48:51], a[48:51], v[56:59]
    ds_read_b64_tr_b16 v[100:101], v8 offset:57344
    v_mfma_f32_16x16x32_bf16 v[60:63], a[52:55], a[52:55], v[60:63]
    ds_read_b64_tr_b16 v[102:103], v8 offset:58368
    s_cmp_lg_u32 s40, 2
    s_cbranch_scc1 cs_17
    v_mfma_f32_16x16x32_bf16 v[104:107], v[124:127], v[64:67], v[104:107]
    v_mfma_f32_16x16x32_bf16 v[108:111], v[124:127], v[68:71], v[108:111]
    v_mfma_f32_16x16x32_bf16 v[112:115], v[124:127], v[72:75], v[112:115]
    v_mfma_f32_16x16x32_bf16 v[116:119], v[124:127], v[76:79], v[116:119]
    v_mfma_f32_16x16x32_bf16 v[120:123], v[124:127], v[80:83], v[120:123]
cs_17:
    s_waitcnt lgkmcnt(0)
    v_mfma_f32_16x16x32_bf16 v[16:19], a[56:59], v[84:87], v[16:19]
    s_waitcnt vmcnt(14)
    ds_read_b128 a[96:99], v140 offset:0
    ds_read_b128 a[100:103], v140 offset:8192
    ds_read_b128 a[104:107], v141 offset:0
    ds_read_b128 a[108:111], v141 offset:8192
    s_mov_b64 exec, 0xffff
    ds_write_b128 v142, v[124:127]
    s_mov_b64 exec, -1
    v_add_u32 v142, 0x4000, v142
    s_barrier
    v_mfma_f32_16x16x32_bf16 v[20:23], a[60:63], v[84:87], v[20:23]
    v_add_u32 v4, 0x10000, v4
    v_add_u32 v5, 0x10000, v5
    v_add_u32 v6, 0x10000, v6
    v_add_u32 v7, 0x10000, v7
    v_add_u32 v8, 0x10000, v8
    s_mov_b64 exec, s[72:73]
    s_add_u32 m0, s51, 106496
    s_add_u32 s100, s55, 12800
    buffer_load_dwordx4 v13, s[12:15], s55 offen lds
    buffer_load_dwordx4 v13, s[12:15], s100 offen offset:1024 lds
    s_add_u32 s55, s55, 110592
    s_cmp_eq_u32 s55, 1990656
    s_cselect_b32 s55, 0, s55
    s_mov_b64 exec, -1
    v_mfma_f32_16x16x32_bf16 v[24:27], a[56:59], v[88:91], v[24:27]
    ds_read_b64_tr_b16 v[64:65], v4 offset:0
    v_mfma_f32_16x16x32_bf16 v[28:31], a[60:63], v[88:91], v[28:31]
    ds_read_b64_tr_b16 v[66:67], v4 offset:1024
    v_mfma_f32_16x16x32_bf16 v[32:35], a[56:59], v[92:95], v[32:35]
    ds_read_b64_tr_b16 v[68:69], v5 offset:0
    v_mfma_f32_16x16x32_bf16 v[36:39], a[60:63], v[92:95], v[36:39]
    ds_read_b64_tr_b16 v[70:71], v5 offset:1024
    v_mfma_f32_16x16x32_bf16 v[40:43], a[56:59], v[96:99], v[40:43]
    ds_read_b64_tr_b16 v[72:73], v6 offset:0
    v_mfma_f32_16x16x32_bf16 v[44:47], a[60:63], v[96:99], v[44:47]
    ds_read_b64_tr_b16 v[74:75], v6 offset:1024
    v_mfma_f32_16x16x32_bf16 v[48:51], a[56:59], v[100:103], v[48:51]
    ds_read_b64_tr_b16 v[76:77], v7 offset:0
    v_mfma_f32_16x16x32_bf16 v[52:55], a[60:63], v[100:103], v[52:55]
    ds_read_b64_tr_b16 v[78:79], v7 offset:1024
    v_mfma_f32_16x16x32_bf16 v[56:59], a[56:59], a[56:59], v[56:59]
    ds_read_b64_tr_b16 v[80:81], v8 offset:0
    v_mfma_f32_16x16x32_bf16 v[60:63], a[60:63], a[60:63], v[60:63]
    ds_read_b64_tr_b16 v[82:83], v8 offset:1024
    s_cmp_lg_u32 s40, 3
    s_cbranch_scc1 cs_18
    v_mfma_f32_16x16x32_bf16 v[104:107], v[124:127], v[84:87], v[104:107]
    v_mfma_f32_16x16x32_bf16 v[108:111], v[124:127], v[88:91], v[108:111]
    v_mfma_f32_16x16x32_bf16 v[112:115], v[124:127], v[92:95], v[112:115]
    v_mfma_f32_16x16x32_bf16 v[116:119], v[124:127], v[96:99], v[116:119]
    v_mfma_f32_16x16x32_bf16 v[120:123], v[124:127], v[100:103], v[120:123]
cs_18:
    s_waitcnt lgkmcnt(0)
    v_mfma_f32_16x16x32_bf16 v[16:19], a[64:67], v[64:67], v[16:19]
    ds_read_b64_tr_b16 v[84:85], v4 offset:8192
    v_mfma_f32_16x16x32_bf16 v[20:23], a[68:71], v[64:67], v[20:23]
    ds_read_b64_tr_b16 v[86:87], v4 offset:9216
    v_mfma_f32_16x16x32_bf16 v[24:27], a[64:67], v[68:71], v[24:27]
    ds_read_b64_tr_b16 v[88:89], v5 offset:8192
    v_mfma_f32_16x16x32_bf16 v[28:31], a[68:71], v[68:71], v[28:31]
    s_mov_b64 exec, s[72:73]
    s_add_u32 m0, s51, 114688
    s_add_u32 s100, s55, 12800
    buffer_load_dwordx4 v13, s[12:15], s55 offen lds
    buffer_load_dwordx4 v13, s[12:15], s100 offen offset:1024 lds
    s_add_u32 s55, s55, 110592
    s_mov_b64 exec, -1
    v_mfma_f32_16x16x32_bf16 v[32:35], a[64:67], v[72:75], v[32:35]
    ds_read_b64_tr_b16 v[90:91], v5 offset:9216
    v_mfma_f32_16x16x32_bf16 v[36:39], a[68:71], v[72:75], v[36:39]
    ds_read_b64_tr_b16 v[92:93], v6 offset:8192
    v_mfma_f32_16x16x32_bf16 v[40:43], a[64:67], v[76:79], v[40:43]
    ds_read_b64_tr_b16 v[94:95], v6 offset:9216
    v_mfma_f32_16x16x32_bf16 v[44:47], a[68:71], v[76:79], v[44:47]
    ds_read_b64_tr_b16 v[96:97], v7 offset:8192
    v_mfma_f32_16x16x32_bf16 v[48:51], a[64:67], v[80:83], v[48:51]
    ds_read_b64_tr_b16 v[98:99], v7 offset:9216
    v_mfma_f32_16x16x32_bf16 v[52:55], a[68:71], v[80:83], v[52:55]
    ds_read_b64_tr_b16 v[100:101], v8 offset:8192
    v_mfma_f32_16x16x32_bf16 v[56:59], a[64:67], a[64:67], v[56:59]
    ds_read_b64_tr_b16 v[102:103], v8 offset:9216
    v_mfma_f32_16x16x32_bf16 v[60:63], a[68:71], a[68:71], v[60:63]
    s_cmp_lg_u32 s40, 0
    s_cbranch_scc1 cs_19
    v_mfma_f32_16x16x32_bf16 v[104:107], v[124:127], v[64:67], v[104:107]
    v_mfma_f32_16x16x32_bf16 v[108:111], v[124:127], v[68:71], v[108:111]
    v_mfma_f32_16x16x32_bf16 v[112:115], v[124:127], v[72:75], v[112:115]
    v_mfma_f32_16x16x32_bf16 v[116:119], v[124:127], v[76:79], v[116:119]
    v_mfma_f32_16x16x32_bf16 v[120:123], v[124:127], v[80:83], v[120:123]
cs_19:
    s_waitcnt lgkmcnt(0)
    v_mfma_f32_16x16x32_bf16 v[16:19], a[72:75], v[84:87], v[16:19]
    s_waitcnt vmcnt(12)
    ds_read_b128 a[112:115], v140 offset:16384
    ds_read_b128 a[116:119], v140 offset:24576
    ds_read_b128 a[120:123], v141 offset:16384
    ds_read_b128 a[124:127], v141 offset:24576
    s_mov_b64 exec, 0xffff
    ds_write_b128 v142, v[124:127]
    s_mov_b64 exec, -1
    v_add_u32 v142, 0x4000, v142
    s_waitcnt vmcnt(10)
    s_barrier
    v_mfma_f32_16x16x32_bf16 v[20:23], a[76:79], v[84:87], v[20:23]
    ds_read_b64_tr_b16 v[64:65], v4 offset:16384
    v_mfma_f32_16x16x32_bf16 v[24:27], a[72:75], v[88:91], v[24:27]
    s_mov_b64 exec, s[72:73]
    s_add_u32 m0, s51, 122880
    s_add_u32 s100, s55, 12800
    buffer_load_dwordx4 v13, s[12:15], s55 offen lds
    buffer_load_dwordx4 v13, s[12:15], s100 offen offset:1024 lds
    s_add_u32 s55, s55, 110592
    s_cmp_eq_u32 s55, 1990656
    s_cselect_b32 s55, 0, s55
    s_mov_b64 exec, -1
    v_mfma_f32_16x16x32_bf16 v[28:31], a[76:79], v[88:91], v[28:31]
    ds_read_b64_tr_b16 v[66:67], v4 offset:17408
    v_mfma_f32_16x16x32_bf16 v[32:35], a[72:75], v[92:95], v[32:35]
    ds_read_b64_tr_b16 v[68:69], v5 offset:16384
    v_mfma_f32_16x16x32_bf16 v[36:39], a[76:79], v[92:95], v[36:39]
    ds_read_b64_tr_b16 v[70:71], v5 offset:17408
    v_mfma_f32_16x16x32_bf16 v[40:43], a[72:75], v[96:99], v[40:43]
    ds_read_b64_tr_b16 v[72:73], v6 offset:16384
    v_mfma_f32_16x16x32_bf16 v[44:47], a[76:79], v[96:99], v[44:47]
    ds_read_b64_tr_b16 v[74:75], v6 offset:17408
    v_mfma_f32_16x16x32_bf16 v[48:51], a[72:75], v[100:103], v[48:51]
    ds_read_b64_tr_b16 v[76:77], v7 offset:16384
    v_mfma_f32_16x16x32_bf16 v[52:55], a[76:79], v[100:103], v[52:55]
    ds_read_b64_tr_b16 v[78:79], v7 offset:17408
    v_mfma_f32_16x16x32_bf16 v[56:59], a[72:75], a[72:75], v[56:59]
    ds_read_b64_tr_b16 v[80:81], v8 offset:16384
    v_mfma_f32_16x16x32_bf16 v[60:63], a[76:79], a[76:79], v[60:63]
    ds_read_b64_tr_b16 v[82:83], v8 offset:17408
    s_cmp_lg_u32 s40, 1
    s_cbranch_scc1 cs_20
    v_mfma_f32_16x16x32_bf16 v[104:107], v[124:127], v[84:87], v[104:107]
    v_mfma_f32_16x16x32_bf16 v[108:111], v[124:127], v[88:91], v[108:111]
    v_mfma_f32_16x16x32_bf16 v[112:115], v[124:127], v[92:95], v[112:115]
    v_mfma_f32_16x16x32_bf16 v[116:119], v[124:127], v[96:99], v[116:119]
    v_mfma_f32_16x16x32_bf16 v[120:123], v[124:127], v[100:103], v[120:123]
cs_20:
    s_waitcnt lgkmcnt(0)
    v_mfma_f32_16x16x32_bf16 v[16:19], a[80:83], v[64:67], v[16:19]
    s_waitcnt vmcnt(6)
    ds_read_b128 a[128:131], v140 offset:32768
    ds_read_b128 a[132:135], v140 offset:40960
    ds_read_b128 a[136:139], v141 offset:32768
    ds_read_b128 a[140:143], v141 offset:40960
    v_mfma_f32_16x16x32_bf16 v[20:23], a[84:87], v[64:67], v[20:23]
    ds_read_b64_tr_b16 v[84:85], v4 offset:24576
    v_mfma_f32_16x16x32_bf16 v[24:27], a[80:83], v[68:71], v[24:27]
    ds_read_b64_tr_b16 v[86:87], v4 offset:25600
    v_mfma_f32_16x16x32_bf16 v[28:31], a[84:87], v[68:71], v[28:31]
    s_mov_b64 exec, s[72:73]
    s_add_u32 m0, s51, 131072
    s_add_u32 s100, s55, 12800
    buffer_load_dwordx4 v13, s[12:15], s55 offen lds
    buffer_load_dwordx4 v13, s[12:15], s100 offen offset:1024 lds
    s_add_u32 s55, s55, 110592
    s_mov_b64 exec, -1
    v_mfma_f32_16x16x32_bf16 v[32:35], a[80:83], v[72:75], v[32:35]
    ds_read_b64_tr_b16 v[88:89], v5 offset:24576
    v_mfma_f32_16x16x32_bf16 v[36:39], a[84:87], v[72:75], v[36:39]
    ds_read_b64_tr_b16 v[90:91], v5 offset:25600
    v_mfma_f32_16x16x32_bf16 v[40:43], a[80:83], v[76:79], v[40:43]
    ds_read_b64_tr_b16 v[92:93], v6 offset:24576
    v_mfma_f32_16x16x32_bf16 v[44:47], a[84:87], v[76:79], v[44:47]
    ds_read_b64_tr_b16 v[94:95], v6 offset:25600
    v_mfma_f32_16x16x32_bf16 v[48:51], a[80:83], v[80:83], v[48:51]
    ds_read_b64_tr_b16 v[96:97], v7 offset:24576
    v_mfma_f32_16x16x32_bf16 v[52:55], a[84:87], v[80:83], v[52:55]
    ds_read_b64_tr_b16 v[98:99], v7 offset:25600
    v_mfma_f32_16x16x32_bf16 v[56:59], a[80:83], a[80:83], v[56:59]
    ds_read_b64_tr_b16 v[100:101], v8 offset:24576
    v_mfma_f32_16x16x32_bf16 v[60:63], a[84:87], a[84:87], v[60:63]
    ds_read_b64_tr_b16 v[102:103], v8 offset:25600
    s_cmp_lg_u32 s40, 2
    s_cbranch_scc1 cs_21
    v_mfma_f32_16x16x32_bf16 v[104:107], v[124:127], v[64:67], v[104:107]
    v_mfma_f32_16x16x32_bf16 v[108:111], v[124:127], v[68:71], v[108:111]
    v_mfma_f32_16x16x32_bf16 v[112:115], v[124:127], v[72:75], v[112:115]
    v_mfma_f32_16x16x32_bf16 v[116:119], v[124:127], v[76:79], v[116:119]
    v_mfma_f32_16x16x32_bf16 v[120:123], v[124:127], v[80:83], v[120:123]
cs_21:
    s_waitcnt lgkmcnt(0)
    v_mfma_f32_16x16x32_bf16 v[16:19], a[88:91], v[84:87], v[16:19]
    s_waitcnt vmcnt(6)
    s_barrier
    ds_read_b64_tr_b16 v[64:65], v4 offset:32768
    v_mfma_f32_16x16x32_bf16 v[20:23], a[92:95], v[84:87], v[20:23]
    ds_read_b64_tr_b16 v[66:67], v4 offset:33792
    s_mov_b64 exec, s[72:73]
    s_add_u32 m0, s51, 139264
    s_add_u32 s100, s55, 12800
    buffer_load_dwordx4 v13, s[12:15], s55 offen lds
    buffer_load_dwordx4 v13, s[12:15], s100 offen offset:1024 lds
    s_add_u32 s55, s55, 110592
    s_cmp_eq_u32 s55, 1990656
    s_cselect_b32 s55, 0, s55
    s_mov_b64 exec, -1
    v_mfma_f32_16x16x32_bf16 v[24:27], a[88:91], v[88:91], v[24:27]
    ds_read_b64_tr_b16 v[68:69], v5 offset:32768
    buffer_load_dwordx2 v[200:201], v128, s[24:27], s56 offen nt
    s_add_u32 s56, s56, s57
    v_mfma_f32_16x16x32_bf16 v[28:31], a[92:95], v[88:91], v[28:31]
    ds_read_b64_tr_b16 v[70:71], v5 offset:33792
    buffer_load_dwordx2 v[202:203], v128, s[24:27], s56 offen nt
    s_add_u32 s56, s56, s57
    v_mfma_f32_16x16x32_bf16 v[32:35], a[88:91], v[92:95], v[32:35]
    ds_read_b64_tr_b16 v[72:73], v6 offset:32768
    v_mfma_f32_16x16x32_bf16 v[36:39], a[92:95], v[92:95], v[36:39]
    buffer_load_dwordx2 v[204:205], v128, s[24:27], s56 offen nt
    s_add_u32 s56, s56, s57
    v_mfma_f32_16x16x32_bf16 v[40:43], a[88:91], v[96:99], v[40:43]
    ds_read_b64_tr_b16 v[74:75], v6 offset:33792
    v_mfma_f32_16x16x32_bf16 v[44:47], a[92:95], v[96:99], v[44:47]
    buffer_load_dwordx2 v[206:207], v128, s[24:27], s56 offen nt
    s_add_u32 s56, s56, s58
    v_mfma_f32_16x16x32_bf16 v[48:51], a[88:91], v[100:103], v[48:51]
    ds_read_b64_tr_b16 v[76:77], v7 offset:32768
    v_mfma_f32_16x16x32_bf16 v[52:55], a[92:95], v[100:103], v[52:55]
    ds_read_b64_tr_b16 v[78:79], v7 offset:33792
    v_mfma_f32_16x16x32_bf16 v[56:59], a[88:91], a[88:91], v[56:59]
    ds_read_b64_tr_b16 v[80:81], v8 offset:32768
    v_mfma_f32_16x16x32_bf16 v[60:63], a[92:95], a[92:95], v[60:63]
    ds_read_b64_tr_b16 v[82:83], v8 offset:33792
    s_cmp_lg_u32 s40, 3
    s_cbranch_scc1 cs_22
    v_mfma_f32_16x16x32_bf16 v[104:107], v[124:127], v[84:87], v[104:107]
    v_mfma_f32_16x16x32_bf16 v[108:111], v[124:127], v[88:91], v[108:111]
    v_mfma_f32_16x16x32_bf16 v[112:115], v[124:127], v[92:95], v[112:115]
    v_mfma_f32_16x16x32_bf16 v[116:119], v[124:127], v[96:99], v[116:119]
    v_mfma_f32_16x16x32_bf16 v[120:123], v[124:127], v[100:103], v[120:123]
cs_22:
    s_waitcnt lgkmcnt(0)
    v_mfma_f32_16x16x32_bf16 v[16:19], a[96:99], v[64:67], v[16:19]
    ds_read_b64_tr_b16 v[84:85], v4 offset:40960
    ds_read_b64_tr_b16 v[86:87], v4 offset:41984
    v_mfma_f32_16x16x32_bf16 v[20:23], a[100:103], v[64:67], v[20:23]
    ds_read_b64_tr_b16 v[88:89], v5 offset:40960
    buffer_load_dwordx2 v[208:209], v128, s[24:27], s56 offen nt
    s_add_u32 s56, s56, s57
    v_mfma_f32_16x16x32_bf16 v[24:27], a[96:99], v[68:71], v[24:27]
    ds_read_b64_tr_b16 v[90:91], v5 offset:41984
    v_mfma_f32_16x16x32_bf16 v[28:31], a[100:103], v[68:71], v[28:31]
    buffer_load_dwordx2 v[210:211], v128, s[24:27], s56 offen nt
    s_add_u32 s56, s56, s57
    v_mfma_f32_16x16x32_bf16 v[32:35], a[96:99], v[72:75], v[32:35]
    ds_read_b64_tr_b16 v[92:93], v6 offset:40960
    v_mfma_f32_16x16x32_bf16 v[36:39], a[100:103], v[72:75], v[36:39]
    buffer_load_dwordx2 v[212:213], v128, s[24:27], s56 offen nt
    s_add_u32 s56, s56, s57
    v_mfma_f32_16x16x32_bf16 v[40:43], a[96:99], v[76:79], v[40:43]
    ds_read_b64_tr_b16 v[94:95], v6 offset:41984
    v_mfma_f32_16x16x32_bf16 v[44:47], a[100:103], v[76:79], v[44:47]
    buffer_load_dwordx2 v[214:215], v128, s[24:27], s56 offen nt
    v_mfma_f32_16x16x32_bf16 v[48:51], a[96:99], v[80:83], v[48:51]
    ds_read_b64_tr_b16 v[96:97], v7 offset:40960
    v_mfma_f32_16x16x32_bf16 v[52:55], a[100:103], v[80:83], v[52:55]
    ds_read_b64_tr_b16 v[98:99], v7 offset:41984
    v_mfma_f32_16x16x32_bf16 v[56:59], a[96:99], a[96:99], v[56:59]
    ds_read_b64_tr_b16 v[100:101], v8 offset:40960
    v_mfma_f32_16x16x32_bf16 v[60:63], a[100:103], a[100:103], v[60:63]
    ds_read_b64_tr_b16 v[102:103], v8 offset:41984
    s_cmp_lg_u32 s40, 0
    s_cbranch_scc1 cs_23
    v_mfma_f32_16x16x32_bf16 v[104:107], v[124:127], v[64:67], v[104:107]
    v_mfma_f32_16x16x32_bf16 v[108:111], v[124:127], v[68:71], v[108:111]
    v_mfma_f32_16x16x32_bf16 v[112:115], v[124:127], v[72:75], v[112:115]
    v_mfma_f32_16x16x32_bf16 v[116:119], v[124:127], v[76:79], v[116:119]
    v_mfma_f32_16x16x32_bf16 v[120:123], v[124:127], v[80:83], v[120:123]
cs_23:
    s_waitcnt lgkmcnt(0)
    v_mfma_f32_16x16x32_bf16 v[16:19], a[104:107], v[84:87], v[16:19]
    s_waitcnt vmcnt(12)
    s_barrier
    ds_read_b64_tr_b16 v[64:65], v4 offset:49152
    v_mfma_f32_16x16x32_bf16 v[20:23], a[108:111], v[84:87], v[20:23]
    ds_read_b64_tr_b16 v[66:67], v4 offset:50176
    buffer_load_dwordx2 v[216:217], v129, s[20:23], s61 offen nt
    s_add_u32 s61, s61, s62
    v_mfma_f32_16x16x32_bf16 v[24:27], a[104:107], v[88:91], v[24:27]
    ds_read_b64_tr_b16 v[68:69], v5 offset:49152
    buffer_load_dwordx2 v[218:219], v129, s[20:23], s61 offen nt
    s_add_u32 s61, s61, s62
    v_mfma_f32_16x16x32_bf16 v[28:31], a[108:111], v[88:91], v[28:31]
    ds_read_b64_tr_b16 v[70:71], v5 offset:50176
    v_mfma_f32_16x16x32_bf16 v[32:35], a[104:107], v[92:95], v[32:35]
    buffer_load_dwordx2 v[220:221], v129, s[20:23], s61 offen nt
    s_add_u32 s61, s61, s62
    v_mfma_f32_16x16x32_bf16 v[36:39], a[108:111], v[92:95], v[36:39]
    ds_read_b64_tr_b16 v[72:73], v6 offset:49152
    v_mfma_f32_16x16x32_bf16 v[40:43], a[104:107], v[96:99], v[40:43]
    buffer_load_dwordx2 v[222:223], v129, s[20:23], s61 offen nt
    s_add_u32 s61, s61, s63
    v_mfma_f32_16x16x32_bf16 v[44:47], a[108:111], v[96:99], v[44:47]
    ds_read_b64_tr_b16 v[74:75], v6 offset:50176
    v_mfma_f32_16x16x32_bf16 v[48:51], a[104:107], v[100:103], v[48:51]
    ds_read_b64_tr_b16 v[76:77], v7 offset:49152
    v_mfma_f32_16x16x32_bf16 v[52:55], a[108:111], v[100:103], v[52:55]
    ds_read_b64_tr_b16 v[78:79], v7 offset:50176
    v_mfma_f32_16x16x32_bf16 v[56:59], a[104:107], a[104:107], v[56:59]
    ds_read_b64_tr_b16 v[80:81], v8 offset:49152
    v_mfma_f32_16x16x32_bf16 v[60:63], a[108:111], a[108:111], v[60:63]
    ds_read_b64_tr_b16 v[82:83], v8 offset:50176
    s_cmp_lg_u32 s40, 1
    s_cbranch_scc1 cs_24
    v_mfma_f32_16x16x32_bf16 v[104:107], v[124:127], v[84:87], v[104:107]
    v_mfma_f32_16x16x32_bf16 v[108:111], v[124:127], v[88:91], v[108:111]
    v_mfma_f32_16x16x32_bf16 v[112:115], v[124:127], v[92:95], v[112:115]
    v_mfma_f32_16x16x32_bf16 v[116:119], v[124:127], v[96:99], v[116:119]
    v_mfma_f32_16x16x32_bf16 v[120:123], v[124:127], v[100:103], v[120:123]
cs_24:
    s_waitcnt lgkmcnt(0)
    v_mfma_f32_16x16x32_bf16 v[16:19], a[112:115], v[64:67], v[16:19]
    ds_read_b64_tr_b16 v[84:85], v4 offset:57344
    ds_read_b64_tr_b16 v[86:87], v4 offset:58368
    v_mfma_f32_16x16x32_bf16 v[20:23], a[116:119], v[64:67], v[20:23]
    ds_read_b64_tr_b16 v[88:89], v5 offset:57344
    buffer_load_dwordx2 v[224:225], v129, s[20:23], s61 offen nt
    s_add_u32 s61, s61, s62
    v_mfma_f32_16x16x32_bf16 v[24:27], a[112:115], v[68:71], v[24:27]
    ds_read_b64_tr_b16 v[90:91], v5 offset:58368
    v_mfma_f32_16x16x32_bf16 v[28:31], a[116:119], v[68:71], v[28:31]
    buffer_load_dwordx2 v[226:227], v129, s[20:23], s61 offen nt
    s_add_u32 s61, s61, s62
    v_mfma_f32_16x16x32_bf16 v[32:35], a[112:115], v[72:75], v[32:35]
    ds_read_b64_tr_b16 v[92:93], v6 offset:57344
    v_mfma_f32_16x16x32_bf16 v[36:39], a[116:119], v[72:75], v[36:39]
    buffer_load_dwordx2 v[228:229], v129, s[20:23], s61 offen nt
    s_add_u32 s61, s61, s62
    v_mfma_f32_16x16x32_bf16 v[40:43], a[112:115], v[76:79], v[40:43]
    ds_read_b64_tr_b16 v[94:95], v6 offset:58368
    v_mfma_f32_16x16x32_bf16 v[44:47], a[116:119], v[76:79], v[44:47]
    buffer_load_dwordx2 v[230:231], v129, s[20:23], s61 offen nt
    v_mfma_f32_16x16x32_bf16 v[48:51], a[112:115], v[80:83], v[48:51]
    ds_read_b64_tr_b16 v[96:97], v7 offset:57344
    v_mfma_f32_16x16x32_bf16 v[52:55], a[116:119], v[80:83], v[52:55]
    ds_read_b64_tr_b16 v[98:99], v7 offset:58368
    v_mfma_f32_16x16x32_bf16 v[56:59], a[112:115], a[112:115], v[56:59]
    ds_read_b64_tr_b16 v[100:101], v8 offset:57344
    v_mfma_f32_16x16x32_bf16 v[60:63], a[116:119], a[116:119], v[60:63]
    ds_read_b64_tr_b16 v[102:103], v8 offset:58368
    s_cmp_lg_u32 s40, 2
    s_cbranch_scc1 cs_25
    v_mfma_f32_16x16x32_bf16 v[104:107], v[124:127], v[64:67], v[104:107]
    v_mfma_f32_16x16x32_bf16 v[108:111], v[124:127], v[68:71], v[108:111]
    v_mfma_f32_16x16x32_bf16 v[112:115], v[124:127], v[72:75], v[112:115]
    v_mfma_f32_16x16x32_bf16 v[116:119], v[124:127], v[76:79], v[116:119]
    v_mfma_f32_16x16x32_bf16 v[120:123], v[124:127], v[80:83], v[120:123]
cs_25:
    s_waitcnt lgkmcnt(0)
    v_mfma_f32_16x16x32_bf16 v[16:19], a[120:123], v[84:87], v[16:19]
    s_waitcnt vmcnt(16)
    s_barrier
    v_add_u32 v4, 0x10000, v4
    v_add_u32 v5, 0x10000, v5
    v_add_u32 v6, 0x10000, v6
    v_add_u32 v7, 0x10000, v7
    v_add_u32 v8, 0x10000, v8
    v_mfma_f32_16x16x32_bf16 v[20:23], a[124:127], v[84:87], v[20:23]
    ds_read_b64_tr_b16 v[64:65], v4 offset:0
    buffer_load_dwordx2 v[232:233], v130, s[96:99], s66 offen nt
    s_add_u32 s66, s66, s67
    v_mfma_f32_16x16x32_bf16 v[24:27], a[120:123], v[88:91], v[24:27]
    ds_read_b64_tr_b16 v[66:67], v4 offset:1024
    buffer_load_dwordx2 v[234:235], v130, s[96:99], s66 offen nt
    s_add_u32 s66, s66, s67
    v_mfma_f32_16x16x32_bf16 v[28:31], a[124:127], v[88:91], v[28:31]
    ds_read_b64_tr_b16 v[68:69], v5 offset:0
    buffer_load_dwordx2 v[236:237], v130, s[96:99], s66 offen nt
    s_add_u32 s66, s66, s67
    v_mfma_f32_16x16x32_bf16 v[32:35], a[120:123], v[92:95], v[32:35]
    ds_read_b64_tr_b16 v[70:71], v5 offset:1024
    v_mfma_f32_16x16x32_bf16 v[36:39], a[124:127], v[92:95], v[36:39]
    buffer_load_dwordx2 v[238:239], v130, s[96:99], s66 offen nt
    s_add_u32 s66, s66, s68
    v_mfma_f32_16x16x32_bf16 v[40:43], a[120:123], v[96:99], v[40:43]
    ds_read_b64_tr_b16 v[72:73], v6 offset:0
    v_mfma_f32_16x16x32_bf16 v[44:47], a[124:127], v[96:99], v[44:47]
    ds_read_b64_tr_b16 v[74:75], v6 offset:1024
    v_mfma_f32_16x16x32_bf16 v[48:51], a[120:123], v[100:103], v[48:51]
    ds_read_b64_tr_b16 v[76:77], v7 offset:0
    v_mfma_f32_16x16x32_bf16 v[52:55], a[124:127], v[100:103], v[52:55]
    ds_read_b64_tr_b16 v[78:79], v7 offset:1024
    v_mfma_f32_16x16x32_bf16 v[56:59], a[120:123], a[120:123], v[56:59]
    ds_read_b64_tr_b16 v[80:81], v8 offset:0
    v_mfma_f32_16x16x32_bf16 v[60:63], a[124:127], a[124:127], v[60:63]
    ds_read_b64_tr_b16 v[82:83], v8 offset:1024
    s_cmp_lg_u32 s40, 3
    s_cbranch_scc1 cs_26
    v_mfma_f32_16x16x32_bf16 v[104:107], v[124:127], v[84:87], v[104:107]
    v_mfma_f32_16x16x32_bf16 v[108:111], v[124:127], v[88:91], v[108:111]
    v_mfma_f32_16x16x32_bf16 v[112:115], v[124:127], v[92:95], v[112:115]
    v_mfma_f32_16x16x32_bf16 v[116:119], v[124:127], v[96:99], v[116:119]
    v_mfma_f32_16x16x32_bf16 v[120:123], v[124:127], v[100:103], v[120:123]
cs_26:
    s_waitcnt lgkmcnt(0)
    v_mfma_f32_16x16x32_bf16 v[16:19], a[128:131], v[64:67], v[16:19]
    ds_read_b64_tr_b16 v[84:85], v4 offset:8192
    ds_read_b64_tr_b16 v[86:87], v4 offset:9216
    v_mfma_f32_16x16x32_bf16 v[20:23], a[132:135], v[64:67], v[20:23]
    ds_read_b64_tr_b16 v[88:89], v5 offset:8192
    buffer_load_dwordx2 v[240:241], v130, s[96:99], s66 offen nt
    s_add_u32 s66, s66, s67
    v_mfma_f32_16x16x32_bf16 v[24:27], a[128:131], v[68:71], v[24:27]
    ds_read_b64_tr_b16 v[90:91], v5 offset:9216
    v_mfma_f32_16x16x32_bf16 v[28:31], a[132:135], v[68:71], v[28:31]
    buffer_load_dwordx2 v[242:243], v130, s[96:99], s66 offen nt
    s_add_u32 s66, s66, s67
    v_mfma_f32_16x16x32_bf16 v[32:35], a[128:131], v[72:75], v[32:35]
    ds_read_b64_tr_b16 v[92:93], v6 offset:8192
    v_mfma_f32_16x16x32_bf16 v[36:39], a[132:135], v[72:75], v[36:39]
    buffer_load_dwordx2 v[244:245], v130, s[96:99], s66 offen nt
    s_add_u32 s66, s66, s67
    v_mfma_f32_16x16x32_bf16 v[40:43], a[128:131], v[76:79], v[40:43]
    ds_read_b64_tr_b16 v[94:95], v6 offset:9216
    v_mfma_f32_16x16x32_bf16 v[44:47], a[132:135], v[76:79], v[44:47]
    buffer_load_dwordx2 v[246:247], v130, s[96:99], s66 offen nt
    v_mfma_f32_16x16x32_bf16 v[48:51], a[128:131], v[80:83], v[48:51]
    ds_read_b64_tr_b16 v[96:97], v7 offset:8192
    v_mfma_f32_16x16x32_bf16 v[52:55], a[132:135], v[80:83], v[52:55]
    ds_read_b64_tr_b16 v[98:99], v7 offset:9216
    v_mfma_f32_16x16x32_bf16 v[56:59], a[128:131], a[128:131], v[56:59]
    ds_read_b64_tr_b16 v[100:101], v8 offset:8192
    v_mfma_f32_16x16x32_bf16 v[60:63], a[132:135], a[132:135], v[60:63]
    ds_read_b64_tr_b16 v[102:103], v8 offset:9216
    s_cmp_lg_u32 s40, 0
    s_cbranch_scc1 cs_27
    v_mfma_f32_16x16x32_bf16 v[104:107], v[124:127], v[64:67], v[104:107]
    v_mfma_f32_16x16x32_bf16 v[108:111], v[124:127], v[68:71], v[108:111]
    v_mfma_f32_16x16x32_bf16 v[112:115], v[124:127], v[72:75], v[112:115]
    v_mfma_f32_16x16x32_bf16 v[116:119], v[124:127], v[76:79], v[116:119]
    v_mfma_f32_16x16x32_bf16 v[120:123], v[124:127], v[80:83], v[120:123]
cs_27:
    s_waitcnt lgkmcnt(0)
    v_mfma_f32_16x16x32_bf16 v[16:19], a[136:139], v[84:87], v[16:19]
    v_mov_b32 v14, 0
    buffer_load_dword v14, v14, s[28:31], 0 offen sc1
    v_mfma_f32_16x16x32_bf16 v[20:23], a[140:143], v[84:87], v[20:23]
    v_mfma_f32_16x16x32_bf16 v[24:27], a[136:139], v[88:91], v[24:27]
    v_mfma_f32_16x16x32_bf16 v[28:31], a[140:143], v[88:91], v[28:31]
    v_mfma_f32_16x16x32_bf16 v[32:35], a[136:139], v[92:95], v[32:35]
    v_mfma_f32_16x16x32_bf16 v[36:39], a[140:143], v[92:95], v[36:39]
    v_mfma_f32_16x16x32_bf16 v[40:43], a[136:139], v[96:99], v[40:43]
    v_mfma_f32_16x16x32_bf16 v[44:47], a[140:143], v[96:99], v[44:47]
    v_mfma_f32_16x16x32_bf16 v[48:51], a[136:139], v[100:103], v[48:51]
    v_mfma_f32_16x16x32_bf16 v[52:55], a[140:143], v[100:103], v[52:55]
    v_mfma_f32_16x16x32_bf16 v[56:59], a[136:139], a[136:139], v[56:59]
    v_mfma_f32_16x16x32_bf16 v[60:63], a[140:143], a[140:143], v[60:63]
    s_cmp_lg_u32 s40, 1
    s_cbranch_scc1 cs_28
    v_mfma_f32_16x16x32_bf16 v[104:107], v[124:127], v[84:87], v[104:107]
    v_mfma_f32_16x16x32_bf16 v[108:111], v[124:127], v[88:91], v[108:111]
    v_mfma_f32_16x16x32_bf16 v[112:115], v[124:127], v[92:95], v[112:115]
    v_mfma_f32_16x16x32_bf16 v[116:119], v[124:127], v[96:99], v[116:119]
    v_mfma_f32_16x16x32_bf16 v[120:123], v[124:127], v[100:103], v[120:123]
cs_28:
    s_lshl_b32 s44, s40, 8
    s_add_u32 s44, s44, 159744
    v_lshl_add_u32 v132, v3, 4, s44
    v_lshl_add_u32 v133, v2, 2, s44
    s_lshl_b32 s44, s40, 2
    s_add_u32 s44, s44, 160768
    v_lshl_add_u32 v134, v2, 4, s44
    v_lshlrev_b32 v135, 4, v2
    v_add_u32 v135, 160768, v135
    s_mov_b32 exec_lo, 0x10001
    s_mov_b32 exec_hi, 0x10001
    ds_write_b128 v132, v[48:51] offset:0
    ds_write_b128 v132, v[52:55] offset:128
    s_mov_b32 exec_lo, 0x100001
    s_mov_b32 exec_hi, 0x10000100
    ds_write_b32 v133, v56 offset:64
    ds_write_b32 v133, v60 offset:192
    s_mov_b32 exec_lo, 0x200002
    s_mov_b32 exec_hi, 0x20000200
    ds_write_b32 v133, v57 offset:64
    ds_write_b32 v133, v61 offset:192
    s_mov_b32 exec_lo, 0x400004
    s_mov_b32 exec_hi, 0x40000400
    ds_write_b32 v133, v58 offset:64
    ds_write_b32 v133, v62 offset:192
    s_mov_b32 exec_lo, 0x800008
    s_mov_b32 exec_hi, 0x80000800
    ds_write_b32 v133, v59 offset:64
    ds_write_b32 v133, v63 offset:192
    s_mov_b32 exec_lo, 0xffff
    s_mov_b32 exec_hi, 0x0
    ds_write_b32 v134, v104 offset:0
    ds_write_b32 v134, v108 offset:256
    ds_write_b32 v134, v112 offset:512
    ds_write_b32 v134, v116 offset:768
    ds_write_b32 v134, v120 offset:1024
    s_mov_b64 exec, -1
    s_waitcnt lgkmcnt(0)
    s_barrier
    ds_read_b128 v[136:139], v132 offset:0
    ds_read_b128 v[140:143], v132 offset:64
    ds_read_b128 v[144:147], v132 offset:128
    ds_read_b128 v[148:151], v132 offset:192
    ds_read_b128 v[104:107], v135 offset:0
    ds_read_b128 v[108:111], v135 offset:256
    ds_read_b128 v[112:115], v135 offset:512
    ds_read_b128 v[116:119], v135 offset:768
    ds_read_b128 v[120:123], v135 offset:1024
    s_mov_b32 s78, 0xbae38e39
    s_mov_b32 s79, 0x3ae38e39
    s_mov_b32 s80, 0x3fb8aa3b
    s_mov_b32 s81, 0x358637bd
    v_mov_b32 v15, 0x3727c5ac
    s_waitcnt lgkmcnt(7)
    v_mul_f32 v136, s78, v136
    v_mul_f32 v137, s78, v137
    v_mul_f32 v138, s78, v138
    v_mul_f32 v139, s78, v139
    v_fma_f32 v140, v140, s79, v15
    v_fma_f32 v141, v141, s79, v15
    v_fma_f32 v142, v142, s79, v15
    v_fma_f32 v143, v143, s79, v15
    v_fma_f32 v140, -v136, v136, v140
    v_fma_f32 v141, -v137, v137, v141
    v_fma_f32 v142, -v138, v138, v142
    v_fma_f32 v143, -v139, v139, v143
    v_max_f32 v140, v140, v15
    v_max_f32 v141, v141, v15
    v_max_f32 v142, v142, v15
    v_max_f32 v143, v143, v15
    v_rsq_f32 v140, v140
    v_rsq_f32 v141, v141
    v_rsq_f32 v142, v142
    v_rsq_f32 v143, v143
    v_mul_f32 v152, s80, v140
    v_mul_f32 v153, s80, v141
    v_mul_f32 v154, s80, v142
    v_mul_f32 v155, s80, v143
    s_waitcnt lgkmcnt(5)
    v_mul_f32 v144, s78, v144
    v_mul_f32 v145, s78, v145
    v_mul_f32 v146, s78, v146
    v_mul_f32 v147, s78, v147
    v_fma_f32 v148, v148, s79, v15
    v_fma_f32 v149, v149, s79, v15
    v_fma_f32 v150, v150, s79, v15
    v_fma_f32 v151, v151, s79, v15
    v_fma_f32 v148, -v144, v144, v148
    v_fma_f32 v149, -v145, v145, v149
    v_fma_f32 v150, -v146, v146, v150
    v_fma_f32 v151, -v147, v147, v151
    v_max_f32 v148, v148, v15
    v_max_f32 v149, v149, v15
    v_max_f32 v150, v150, v15
    v_max_f32 v151, v151, v15
    v_rsq_f32 v148, v148
    v_rsq_f32 v149, v149
    v_rsq_f32 v150, v150
    v_rsq_f32 v151, v151
    v_mul_f32 v156, s80, v148
    v_mul_f32 v157, s80, v149
    v_mul_f32 v158, s80, v150
    v_mul_f32 v159, s80, v151
    s_waitcnt lgkmcnt(4)
    v_add_f32 v104, v104, v105
    v_add_f32 v106, v106, v107
    v_add_f32 v104, v104, v106
    s_waitcnt lgkmcnt(3)
    v_add_f32 v108, v108, v109
    v_add_f32 v110, v110, v111
    v_add_f32 v108, v108, v110
    s_waitcnt lgkmcnt(2)
    v_add_f32 v112, v112, v113
    v_add_f32 v114, v114, v115
    v_add_f32 v112, v112, v114
    s_waitcnt lgkmcnt(1)
    v_add_f32 v116, v116, v117
    v_add_f32 v118, v118, v119
    v_add_f32 v116, v116, v118
    s_waitcnt lgkmcnt(0)
    v_add_f32 v120, v120, v121
    v_add_f32 v122, v122, v123
    v_add_f32 v120, v120, v122
    s_mov_b32 s76, 0xf000f000
    s_mov_b32 s77, 0xf000f000
    v_fma_f32 v16, v136, v104, v16
    v_fma_f32 v17, v137, v104, v17
    v_fma_f32 v18, v138, v104, v18
    v_fma_f32 v19, v139, v104, v19
    v_mul_f32 v64, v16, v152
    v_mul_f32 v65, v17, v153
    v_mul_f32 v66, v18, v154
    v_mul_f32 v67, v19, v155
    v_exp_f32 v64, v64 clamp
    v_exp_f32 v65, v65 clamp
    v_exp_f32 v66, v66 clamp
    v_exp_f32 v67, v67 clamp
    v_fma_f32 v16, v16, v140, s81
    v_fma_f32 v17, v17, v141, s81
    v_fma_f32 v18, v18, v142, s81
    v_fma_f32 v19, v19, v143, s81
    v_max_f32 v16, s81, v16
    v_max_f32 v17, s81, v17
    v_max_f32 v18, s81, v18
    v_max_f32 v19, s81, v19
    v_add_f32 v16, v16, v64
    v_add_f32 v17, v17, v65
    v_add_f32 v18, v18, v66
    v_add_f32 v19, v19, v67
    v_cvt_pk_bf16_f32 v160, v16, v17
    v_cvt_pk_bf16_f32 v161, v18, v19
    v_fma_f32 v20, v144, v104, v20
    v_fma_f32 v21, v145, v104, v21
    v_fma_f32 v22, v146, v104, v22
    v_fma_f32 v23, v147, v104, v23
    v_mul_f32 v64, v20, v156
    v_mul_f32 v65, v21, v157
    v_mul_f32 v66, v22, v158
    v_mul_f32 v67, v23, v159
    v_exp_f32 v64, v64 clamp
    v_exp_f32 v65, v65 clamp
    v_exp_f32 v66, v66 clamp
    v_exp_f32 v67, v67 clamp
    v_fma_f32 v20, v20, v148, s81
    v_fma_f32 v21, v21, v149, s81
    v_fma_f32 v22, v22, v150, s81
    v_fma_f32 v23, v23, v151, s81
    v_max_f32 v20, s81, v20
    v_max_f32 v21, s81, v21
    v_max_f32 v22, s81, v22
    v_max_f32 v23, s81, v23
    v_add_f32 v20, v20, v64
    v_add_f32 v21, v21, v65
    v_add_f32 v22, v22, v66
    v_add_f32 v23, v23, v67
    v_cvt_pk_bf16_f32 v162, v20, v21
    v_cvt_pk_bf16_f32 v163, v22, v23
    v_fma_f32 v32, v136, v112, v32
    v_fma_f32 v33, v137, v112, v33
    v_fma_f32 v34, v138, v112, v34
    v_fma_f32 v35, v139, v112, v35
    v_mul_f32 v32, v32, v140
    v_mul_f32 v33, v33, v141
    v_mul_f32 v34, v34, v142
    v_mul_f32 v35, v35, v143
    v_cvt_pk_bf16_f32 v168, v32, v33
    v_cvt_pk_bf16_f32 v169, v34, v35
    v_fma_f32 v36, v144, v112, v36
    v_fma_f32 v37, v145, v112, v37
    v_fma_f32 v38, v146, v112, v38
    v_fma_f32 v39, v147, v112, v39
    v_mul_f32 v36, v36, v148
    v_mul_f32 v37, v37, v149
    v_mul_f32 v38, v38, v150
    v_mul_f32 v39, v39, v151
    v_cvt_pk_bf16_f32 v170, v36, v37
    v_cvt_pk_bf16_f32 v171, v38, v39
    s_nop 1
    v_mfma_f32_16x16x32_bf16 v[16:19], v[160:163], v[168:171], 0
    v_fma_f32 v24, v136, v108, v24
    v_fma_f32 v25, v137, v108, v25
    v_fma_f32 v26, v138, v108, v26
    v_fma_f32 v27, v139, v108, v27
    v_mul_f32 v64, v24, v152
    v_mul_f32 v65, v25, v153
    v_mul_f32 v66, v26, v154
    v_mul_f32 v67, v27, v155
    v_exp_f32 v64, v64 clamp
    v_exp_f32 v65, v65 clamp
    v_exp_f32 v66, v66 clamp
    v_exp_f32 v67, v67 clamp
    v_fma_f32 v24, v24, v140, s81
    v_fma_f32 v25, v25, v141, s81
    v_fma_f32 v26, v26, v142, s81
    v_fma_f32 v27, v27, v143, s81
    v_max_f32 v24, s81, v24
    v_max_f32 v25, s81, v25
    v_max_f32 v26, s81, v26
    v_max_f32 v27, s81, v27
    v_add_f32 v24, v24, v64
    v_add_f32 v25, v25, v65
    v_add_f32 v26, v26, v66
    v_add_f32 v27, v27, v67
    v_cvt_pk_bf16_f32 v164, v24, v25
    v_cvt_pk_bf16_f32 v165, v26, v27
    v_fma_f32 v28, v144, v108, v28
    v_fma_f32 v29, v145, v108, v29
    v_fma_f32 v30, v146, v108, v30
    v_fma_f32 v31, v147, v108, v31
    v_mul_f32 v64, v28, v156
    v_mul_f32 v65, v29, v157
    v_mul_f32 v66, v30, v158
    v_mul_f32 v67, v31, v159
    v_exp_f32 v64, v64 clamp
    v_exp_f32 v65, v65 clamp
    v_exp_f32 v66, v66 clamp
    v_exp_f32 v67, v67 clamp
    v_fma_f32 v28, v28, v148, s81
    v_fma_f32 v29, v29, v149, s81
    v_fma_f32 v30, v30, v150, s81
    v_fma_f32 v31, v31, v151, s81
    v_max_f32 v28, s81, v28
    v_max_f32 v29, s81, v29
    v_max_f32 v30, s81, v30
    v_max_f32 v31, s81, v31
    v_add_f32 v28, v28, v64
    v_add_f32 v29, v29, v65
    v_add_f32 v30, v30, v66
    v_add_f32 v31, v31, v67
    v_cvt_pk_bf16_f32 v166, v28, v29
    v_cvt_pk_bf16_f32 v167, v30, v31
    v_fma_f32 v40, v136, v116, v40
    v_fma_f32 v41, v137, v116, v41
    v_fma_f32 v42, v138, v116, v42
    v_fma_f32 v43, v139, v116, v43
    v_mul_f32 v40, v40, v140
    v_mul_f32 v41, v41, v141
    v_mul_f32 v42, v42, v142
    v_mul_f32 v43, v43, v143
    v_cvt_pk_bf16_f32 v172, v40, v41
    v_cvt_pk_bf16_f32 v173, v42, v43
    v_fma_f32 v44, v144, v116, v44
    v_fma_f32 v45, v145, v116, v45
    v_fma_f32 v46, v146, v116, v46
    v_fma_f32 v47, v147, v116, v47
    v_mul_f32 v44, v44, v148
    v_mul_f32 v45, v45, v149
    v_mul_f32 v46, v46, v150
    v_mul_f32 v47, v47, v151
    v_cvt_pk_bf16_f32 v174, v44, v45
    v_cvt_pk_bf16_f32 v175, v46, v47
    s_nop 1
    v_mfma_f32_16x16x32_bf16 v[20:23], v[164:167], v[172:175], 0
    v_fma_f32 v48, v136, v120, v48
    v_fma_f32 v49, v137, v120, v49
    v_fma_f32 v50, v138, v120, v50
    v_fma_f32 v51, v139, v120, v51
    v_mul_f32 v64, v48, v152
    v_mul_f32 v65, v49, v153
    v_mul_f32 v66, v50, v154
    v_mul_f32 v67, v51, v155
    v_mul_f32 v68, v48, v140
    v_mul_f32 v69, v49, v141
    v_mul_f32 v70, v50, v142
    v_mul_f32 v71, v51, v143
    v_exp_f32 v64, v64 clamp
    v_exp_f32 v65, v65 clamp
    v_exp_f32 v66, v66 clamp
    v_exp_f32 v67, v67 clamp
    v_fma_f32 v48, v48, v140, s81
    v_fma_f32 v49, v49, v141, s81
    v_fma_f32 v50, v50, v142, s81
    v_fma_f32 v51, v51, v143, s81
    v_max_f32 v48, s81, v48
    v_max_f32 v49, s81, v49
    v_max_f32 v50, s81, v50
    v_max_f32 v51, s81, v51
    v_add_f32 v48, v48, v64
    v_add_f32 v49, v49, v65
    v_add_f32 v50, v50, v66
    v_add_f32 v51, v51, v67
    v_cndmask_b32 v48, v48, v68, s[76:77]
    v_cndmask_b32 v49, v49, v69, s[76:77]
    v_cndmask_b32 v50, v50, v70, s[76:77]
    v_cndmask_b32 v51, v51, v71, s[76:77]
    v_cvt_pk_bf16_f32 v176, v48, v49
    v_cvt_pk_bf16_f32 v177, v50, v51
    v_fma_f32 v52, v144, v120, v52
    v_fma_f32 v53, v145, v120, v53
    v_fma_f32 v54, v146, v120, v54
    v_fma_f32 v55, v147, v120, v55
    v_mul_f32 v64, v52, v156
    v_mul_f32 v65, v53, v157
    v_mul_f32 v66, v54, v158
    v_mul_f32 v67, v55, v159
    v_mul_f32 v68, v52, v148
    v_mul_f32 v69, v53, v149
    v_mul_f32 v70, v54, v150
    v_mul_f32 v71, v55, v151
    v_exp_f32 v64, v64 clamp
    v_exp_f32 v65, v65 clamp
    v_exp_f32 v66, v66 clamp
    v_exp_f32 v67, v67 clamp
    v_fma_f32 v52, v52, v148, s81
    v_fma_f32 v53, v53, v149, s81
    v_fma_f32 v54, v54, v150, s81
    v_fma_f32 v55, v55, v151, s81
    v_max_f32 v52, s81, v52
    v_max_f32 v53, s81, v53
    v_max_f32 v54, s81, v54
    v_max_f32 v55, s81, v55
    v_add_f32 v52, v52, v64
    v_add_f32 v53, v53, v65
    v_add_f32 v54, v54, v66
    v_add_f32 v55, v55, v67
    v_cndmask_b32 v52, v52, v68, s[76:77]
    v_cndmask_b32 v53, v53, v69, s[76:77]
    v_cndmask_b32 v54, v54, v70, s[76:77]
    v_cndmask_b32 v55, v55, v71, s[76:77]
    v_cvt_pk_bf16_f32 v178, v52, v53
    v_cvt_pk_bf16_f32 v179, v54, v55
    v_and_or_b32 v72, v176, v249, v248
    v_and_or_b32 v73, v177, v249, v248
    v_and_or_b32 v74, v178, v249, v248
    v_and_or_b32 v75, v179, v249, v248
    v_and_b32 v80, v176, v252
    v_and_b32 v81, v177, v252
    v_and_b32 v82, v178, v252
    v_and_b32 v83, v179, v252
    v_mfma_f32_16x16x32_bf16 v[24:27], v[160:163], v[72:75], 0
    v_and_or_b32 v76, v176, v251, v250
    v_and_or_b32 v77, v177, v251, v250
    v_and_or_b32 v78, v178, v251, v250
    v_and_or_b32 v79, v179, v251, v250
    v_mfma_f32_16x16x32_bf16 v[28:31], v[80:83], v[168:171], 0
    v_and_b32 v84, v176, v253
    v_and_b32 v85, v177, v253
    v_and_b32 v86, v178, v253
    v_and_b32 v87, v179, v253
    v_mfma_f32_16x16x32_bf16 v[24:27], v[164:167], v[76:79], v[24:27]
    v_and_b32 v88, v176, v254
    v_and_b32 v89, v177, v254
    v_and_b32 v90, v178, v254
    v_and_b32 v91, v179, v254
    v_mfma_f32_16x16x32_bf16 v[28:31], v[84:87], v[172:175], v[28:31]
    v_and_b32 v92, v176, v131
    v_and_b32 v93, v177, v131
    v_and_b32 v94, v178, v131
    v_and_b32 v95, v179, v131
    v_mfma_f32_16x16x32_bf16 v[28:31], v[88:91], v[72:75], v[28:31]
    s_nop 0
    v_mfma_f32_16x16x32_bf16 v[28:31], v[92:95], v[76:79], v[28:31]
    v_add_u32 v134, 147456, v1
kv_30:
    s_cmp_lg_u32 s40, 0
    s_cbranch_scc1 kv_31
    ds_write_b128 v134, v[20:23] offset:5120
    ds_write_b128 v134, v[24:27] offset:7168
    s_nop 2
    ds_write_b128 v134, v[28:31] offset:9216
    v_mov_b32 v32, v16
    v_mov_b32 v33, v17
    v_mov_b32 v34, v18
    v_mov_b32 v35, v19
    s_branch kvd_29
kv_31:
    s_cmp_lg_u32 s40, 1
    s_cbranch_scc1 kv_32
    ds_write_b128 v134, v[16:19] offset:0
    ds_write_b128 v134, v[24:27] offset:8192
    s_nop 0
    ds_write_b128 v134, v[28:31] offset:10240
    v_mov_b32 v32, v20
    v_mov_b32 v33, v21
    v_mov_b32 v34, v22
    v_mov_b32 v35, v23
    s_branch kvd_29
kv_32:
    s_cmp_lg_u32 s40, 2
    s_cbranch_scc1 kv_33
    ds_write_b128 v134, v[16:19] offset:1024
    ds_write_b128 v134, v[20:23] offset:3072
    ds_write_b128 v134, v[28:31] offset:11264
    v_mov_b32 v32, v24
    v_mov_b32 v33, v25
    v_mov_b32 v34, v26
    v_mov_b32 v35, v27
    s_branch kvd_29
kv_33:
    ds_write_b128 v134, v[16:19] offset:2048
    ds_write_b128 v134, v[20:23] offset:4096
    ds_write_b128 v134, v[24:27] offset:6144
    v_mov_b32 v32, v28
    v_mov_b32 v33, v29
    v_mov_b32 v34, v30
    v_mov_b32 v35, v31
kvd_29:
    s_mul_i32 s44, s40, 3072
    v_add_u32 v134, s44, v134
    s_waitcnt lgkmcnt(0)
    s_barrier
    ds_read_b128 v[16:19], v134 offset:0
    ds_read_b128 v[20:23], v134 offset:1024
    ds_read_b128 v[24:27], v134 offset:2048
    s_lshl_b32 s44, s42, 4
    s_add_u32 s44, s44, s41
    s_lshl_b32 s44, s44, 2
    s_add_u32 s44, s44, s40
    s_lshl_b32 s44, s44, 10
    s_add_u32 s44, s44, 65536
    s_waitcnt lgkmcnt(2)
    v_add_f32 v32, v32, v16
    v_add_f32 v33, v33, v17
    v_add_f32 v34, v34, v18
    v_add_f32 v35, v35, v19
    s_waitcnt lgkmcnt(1)
    v_add_f32 v32, v32, v20
    v_add_f32 v33, v33, v21
    v_add_f32 v34, v34, v22
    v_add_f32 v35, v35, v23
    s_waitcnt lgkmcnt(0)
    v_add_f32 v32, v32, v24
    v_add_f32 v33, v33, v25
    v_add_f32 v34, v34, v26
    v_add_f32 v35, v35, v27
    buffer_store_dwordx4 v[32:35], v1, s[4:7], s44 offen sc1
    ds_read_b64_tr_b16 v[64:65], v9 offset:0
    ds_read_b64_tr_b16 v[66:67], v9 offset:1024
    ds_read_b64_tr_b16 v[68:69], v10 offset:0
    ds_read_b64_tr_b16 v[70:71], v10 offset:1024
    ds_read_b64_tr_b16 v[72:73], v11 offset:0
    ds_read_b64_tr_b16 v[74:75], v11 offset:1024
    s_lshr_b32 s44, s39, 3
    s_lshl_b32 s84, s38, 2
    s_add_u32 s84, s84, s44
    s_and_b32 s85, s39, 7
    v_mov_b32 v6, 0
    s_and_b32 s94, s38, 6
    s_and_b32 s44, s39, 1
    s_add_u32 s94, s94, s44
    s_and_b32 s95, s38, 1
    s_lshl_b32 s95, s95, 4
    s_lshr_b32 s44, s39, 1
    s_add_u32 s95, s95, s44
    s_lshl_b32 s47, s42, 8
    s_lshl_b32 s44, s40, 6
    s_add_u32 s47, s47, s44
    s_lshl_b32 s44, s41, 2
    s_add_u32 s48, s47, s44
    s_waitcnt lgkmcnt(0)
    v_mfma_f32_16x16x32_bf16 v[16:19], v[64:67], a[0:3], 0
    ds_read_b64_tr_b16 v[76:77], v9 offset:8192
    v_mfma_f32_16x16x32_bf16 v[20:23], v[64:67], a[4:7], 0
    ds_read_b64_tr_b16 v[78:79], v9 offset:9216
    v_mfma_f32_16x16x32_bf16 v[40:43], v[64:67], v[124:127], 0
    ds_read_b64_tr_b16 v[80:81], v10 offset:8192
    v_mfma_f32_16x16x32_bf16 v[24:27], v[68:71], a[0:3], 0
    ds_read_b64_tr_b16 v[82:83], v10 offset:9216
    v_mfma_f32_16x16x32_bf16 v[28:31], v[68:71], a[4:7], 0
    ds_read_b64_tr_b16 v[84:85], v11 offset:8192
    v_mfma_f32_16x16x32_bf16 v[44:47], v[68:71], v[124:127], 0
    ds_read_b64_tr_b16 v[86:87], v11 offset:9216
    v_mfma_f32_16x16x32_bf16 v[32:35], v[72:75], a[0:3], 0
    v_mfma_f32_16x16x32_bf16 v[36:39], v[72:75], a[4:7], 0
    v_mfma_f32_16x16x32_bf16 v[48:51], v[72:75], v[124:127], 0
    s_waitcnt lgkmcnt(0)
    v_mfma_f32_16x16x32_bf16 v[16:19], v[76:79], a[8:11], v[16:19]
    ds_read_b64_tr_b16 v[64:65], v9 offset:16384
    v_mfma_f32_16x16x32_bf16 v[20:23], v[76:79], a[12:15], v[20:23]
    ds_read_b64_tr_b16 v[66:67], v9 offset:17408
    v_mfma_f32_16x16x32_bf16 v[40:43], v[76:79], v[124:127], v[40:43]
    ds_read_b64_tr_b16 v[68:69], v10 offset:16384
    v_mfma_f32_16x16x32_bf16 v[24:27], v[80:83], a[8:11], v[24:27]
    ds_read_b64_tr_b16 v[70:71], v10 offset:17408
    v_mfma_f32_16x16x32_bf16 v[28:31], v[80:83], a[12:15], v[28:31]
    ds_read_b64_tr_b16 v[72:73], v11 offset:16384
    v_mfma_f32_16x16x32_bf16 v[44:47], v[80:83], v[124:127], v[44:47]
    ds_read_b64_tr_b16 v[74:75], v11 offset:17408
    v_mfma_f32_16x16x32_bf16 v[32:35], v[84:87], a[8:11], v[32:35]
    v_mfma_f32_16x16x32_bf16 v[36:39], v[84:87], a[12:15], v[36:39]
    v_mfma_f32_16x16x32_bf16 v[48:51], v[84:87], v[124:127], v[48:51]
    s_waitcnt lgkmcnt(0)
    v_mfma_f32_16x16x32_bf16 v[16:19], v[64:67], a[16:19], v[16:19]
    ds_read_b64_tr_b16 v[76:77], v9 offset:24576
    v_mfma_f32_16x16x32_bf16 v[20:23], v[64:67], a[20:23], v[20:23]
    ds_read_b64_tr_b16 v[78:79], v9 offset:25600
    v_mfma_f32_16x16x32_bf16 v[40:43], v[64:67], v[124:127], v[40:43]
    ds_read_b64_tr_b16 v[80:81], v10 offset:24576
    v_mfma_f32_16x16x32_bf16 v[24:27], v[68:71], a[16:19], v[24:27]
    ds_read_b64_tr_b16 v[82:83], v10 offset:25600
    v_mfma_f32_16x16x32_bf16 v[28:31], v[68:71], a[20:23], v[28:31]
    ds_read_b64_tr_b16 v[84:85], v11 offset:24576
    v_mfma_f32_16x16x32_bf16 v[44:47], v[68:71], v[124:127], v[44:47]
    ds_read_b64_tr_b16 v[86:87], v11 offset:25600
    v_mfma_f32_16x16x32_bf16 v[32:35], v[72:75], a[16:19], v[32:35]
    v_mfma_f32_16x16x32_bf16 v[36:39], v[72:75], a[20:23], v[36:39]
    v_mfma_f32_16x16x32_bf16 v[48:51], v[72:75], v[124:127], v[48:51]
    s_waitcnt lgkmcnt(0)
    v_mfma_f32_16x16x32_bf16 v[16:19], v[76:79], a[24:27], v[16:19]
    ds_read_b64_tr_b16 v[64:65], v9 offset:32768
    v_mfma_f32_16x16x32_bf16 v[20:23], v[76:79], a[28:31], v[20:23]
    ds_read_b64_tr_b16 v[66:67], v9 offset:33792
    v_mfma_f32_16x16x32_bf16 v[40:43], v[76:79], v[124:127], v[40:43]
    ds_read_b64_tr_b16 v[68:69], v10 offset:32768
    v_mfma_f32_16x16x32_bf16 v[24:27], v[80:83], a[24:27], v[24:27]
    ds_read_b64_tr_b16 v[70:71], v10 offset:33792
    v_mfma_f32_16x16x32_bf16 v[28:31], v[80:83], a[28:31], v[28:31]
    ds_read_b64_tr_b16 v[72:73], v11 offset:32768
    v_mfma_f32_16x16x32_bf16 v[44:47], v[80:83], v[124:127], v[44:47]
    ds_read_b64_tr_b16 v[74:75], v11 offset:33792
    v_mfma_f32_16x16x32_bf16 v[32:35], v[84:87], a[24:27], v[32:35]
    s_waitcnt vmcnt(0)
    v_cmp_ne_u32 vcc, 1, v14
    s_cbranch_vccz ok_34
    s_mov_b32 s52, 0
poll_35:
    buffer_load_dword v14, v6, s[28:31], 0 offen sc1
    s_waitcnt vmcnt(0)
    v_cmp_ne_u32 vcc, 1, v14
    s_cbranch_vccz pdone_36
    s_add_u32 s52, s52, 1
    s_cmp_lt_u32 s52, 20000
    s_cbranch_scc1 poll_35
pdone_36:
ok_34:
    v_mov_b32 v14, 1
    s_mov_b64 exec, 1
    buffer_store_dword v14, v6, s[4:7], s48 offen sc1
    s_mov_b64 exec, -1
    v_mfma_f32_16x16x32_bf16 v[36:39], v[84:87], a[28:31], v[36:39]
    v_mfma_f32_16x16x32_bf16 v[48:51], v[84:87], v[124:127], v[48:51]
    s_waitcnt lgkmcnt(0)
    v_mfma_f32_16x16x32_bf16 v[16:19], v[64:67], a[32:35], v[16:19]
    ds_read_b64_tr_b16 v[76:77], v9 offset:40960
    v_mfma_f32_16x16x32_bf16 v[20:23], v[64:67], a[36:39], v[20:23]
    ds_read_b64_tr_b16 v[78:79], v9 offset:41984
    v_mfma_f32_16x16x32_bf16 v[40:43], v[64:67], v[124:127], v[40:43]
    ds_read_b64_tr_b16 v[80:81], v10 offset:40960
    v_mfma_f32_16x16x32_bf16 v[24:27], v[68:71], a[32:35], v[24:27]
    ds_read_b64_tr_b16 v[82:83], v10 offset:41984
    v_mfma_f32_16x16x32_bf16 v[28:31], v[68:71], a[36:39], v[28:31]
    ds_read_b64_tr_b16 v[84:85], v11 offset:40960
    v_mfma_f32_16x16x32_bf16 v[44:47], v[68:71], v[124:127], v[44:47]
    ds_read_b64_tr_b16 v[86:87], v11 offset:41984
    v_mfma_f32_16x16x32_bf16 v[32:35], v[72:75], a[32:35], v[32:35]
    v_perm_b32 v176, v202, v200, s74
    v_mfma_f32_16x16x32_bf16 v[36:39], v[72:75], a[36:39], v[36:39]
    v_perm_b32 v177, v206, v204, s74
    v_mfma_f32_16x16x32_bf16 v[48:51], v[72:75], v[124:127], v[48:51]
    v_perm_b32 v178, v210, v208, s74
    v_perm_b32 v179, v214, v212, s74
    buffer_store_dwordx4 v[176:179], v1, s[4:7], s59 offen sc1
    s_add_u32 s59, s59, s60
    v_perm_b32 v180, v202, v200, s75
    v_perm_b32 v181, v206, v204, s75
    v_perm_b32 v182, v210, v208, s75
    s_waitcnt lgkmcnt(0)
    v_mfma_f32_16x16x32_bf16 v[16:19], v[76:79], a[40:43], v[16:19]
    ds_read_b64_tr_b16 v[64:65], v9 offset:49152
    v_mfma_f32_16x16x32_bf16 v[20:23], v[76:79], a[44:47], v[20:23]
    ds_read_b64_tr_b16 v[66:67], v9 offset:50176
    v_mfma_f32_16x16x32_bf16 v[40:43], v[76:79], v[124:127], v[40:43]
    ds_read_b64_tr_b16 v[68:69], v10 offset:49152
    v_mfma_f32_16x16x32_bf16 v[24:27], v[80:83], a[40:43], v[24:27]
    ds_read_b64_tr_b16 v[70:71], v10 offset:50176
    v_mfma_f32_16x16x32_bf16 v[28:31], v[80:83], a[44:47], v[28:31]
    ds_read_b64_tr_b16 v[72:73], v11 offset:49152
    v_mfma_f32_16x16x32_bf16 v[44:47], v[80:83], v[124:127], v[44:47]
    ds_read_b64_tr_b16 v[74:75], v11 offset:50176
    v_mfma_f32_16x16x32_bf16 v[32:35], v[84:87], a[40:43], v[32:35]
    v_perm_b32 v183, v214, v212, s75
    v_mfma_f32_16x16x32_bf16 v[36:39], v[84:87], a[44:47], v[36:39]
    buffer_store_dwordx4 v[180:183], v1, s[4:7], s59 offen sc1
    s_add_u32 s59, s59, s60
    v_mfma_f32_16x16x32_bf16 v[48:51], v[84:87], v[124:127], v[48:51]
    v_perm_b32 v184, v203, v201, s74
    v_perm_b32 v185, v207, v205, s74
    v_perm_b32 v186, v211, v209, s74
    v_perm_b32 v187, v215, v213, s74
    buffer_store_dwordx4 v[184:187], v1, s[4:7], s59 offen sc1
    s_add_u32 s59, s59, s60
    v_perm_b32 v188, v203, v201, s75
    s_waitcnt lgkmcnt(0)
    v_mfma_f32_16x16x32_bf16 v[16:19], v[64:67], a[48:51], v[16:19]
    ds_read_b64_tr_b16 v[76:77], v9 offset:57344
    v_mfma_f32_16x16x32_bf16 v[20:23], v[64:67], a[52:55], v[20:23]
    ds_read_b64_tr_b16 v[78:79], v9 offset:58368
    v_mfma_f32_16x16x32_bf16 v[40:43], v[64:67], v[124:127], v[40:43]
    ds_read_b64_tr_b16 v[80:81], v10 offset:57344
    v_mfma_f32_16x16x32_bf16 v[24:27], v[68:71], a[48:51], v[24:27]
    ds_read_b64_tr_b16 v[82:83], v10 offset:58368
    v_mfma_f32_16x16x32_bf16 v[28:31], v[68:71], a[52:55], v[28:31]
    ds_read_b64_tr_b16 v[84:85], v11 offset:57344
    v_mfma_f32_16x16x32_bf16 v[44:47], v[68:71], v[124:127], v[44:47]
    ds_read_b64_tr_b16 v[86:87], v11 offset:58368
    v_mfma_f32_16x16x32_bf16 v[32:35], v[72:75], a[48:51], v[32:35]
    v_perm_b32 v189, v207, v205, s75
    v_mfma_f32_16x16x32_bf16 v[36:39], v[72:75], a[52:55], v[36:39]
    v_perm_b32 v190, v211, v209, s75
    v_mfma_f32_16x16x32_bf16 v[48:51], v[72:75], v[124:127], v[48:51]
    v_perm_b32 v191, v215, v213, s75
    buffer_store_dwordx4 v[188:191], v1, s[4:7], s59 offen sc1
    s_add_u32 s59, s59, s60
    v_perm_b32 v176, v218, v216, s74
    v_perm_b32 v177, v222, v220, s74
    v_perm_b32 v178, v226, v224, s74
    v_perm_b32 v179, v230, v228, s74
    s_waitcnt lgkmcnt(0)
    v_mfma_f32_16x16x32_bf16 v[16:19], v[76:79], a[56:59], v[16:19]
    v_add_u32 v9, 0x10000, v9
    v_add_u32 v10, 0x10000, v10
    v_add_u32 v11, 0x10000, v11
    v_mfma_f32_16x16x32_bf16 v[20:23], v[76:79], a[60:63], v[20:23]
    ds_read_b64_tr_b16 v[64:65], v9 offset:0
    v_mfma_f32_16x16x32_bf16 v[40:43], v[76:79], v[124:127], v[40:43]
    ds_read_b64_tr_b16 v[66:67], v9 offset:1024
    v_mfma_f32_16x16x32_bf16 v[24:27], v[80:83], a[56:59], v[24:27]
    ds_read_b64_tr_b16 v[68:69], v10 offset:0
    v_mfma_f32_16x16x32_bf16 v[28:31], v[80:83], a[60:63], v[28:31]
    ds_read_b64_tr_b16 v[70:71], v10 offset:1024
    v_mfma_f32_16x16x32_bf16 v[44:47], v[80:83], v[124:127], v[44:47]
    ds_read_b64_tr_b16 v[72:73], v11 offset:0
    v_mfma_f32_16x16x32_bf16 v[32:35], v[84:87], a[56:59], v[32:35]
    ds_read_b64_tr_b16 v[74:75], v11 offset:1024
    v_mfma_f32_16x16x32_bf16 v[36:39], v[84:87], a[60:63], v[36:39]
    buffer_store_dwordx4 v[176:179], v1, s[4:7], s64 offen sc1
    s_add_u32 s64, s64, s65
    v_mfma_f32_16x16x32_bf16 v[48:51], v[84:87], v[124:127], v[48:51]
    v_perm_b32 v180, v218, v216, s75
    v_perm_b32 v181, v222, v220, s75
    v_perm_b32 v182, v226, v224, s75
    v_perm_b32 v183, v230, v228, s75
    buffer_store_dwordx4 v[180:183], v1, s[4:7], s64 offen sc1
    s_add_u32 s64, s64, s65
    v_perm_b32 v184, v219, v217, s74
    v_perm_b32 v185, v223, v221, s74
    s_waitcnt lgkmcnt(0)
    v_mfma_f32_16x16x32_bf16 v[16:19], v[64:67], a[64:67], v[16:19]
    ds_read_b64_tr_b16 v[76:77], v9 offset:8192
    v_mfma_f32_16x16x32_bf16 v[20:23], v[64:67], a[68:71], v[20:23]
    ds_read_b64_tr_b16 v[78:79], v9 offset:9216
    v_mfma_f32_16x16x32_bf16 v[40:43], v[64:67], v[124:127], v[40:43]
    ds_read_b64_tr_b16 v[80:81], v10 offset:8192
    v_mfma_f32_16x16x32_bf16 v[24:27], v[68:71], a[64:67], v[24:27]
    ds_read_b64_tr_b16 v[82:83], v10 offset:9216
    v_mfma_f32_16x16x32_bf16 v[28:31], v[68:71], a[68:71], v[28:31]
    ds_read_b64_tr_b16 v[84:85], v11 offset:8192
    v_mfma_f32_16x16x32_bf16 v[44:47], v[68:71], v[124:127], v[44:47]
    ds_read_b64_tr_b16 v[86:87], v11 offset:9216
    v_mfma_f32_16x16x32_bf16 v[32:35], v[72:75], a[64:67], v[32:35]
    v_perm_b32 v186, v227, v225, s74
    v_mfma_f32_16x16x32_bf16 v[36:39], v[72:75], a[68:71], v[36:39]
    v_perm_b32 v187, v231, v229, s74
    v_mfma_f32_16x16x32_bf16 v[48:51], v[72:75], v[124:127], v[48:51]
    buffer_store_dwordx4 v[184:187], v1, s[4:7], s64 offen sc1
    s_add_u32 s64, s64, s65
    v_perm_b32 v188, v219, v217, s75
    v_perm_b32 v189, v223, v221, s75
    v_perm_b32 v190, v227, v225, s75
    v_perm_b32 v191, v231, v229, s75
    buffer_store_dwordx4 v[188:191], v1, s[4:7], s64 offen sc1
    s_add_u32 s64, s64, s65
    s_waitcnt lgkmcnt(0)
    v_mfma_f32_16x16x32_bf16 v[16:19], v[76:79], a[72:75], v[16:19]
    ds_read_b64_tr_b16 v[64:65], v9 offset:16384
    v_mfma_f32_16x16x32_bf16 v[20:23], v[76:79], a[76:79], v[20:23]
    ds_read_b64_tr_b16 v[66:67], v9 offset:17408
    v_mfma_f32_16x16x32_bf16 v[40:43], v[76:79], v[124:127], v[40:43]
    ds_read_b64_tr_b16 v[68:69], v10 offset:16384
    v_mfma_f32_16x16x32_bf16 v[24:27], v[80:83], a[72:75], v[24:27]
    ds_read_b64_tr_b16 v[70:71], v10 offset:17408
    v_mfma_f32_16x16x32_bf16 v[28:31], v[80:83], a[76:79], v[28:31]
    ds_read_b64_tr_b16 v[72:73], v11 offset:16384
    v_mfma_f32_16x16x32_bf16 v[44:47], v[80:83], v[124:127], v[44:47]
    ds_read_b64_tr_b16 v[74:75], v11 offset:17408
    v_mfma_f32_16x16x32_bf16 v[32:35], v[84:87], a[72:75], v[32:35]
    v_perm_b32 v176, v234, v232, s74
    v_mfma_f32_16x16x32_bf16 v[36:39], v[84:87], a[76:79], v[36:39]
    v_perm_b32 v177, v238, v236, s74
    v_mfma_f32_16x16x32_bf16 v[48:51], v[84:87], v[124:127], v[48:51]
    v_perm_b32 v178, v242, v240, s74
    v_perm_b32 v179, v246, v244, s74
    buffer_store_dwordx4 v[176:179], v1, s[4:7], s69 offen sc1
    s_add_u32 s69, s69, s70
    v_perm_b32 v180, v234, v232, s75
    v_perm_b32 v181, v238, v236, s75
    v_perm_b32 v182, v242, v240, s75
    s_waitcnt lgkmcnt(0)
    v_mfma_f32_16x16x32_bf16 v[16:19], v[64:67], a[80:83], v[16:19]
    ds_read_b64_tr_b16 v[76:77], v9 offset:24576
    v_mfma_f32_16x16x32_bf16 v[20:23], v[64:67], a[84:87], v[20:23]
    ds_read_b64_tr_b16 v[78:79], v9 offset:25600
    v_mfma_f32_16x16x32_bf16 v[40:43], v[64:67], v[124:127], v[40:43]
    ds_read_b64_tr_b16 v[80:81], v10 offset:24576
    v_mfma_f32_16x16x32_bf16 v[24:27], v[68:71], a[80:83], v[24:27]
    ds_read_b64_tr_b16 v[82:83], v10 offset:25600
    v_mfma_f32_16x16x32_bf16 v[28:31], v[68:71], a[84:87], v[28:31]
    ds_read_b64_tr_b16 v[84:85], v11 offset:24576
    v_mfma_f32_16x16x32_bf16 v[44:47], v[68:71], v[124:127], v[44:47]
    ds_read_b64_tr_b16 v[86:87], v11 offset:25600
    v_mfma_f32_16x16x32_bf16 v[32:35], v[72:75], a[80:83], v[32:35]
    v_perm_b32 v183, v246, v244, s75
    v_mfma_f32_16x16x32_bf16 v[36:39], v[72:75], a[84:87], v[36:39]
    buffer_store_dwordx4 v[180:183], v1, s[4:7], s69 offen sc1
    s_add_u32 s69, s69, s70
    v_mfma_f32_16x16x32_bf16 v[48:51], v[72:75], v[124:127], v[48:51]
    v_perm_b32 v184, v235, v233, s74
    v_perm_b32 v185, v239, v237, s74
    v_perm_b32 v186, v243, v241, s74
    v_perm_b32 v187, v247, v245, s74
    buffer_store_dwordx4 v[184:187], v1, s[4:7], s69 offen sc1
    s_add_u32 s69, s69, s70
    v_perm_b32 v188, v235, v233, s75
    s_waitcnt lgkmcnt(0)
    v_mfma_f32_16x16x32_bf16 v[16:19], v[76:79], a[88:91], v[16:19]
    ds_read_b64_tr_b16 v[64:65], v9 offset:32768
    v_mfma_f32_16x16x32_bf16 v[20:23], v[76:79], a[92:95], v[20:23]
    ds_read_b64_tr_b16 v[66:67], v9 offset:33792
    v_mfma_f32_16x16x32_bf16 v[40:43], v[76:79], v[124:127], v[40:43]
    ds_read_b64_tr_b16 v[68:69], v10 offset:32768
    v_mfma_f32_16x16x32_bf16 v[24:27], v[80:83], a[88:91], v[24:27]
    ds_read_b64_tr_b16 v[70:71], v10 offset:33792
    v_mfma_f32_16x16x32_bf16 v[28:31], v[80:83], a[92:95], v[28:31]
    ds_read_b64_tr_b16 v[72:73], v11 offset:32768
    v_mfma_f32_16x16x32_bf16 v[44:47], v[80:83], v[124:127], v[44:47]
    ds_read_b64_tr_b16 v[74:75], v11 offset:33792
    v_mfma_f32_16x16x32_bf16 v[32:35], v[84:87], a[88:91], v[32:35]
    v_perm_b32 v189, v239, v237, s75
    v_mfma_f32_16x16x32_bf16 v[36:39], v[84:87], a[92:95], v[36:39]
    v_perm_b32 v190, v243, v241, s75
    v_mfma_f32_16x16x32_bf16 v[48:51], v[84:87], v[124:127], v[48:51]
    v_perm_b32 v191, v247, v245, s75
    buffer_store_dwordx4 v[188:191], v1, s[4:7], s69 offen sc1
    s_add_u32 s69, s69, s70
    s_waitcnt lgkmcnt(0)
    v_mfma_f32_16x16x32_bf16 v[16:19], v[64:67], a[96:99], v[16:19]
    ds_read_b64_tr_b16 v[76:77], v9 offset:40960
    v_mfma_f32_16x16x32_bf16 v[20:23], v[64:67], a[100:103], v[20:23]
    ds_read_b64_tr_b16 v[78:79], v9 offset:41984
    v_mfma_f32_16x16x32_bf16 v[40:43], v[64:67], v[124:127], v[40:43]
    ds_read_b64_tr_b16 v[80:81], v10 offset:40960
    v_mfma_f32_16x16x32_bf16 v[24:27], v[68:71], a[96:99], v[24:27]
    ds_read_b64_tr_b16 v[82:83], v10 offset:41984
    v_mfma_f32_16x16x32_bf16 v[28:31], v[68:71], a[100:103], v[28:31]
    ds_read_b64_tr_b16 v[84:85], v11 offset:40960
    v_mfma_f32_16x16x32_bf16 v[44:47], v[68:71], v[124:127], v[44:47]
    ds_read_b64_tr_b16 v[86:87], v11 offset:41984
    v_mfma_f32_16x16x32_bf16 v[32:35], v[72:75], a[96:99], v[32:35]
    v_mfma_f32_16x16x32_bf16 v[36:39], v[72:75], a[100:103], v[36:39]
    v_mfma_f32_16x16x32_bf16 v[48:51], v[72:75], v[124:127], v[48:51]
    s_waitcnt lgkmcnt(0)
    v_mfma_f32_16x16x32_bf16 v[16:19], v[76:79], a[104:107], v[16:19]
    ds_read_b64_tr_b16 v[64:65], v9 offset:49152
    v_mfma_f32_16x16x32_bf16 v[20:23], v[76:79], a[108:111], v[20:23]
    ds_read_b64_tr_b16 v[66:67], v9 offset:50176
    v_mfma_f32_16x16x32_bf16 v[40:43], v[76:79], v[124:127], v[40:43]
    ds_read_b64_tr_b16 v[68:69], v10 offset:49152
    v_mfma_f32_16x16x32_bf16 v[24:27], v[80:83], a[104:107], v[24:27]
    ds_read_b64_tr_b16 v[70:71], v10 offset:50176
    v_mfma_f32_16x16x32_bf16 v[28:31], v[80:83], a[108:111], v[28:31]
    ds_read_b64_tr_b16 v[72:73], v11 offset:49152
    v_mfma_f32_16x16x32_bf16 v[44:47], v[80:83], v[124:127], v[44:47]
    ds_read_b64_tr_b16 v[74:75], v11 offset:50176
    v_mfma_f32_16x16x32_bf16 v[32:35], v[84:87], a[104:107], v[32:35]
    v_mfma_f32_16x16x32_bf16 v[36:39], v[84:87], a[108:111], v[36:39]
    v_mfma_f32_16x16x32_bf16 v[48:51], v[84:87], v[124:127], v[48:51]
    s_waitcnt lgkmcnt(0)
    v_mfma_f32_16x16x32_bf16 v[16:19], v[64:67], a[112:115], v[16:19]
    ds_read_b64_tr_b16 v[76:77], v9 offset:57344
    v_mfma_f32_16x16x32_bf16 v[20:23], v[64:67], a[116:119], v[20:23]
    ds_read_b64_tr_b16 v[78:79], v9 offset:58368
    v_mfma_f32_16x16x32_bf16 v[40:43], v[64:67], v[124:127], v[40:43]
    ds_read_b64_tr_b16 v[80:81], v10 offset:57344
    v_mfma_f32_16x16x32_bf16 v[24:27], v[68:71], a[112:115], v[24:27]
    ds_read_b64_tr_b16 v[82:83], v10 offset:58368
    v_mfma_f32_16x16x32_bf16 v[28:31], v[68:71], a[116:119], v[28:31]
    ds_read_b64_tr_b16 v[84:85], v11 offset:57344
    v_mfma_f32_16x16x32_bf16 v[44:47], v[68:71], v[124:127], v[44:47]
    ds_read_b64_tr_b16 v[86:87], v11 offset:58368
    v_mfma_f32_16x16x32_bf16 v[32:35], v[72:75], a[112:115], v[32:35]
    v_lshlrev_b32 v134, 2, v2
    buffer_load_dword v240, v134, s[4:7], s47 offen sc1
    v_mfma_f32_16x16x32_bf16 v[36:39], v[72:75], a[116:119], v[36:39]
    v_mfma_f32_16x16x32_bf16 v[48:51], v[72:75], v[124:127], v[48:51]
    s_waitcnt lgkmcnt(0)
    v_mfma_f32_16x16x32_bf16 v[16:19], v[76:79], a[120:123], v[16:19]
    v_add_u32 v9, 0x10000, v9
    v_add_u32 v10, 0x10000, v10
    v_add_u32 v11, 0x10000, v11
    v_mfma_f32_16x16x32_bf16 v[20:23], v[76:79], a[124:127], v[20:23]
    ds_read_b64_tr_b16 v[64:65], v9 offset:0
    v_mfma_f32_16x16x32_bf16 v[40:43], v[76:79], v[124:127], v[40:43]
    ds_read_b64_tr_b16 v[66:67], v9 offset:1024
    v_mfma_f32_16x16x32_bf16 v[24:27], v[80:83], a[120:123], v[24:27]
    ds_read_b64_tr_b16 v[68:69], v10 offset:0
    v_mfma_f32_16x16x32_bf16 v[28:31], v[80:83], a[124:127], v[28:31]
    ds_read_b64_tr_b16 v[70:71], v10 offset:1024
    v_mfma_f32_16x16x32_bf16 v[44:47], v[80:83], v[124:127], v[44:47]
    ds_read_b64_tr_b16 v[72:73], v11 offset:0
    v_mfma_f32_16x16x32_bf16 v[32:35], v[84:87], a[120:123], v[32:35]
    ds_read_b64_tr_b16 v[74:75], v11 offset:1024
    v_mfma_f32_16x16x32_bf16 v[36:39], v[84:87], a[124:127], v[36:39]
    v_mfma_f32_16x16x32_bf16 v[48:51], v[84:87], v[124:127], v[48:51]
    s_waitcnt lgkmcnt(0)
    v_mfma_f32_16x16x32_bf16 v[16:19], v[64:67], a[128:131], v[16:19]
    ds_read_b64_tr_b16 v[76:77], v9 offset:8192
    v_mfma_f32_16x16x32_bf16 v[20:23], v[64:67], a[132:135], v[20:23]
    ds_read_b64_tr_b16 v[78:79], v9 offset:9216
    v_mfma_f32_16x16x32_bf16 v[40:43], v[64:67], v[124:127], v[40:43]
    ds_read_b64_tr_b16 v[80:81], v10 offset:8192
    v_mfma_f32_16x16x32_bf16 v[24:27], v[68:71], a[128:131], v[24:27]
    ds_read_b64_tr_b16 v[82:83], v10 offset:9216
    v_mfma_f32_16x16x32_bf16 v[28:31], v[68:71], a[132:135], v[28:31]
    ds_read_b64_tr_b16 v[84:85], v11 offset:8192
    v_mfma_f32_16x16x32_bf16 v[44:47], v[68:71], v[124:127], v[44:47]
    ds_read_b64_tr_b16 v[86:87], v11 offset:9216
    v_mfma_f32_16x16x32_bf16 v[32:35], v[72:75], a[128:131], v[32:35]
    v_mfma_f32_16x16x32_bf16 v[36:39], v[72:75], a[132:135], v[36:39]
    v_mfma_f32_16x16x32_bf16 v[48:51], v[72:75], v[124:127], v[48:51]
    s_waitcnt lgkmcnt(0)
    v_mfma_f32_16x16x32_bf16 v[16:19], v[76:79], a[136:139], v[16:19]
    s_waitcnt vmcnt(0)
    v_mfma_f32_16x16x32_bf16 v[20:23], v[76:79], a[140:143], v[20:23]
    s_lshl_b32 s46, s42, 16
    s_lshl_b32 s45, s40, 10
    s_add_u32 s46, s46, s45
    s_add_u32 s46, s46, 65536
    buffer_load_dwordx4 v[176:179], v1, s[4:7], s46 offen sc1
    s_add_u32 s46, s46, 4096
    v_mfma_f32_16x16x32_bf16 v[40:43], v[76:79], v[124:127], v[40:43]
    ds_read_b32 v136, v133 offset:0
    v_mfma_f32_16x16x32_bf16 v[24:27], v[80:83], a[136:139], v[24:27]
    buffer_load_dwordx4 v[180:183], v1, s[4:7], s46 offen sc1
    s_add_u32 s46, s46, 4096
    v_mfma_f32_16x16x32_bf16 v[28:31], v[80:83], a[140:143], v[28:31]
    ds_read_b32 v138, v133 offset:64
    v_mfma_f32_16x16x32_bf16 v[44:47], v[80:83], v[124:127], v[44:47]
    buffer_load_dwordx4 v[184:187], v1, s[4:7], s46 offen sc1
    s_add_u32 s46, s46, 4096
    v_mfma_f32_16x16x32_bf16 v[32:35], v[84:87], a[136:139], v[32:35]
    ds_read_b32 v137, v133 offset:128
    v_mfma_f32_16x16x32_bf16 v[36:39], v[84:87], a[140:143], v[36:39]
    ds_read_b32 v139, v133 offset:192
    v_mfma_f32_16x16x32_bf16 v[48:51], v[84:87], v[124:127], v[48:51]
    s_waitcnt lgkmcnt(0)
    v_mul_f32 v136, s78, v136
    v_mul_f32 v137, s78, v137
    v_fma_f32 v138, v138, s79, v15
    v_fma_f32 v139, v139, s79, v15
    v_fma_f32 v138, -v136, v136, v138
    v_fma_f32 v139, -v137, v137, v139
    v_max_f32 v138, v138, v15
    v_max_f32 v139, v139, v15
    v_rsq_f32 v138, v138
    v_rsq_f32 v139, v139
    v_mul_f32 v140, s80, v138
    v_mul_f32 v141, s80, v139
    buffer_load_dwordx4 v[188:191], v1, s[4:7], s46 offen sc1
    s_add_u32 s46, s46, 4096
    buffer_load_dwordx4 v[192:195], v1, s[4:7], s46 offen sc1
    s_add_u32 s46, s46, 4096
    buffer_load_dwordx4 v[196:199], v1, s[4:7], s46 offen sc1
    s_add_u32 s46, s46, 4096
    v_fma_f32 v16, v136, v40, v16
    v_fma_f32 v17, v136, v41, v17
    v_fma_f32 v18, v136, v42, v18
    v_fma_f32 v19, v136, v43, v19
    v_mul_f32 v64, v16, v140
    v_mul_f32 v65, v17, v140
    v_mul_f32 v66, v18, v140
    v_mul_f32 v67, v19, v140
    v_exp_f32 v64, v64 clamp
    v_exp_f32 v65, v65 clamp
    v_exp_f32 v66, v66 clamp
    v_exp_f32 v67, v67 clamp
    v_fma_f32 v16, v16, v138, s81
    v_fma_f32 v17, v17, v138, s81
    v_fma_f32 v18, v18, v138, s81
    v_fma_f32 v19, v19, v138, s81
    v_max_f32 v16, s81, v16
    v_max_f32 v17, s81, v17
    v_max_f32 v18, s81, v18
    v_max_f32 v19, s81, v19
    v_add_f32 v16, v16, v64
    v_add_f32 v17, v17, v65
    v_add_f32 v18, v18, v66
    v_add_f32 v19, v19, v67
    v_cvt_pk_bf16_f32 v144, v16, v17
    v_cvt_pk_bf16_f32 v145, v18, v19
    buffer_load_dwordx4 v[200:203], v1, s[4:7], s46 offen sc1
    s_add_u32 s46, s46, 4096
    buffer_load_dwordx4 v[204:207], v1, s[4:7], s46 offen sc1
    s_add_u32 s46, s46, 4096
    v_fma_f32 v20, v137, v40, v20
    v_fma_f32 v21, v137, v41, v21
    v_fma_f32 v22, v137, v42, v22
    v_fma_f32 v23, v137, v43, v23
    v_mul_f32 v64, v20, v141
    v_mul_f32 v65, v21, v141
    v_mul_f32 v66, v22, v141
    v_mul_f32 v67, v23, v141
    v_exp_f32 v64, v64 clamp
    v_exp_f32 v65, v65 clamp
    v_exp_f32 v66, v66 clamp
    v_exp_f32 v67, v67 clamp
    v_fma_f32 v20, v20, v139, s81
    v_fma_f32 v21, v21, v139, s81
    v_fma_f32 v22, v22, v139, s81
    v_fma_f32 v23, v23, v139, s81
    v_max_f32 v20, s81, v20
    v_max_f32 v21, s81, v21
    v_max_f32 v22, s81, v22
    v_max_f32 v23, s81, v23
    v_add_f32 v20, v20, v64
    v_add_f32 v21, v21, v65
    v_add_f32 v22, v22, v66
    v_add_f32 v23, v23, v67
    v_cvt_pk_bf16_f32 v148, v20, v21
    v_cvt_pk_bf16_f32 v149, v22, v23
    buffer_load_dwordx4 v[208:211], v1, s[4:7], s46 offen sc1
    s_add_u32 s46, s46, 4096
    buffer_load_dwordx4 v[212:215], v1, s[4:7], s46 offen sc1
    s_add_u32 s46, s46, 4096
    v_fma_f32 v24, v136, v44, v24
    v_fma_f32 v25, v136, v45, v25
    v_fma_f32 v26, v136, v46, v26
    v_fma_f32 v27, v136, v47, v27
    v_mul_f32 v64, v24, v140
    v_mul_f32 v65, v25, v140
    v_mul_f32 v66, v26, v140
    v_mul_f32 v67, v27, v140
    v_exp_f32 v64, v64 clamp
    v_exp_f32 v65, v65 clamp
    v_exp_f32 v66, v66 clamp
    v_exp_f32 v67, v67 clamp
    v_fma_f32 v24, v24, v138, s81
    v_fma_f32 v25, v25, v138, s81
    v_fma_f32 v26, v26, v138, s81
    v_fma_f32 v27, v27, v138, s81
    v_max_f32 v24, s81, v24
    v_max_f32 v25, s81, v25
    v_max_f32 v26, s81, v26
    v_max_f32 v27, s81, v27
    v_add_f32 v24, v24, v64
    v_add_f32 v25, v25, v65
    v_add_f32 v26, v26, v66
    v_add_f32 v27, v27, v67
    v_cvt_pk_bf16_f32 v146, v24, v25
    v_cvt_pk_bf16_f32 v147, v26, v27
    buffer_load_dwordx4 v[216:219], v1, s[4:7], s46 offen sc1
    s_add_u32 s46, s46, 4096
    buffer_load_dwordx4 v[220:223], v1, s[4:7], s46 offen sc1
    s_add_u32 s46, s46, 4096
    v_fma_f32 v28, v137, v44, v28
    v_fma_f32 v29, v137, v45, v29
    v_fma_f32 v30, v137, v46, v30
    v_fma_f32 v31, v137, v47, v31
    v_mul_f32 v64, v28, v141
    v_mul_f32 v65, v29, v141
    v_mul_f32 v66, v30, v141
    v_mul_f32 v67, v31, v141
    v_exp_f32 v64, v64 clamp
    v_exp_f32 v65, v65 clamp
    v_exp_f32 v66, v66 clamp
    v_exp_f32 v67, v67 clamp
    v_fma_f32 v28, v28, v139, s81
    v_fma_f32 v29, v29, v139, s81
    v_fma_f32 v30, v30, v139, s81
    v_fma_f32 v31, v31, v139, s81
    v_max_f32 v28, s81, v28
    v_max_f32 v29, s81, v29
    v_max_f32 v30, s81, v30
    v_max_f32 v31, s81, v31
    v_add_f32 v28, v28, v64
    v_add_f32 v29, v29, v65
    v_add_f32 v30, v30, v66
    v_add_f32 v31, v31, v67
    v_cvt_pk_bf16_f32 v150, v28, v29
    v_cvt_pk_bf16_f32 v151, v30, v31
    buffer_load_dwordx4 v[224:227], v1, s[4:7], s46 offen sc1
    s_add_u32 s46, s46, 4096
    buffer_load_dwordx4 v[228:231], v1, s[4:7], s46 offen sc1
    s_add_u32 s46, s46, 4096
    v_fma_f32 v32, v136, v48, v32
    v_fma_f32 v33, v136, v49, v33
    v_fma_f32 v34, v136, v50, v34
    v_fma_f32 v35, v136, v51, v35
    v_mul_f32 v64, v32, v140
    v_mul_f32 v65, v33, v140
    v_mul_f32 v66, v34, v140
    v_mul_f32 v67, v35, v140
    v_exp_f32 v64, v64 clamp
    v_exp_f32 v65, v65 clamp
    v_exp_f32 v66, v66 clamp
    v_exp_f32 v67, v67 clamp
    v_fma_f32 v32, v32, v138, s81
    v_fma_f32 v33, v33, v138, s81
    v_fma_f32 v34, v34, v138, s81
    v_fma_f32 v35, v35, v138, s81
    v_max_f32 v32, s81, v32
    v_max_f32 v33, s81, v33
    v_max_f32 v34, s81, v34
    v_max_f32 v35, s81, v35
    v_add_f32 v32, v32, v64
    v_add_f32 v33, v33, v65
    v_add_f32 v34, v34, v66
    v_add_f32 v35, v35, v67
    v_cvt_pk_bf16_f32 v152, v32, v33
    v_cvt_pk_bf16_f32 v153, v34, v35
    buffer_load_dwordx4 v[232:235], v1, s[4:7], s46 offen sc1
    s_add_u32 s46, s46, 4096
    buffer_load_dwordx4 v[236:239], v1, s[4:7], s46 offen sc1
    v_fma_f32 v36, v137, v48, v36
    v_fma_f32 v37, v137, v49, v37
    v_fma_f32 v38, v137, v50, v38
    v_fma_f32 v39, v137, v51, v39
    v_mul_f32 v64, v36, v141
    v_mul_f32 v65, v37, v141
    v_mul_f32 v66, v38, v141
    v_mul_f32 v67, v39, v141
    v_exp_f32 v64, v64 clamp
    v_exp_f32 v65, v65 clamp
    v_exp_f32 v66, v66 clamp
    v_exp_f32 v67, v67 clamp
    v_fma_f32 v36, v36, v139, s81
    v_fma_f32 v37, v37, v139, s81
    v_fma_f32 v38, v38, v139, s81
    v_fma_f32 v39, v39, v139, s81
    v_max_f32 v36, s81, v36
    v_max_f32 v37, s81, v37
    v_max_f32 v38, s81, v38
    v_max_f32 v39, s81, v39
    v_add_f32 v36, v36, v64
    v_add_f32 v37, v37, v65
    v_add_f32 v38, v38, v66
    v_add_f32 v39, v39, v67
    v_cvt_pk_bf16_f32 v154, v36, v37
    v_cvt_pk_bf16_f32 v155, v38, v39
    s_mov_b32 s45, 0x3111
    v_bfe_i32 v248, s45, v2, 1
    s_mov_b32 s45, 0xc222
    v_bfe_i32 v249, s45, v2, 1
    v_bfe_i32 v250, 2, v3, 1
    v_bfe_i32 v251, 4, v3, 1
    v_lshlrev_b32 v134, 2, v2
    s_lshl_b32 s45, s40, 9
    s_add_u32 s45, s45, 160768
    v_lshl_add_u32 v132, v0, 3, s45
    v_lshlrev_b32 v133, 3, v0
    v_add_u32 v133, 160768, v133
    v_cmp_ne_u32 vcc, 1, v240
    s_cbranch_vccz kvd_37
    s_mov_b32 s52, 0
poll_38:
    buffer_load_dword v136, v134, s[4:7], s47 offen sc1
    s_waitcnt vmcnt(0)
    v_cmp_ne_u32 vcc, 1, v136
    s_cbranch_vccz pdone_39
    s_add_u32 s52, s52, 1
    s_cmp_lt_u32 s52, 20000
    s_cbranch_scc1 poll_38
pdone_39:
    s_lshl_b32 s44, s42, 16
    s_lshl_b32 s45, s40, 10
    s_add_u32 s44, s44, s45
    s_add_u32 s44, s44, 65536
    buffer_load_dwordx4 v[176:179], v1, s[4:7], s44 offen sc1
    s_add_u32 s44, s44, 4096
    buffer_load_dwordx4 v[180:183], v1, s[4:7], s44 offen sc1
    s_add_u32 s44, s44, 4096
    buffer_load_dwordx4 v[184:187], v1, s[4:7], s44 offen sc1
    s_add_u32 s44, s44, 4096
    buffer_load_dwordx4 v[188:191], v1, s[4:7], s44 offen sc1
    s_add_u32 s44, s44, 4096
    buffer_load_dwordx4 v[192:195], v1, s[4:7], s44 offen sc1
    s_add_u32 s44, s44, 4096
    buffer_load_dwordx4 v[196:199], v1, s[4:7], s44 offen sc1
    s_add_u32 s44, s44, 4096
    buffer_load_dwordx4 v[200:203], v1, s[4:7], s44 offen sc1
    s_add_u32 s44, s44, 4096
    buffer_load_dwordx4 v[204:207], v1, s[4:7], s44 offen sc1
    s_add_u32 s44, s44, 4096
    buffer_load_dwordx4 v[208:211], v1, s[4:7], s44 offen sc1
    s_add_u32 s44, s44, 4096
    buffer_load_dwordx4 v[212:215], v1, s[4:7], s44 offen sc1
    s_add_u32 s44, s44, 4096
    buffer_load_dwordx4 v[216:219], v1, s[4:7], s44 offen sc1
    s_add_u32 s44, s44, 4096
    buffer_load_dwordx4 v[220:223], v1, s[4:7], s44 offen sc1
    s_add_u32 s44, s44, 4096
    buffer_load_dwordx4 v[224:227], v1, s[4:7], s44 offen sc1
    s_add_u32 s44, s44, 4096
    buffer_load_dwordx4 v[228:231], v1, s[4:7], s44 offen sc1
    s_add_u32 s44, s44, 4096
    buffer_load_dwordx4 v[232:235], v1, s[4:7], s44 offen sc1
    s_add_u32 s44, s44, 4096
    buffer_load_dwordx4 v[236:239], v1, s[4:7], s44 offen sc1
kvd_37:
    s_lshl_b32 s44, s84, 6
    s_lshl_b32 s45, s40, 4
    s_add_u32 s45, s45, s44
    s_mul_i32 s45, s45, 1152
    s_lshl_b32 s46, s85, 7
    s_add_u32 s90, s45, s46
    s_add_u32 s91, s90, 9216
    s_lshr_b32 s45, s85, 1
    s_lshl_b32 s45, s45, 4
    s_add_u32 s44, s44, s45
    s_lshl_b32 s45, s40, 3
    s_add_u32 s44, s44, s45
    s_mul_i32 s44, s44, 1152
    s_add_u32 s92, s44, 1024
    s_cmp_lt_u32 s40, 2
    s_cselect_b32 s92, s92, 0x7f000000
    s_waitcnt vmcnt(14)
    s_waitcnt vmcnt(13)
    v_pk_add_f32 v[176:177], v[176:177], v[184:185]
    v_pk_add_f32 v[178:179], v[178:179], v[186:187]
    s_waitcnt vmcnt(12)
    v_pk_add_f32 v[180:181], v[180:181], v[188:189]
    v_pk_add_f32 v[182:183], v[182:183], v[190:191]
    s_waitcnt vmcnt(11)
    v_pk_add_f32 v[176:177], v[176:177], v[192:193]
    v_pk_add_f32 v[178:179], v[178:179], v[194:195]
    s_waitcnt vmcnt(10)
    v_pk_add_f32 v[180:181], v[180:181], v[196:197]
    v_pk_add_f32 v[182:183], v[182:183], v[198:199]
    s_waitcnt vmcnt(9)
    v_pk_add_f32 v[176:177], v[176:177], v[200:201]
    v_pk_add_f32 v[178:179], v[178:179], v[202:203]
    s_waitcnt vmcnt(8)
    v_pk_add_f32 v[180:181], v[180:181], v[204:205]
    v_pk_add_f32 v[182:183], v[182:183], v[206:207]
    s_waitcnt vmcnt(7)
    v_pk_add_f32 v[176:177], v[176:177], v[208:209]
    v_pk_add_f32 v[178:179], v[178:179], v[210:211]
    s_waitcnt vmcnt(6)
    v_pk_add_f32 v[180:181], v[180:181], v[212:213]
    v_pk_add_f32 v[182:183], v[182:183], v[214:215]
    s_waitcnt vmcnt(5)
    v_pk_add_f32 v[176:177], v[176:177], v[216:217]
    v_pk_add_f32 v[178:179], v[178:179], v[218:219]
    s_waitcnt vmcnt(4)
    v_pk_add_f32 v[180:181], v[180:181], v[220:221]
    v_pk_add_f32 v[182:183], v[182:183], v[222:223]
    s_waitcnt vmcnt(3)
    v_pk_add_f32 v[176:177], v[176:177], v[224:225]
    v_pk_add_f32 v[178:179], v[178:179], v[226:227]
    s_waitcnt vmcnt(2)
    v_pk_add_f32 v[180:181], v[180:181], v[228:229]
    v_pk_add_f32 v[182:183], v[182:183], v[230:231]
    s_waitcnt vmcnt(1)
    v_pk_add_f32 v[176:177], v[176:177], v[232:233]
    v_pk_add_f32 v[178:179], v[178:179], v[234:235]
    s_waitcnt vmcnt(0)
    v_pk_add_f32 v[180:181], v[180:181], v[236:237]
    v_pk_add_f32 v[182:183], v[182:183], v[238:239]
    v_pk_add_f32 v[176:177], v[176:177], v[180:181]
    v_pk_add_f32 v[178:179], v[178:179], v[182:183]
    v_cvt_pk_bf16_f32 v160, v176, v177
    v_cvt_pk_bf16_f32 v161, v178, v179
    ds_write_b64 v132, v[160:161]
    s_waitcnt lgkmcnt(0)
    s_barrier
    ds_read_b64 v[160:161], v133 offset:0
    ds_read_b64 v[162:163], v133 offset:512
    ds_read_b64 v[164:165], v133 offset:1024
    ds_read_b64 v[166:167], v133 offset:1536
    v_lshlrev_b32 v135, 10, v3
    v_lshl_add_u32 v135, v2, 4, v135
    s_movk_i32 s86, 768
    s_lshr_b32 s87, s94, 1
    s_lshl_b32 s87, s87, 10
    v_subrev_u32 v168, 256, v135
    v_cmp_gt_u32 vcc, 2, v3
    s_nop 1
    v_cndmask_b32 v135, v135, v168, vcc
    v_add_u32 v135, 768, v135
    s_mov_b32 s86, 0
    buffer_load_dwordx4 v[168:171], v135, s[4:7], s86 offen sc1
    s_add_u32 m0, s51, 81920
    s_nop 0
    buffer_load_dwordx4 v12, s[8:11], s90 offen lds
    s_add_u32 m0, s51, 82944
    s_nop 0
    buffer_load_dwordx4 v12, s[8:11], s91 offen lds
    s_lshr_b32 s44, s51, 1
    s_add_u32 m0, s44, 90112
    s_nop 0
    buffer_load_dwordx4 v12, s[8:11], s92 offen lds
    s_lshl_b32 s44, s41, 1
    s_lshr_b32 s45, s40, 1
    s_add_u32 s44, s44, s45
    s_lshl_b32 s48, s44, 7
    s_mul_i32 s44, s44, 73728
    s_and_b32 s45, s40, 1
    s_lshl_b32 s46, s45, 11
    s_add_u32 s44, s44, s46
    s_add_u32 s44, s44, 2097152
    s_lshl_b32 s45, s45, 2
    s_add_u32 s48, s48, s45
    s_lshl_b32 s45, s42, 3
    s_add_u32 s48, s48, s45
    s_add_u32 s48, s48, 5120
    s_lshr_b32 s45, s42, 3
    s_add_u32 s45, s45, 16
    s_lshl_b32 s45, s45, 12
    s_and_b32 s46, s42, 6
    s_lshl_b32 s46, s46, 7
    s_add_u32 s45, s45, s46
    s_add_u32 s45, s45, s43
    s_add_u32 s45, s45, s44
    s_lshl_b32 s46, s42, 12
    s_add_u32 s44, s44, s46
    v_lshlrev_b32 v134, 4, v2
    s_waitcnt lgkmcnt(2)
    v_mfma_f32_16x16x16_bf16 v[16:19], v[160:161], v[144:145], 0
    v_mfma_f32_16x16x16_bf16 v[20:23], v[162:163], v[146:147], 0
    v_mfma_f32_16x16x16_bf16 v[28:31], v[160:161], v[148:149], 0
    v_mfma_f32_16x16x16_bf16 v[32:35], v[162:163], v[150:151], 0
    s_waitcnt lgkmcnt(0)
    v_mov_b32 v61, 0
    v_mov_b32 v62, 0
    v_and_b32 v56, v164, v248
    v_and_b32 v57, v165, v248
    v_and_b32 v58, v164, v249
    v_and_b32 v59, v165, v249
    v_and_b32 v64, v166, v251
    v_and_b32 v65, v167, v250
    v_and_b32 v60, v166, v250
    v_and_b32 v63, v167, v251
    v_mfma_f32_16x16x32_bf16 v[24:27], v[56:59], v[144:147], 0
    v_mfma_f32_16x16x32_bf16 v[36:39], v[56:59], v[148:151], 0
    v_mfma_f32_16x16x16_bf16 v[24:27], v[64:65], v[152:153], v[24:27]
    v_mfma_f32_16x16x16_bf16 v[36:39], v[64:65], v[154:155], v[36:39]
    v_mfma_f32_16x16x16_bf16 v[16:19], v[60:61], v[152:153], v[16:19]
    v_mfma_f32_16x16x16_bf16 v[20:23], v[62:63], v[152:153], v[20:23]
    v_mfma_f32_16x16x16_bf16 v[28:31], v[60:61], v[154:155], v[28:31]
    v_mfma_f32_16x16x16_bf16 v[32:35], v[62:63], v[154:155], v[32:35]
    s_nop 2
    v_add_f32 v68, s81, v24
    v_add_f32 v69, s81, v24
    v_add_f32 v70, s81, v25
    v_add_f32 v71, s81, v25
    v_add_f32 v72, s81, v36
    v_add_f32 v73, s81, v36
    v_add_f32 v74, s81, v37
    v_add_f32 v75, s81, v37
    v_permlane16_swap_b32 v68, v69
    v_permlane16_swap_b32 v70, v71
    v_permlane16_swap_b32 v72, v73
    v_permlane16_swap_b32 v74, v75
    v_rcp_f32 v68, v68
    v_rcp_f32 v70, v70
    v_rcp_f32 v72, v72
    v_rcp_f32 v74, v74
    v_mul_f32 v16, v16, v68
    v_mul_f32 v17, v17, v68
    v_mul_f32 v18, v18, v68
    v_mul_f32 v19, v19, v68
    v_cvt_pk_bf16_f32 v80, v16, v17
    v_cvt_pk_bf16_f32 v81, v18, v19
    v_mul_f32 v20, v20, v70
    v_mul_f32 v21, v21, v70
    v_mul_f32 v22, v22, v70
    v_mul_f32 v23, v23, v70
    v_cvt_pk_bf16_f32 v82, v20, v21
    v_cvt_pk_bf16_f32 v83, v22, v23
    buffer_store_dwordx4 v[80:83], v1, s[4:7], s44 offen offset:0 sc1
    v_mul_f32 v28, v28, v72
    v_mul_f32 v29, v29, v72
    v_mul_f32 v30, v30, v72
    v_mul_f32 v31, v31, v72
    v_cvt_pk_bf16_f32 v88, v28, v29
    v_cvt_pk_bf16_f32 v89, v30, v31
    v_mul_f32 v32, v32, v74
    v_mul_f32 v33, v33, v74
    v_mul_f32 v34, v34, v74
    v_mul_f32 v35, v35, v74
    v_cvt_pk_bf16_f32 v90, v32, v33
    v_cvt_pk_bf16_f32 v91, v34, v35
    buffer_store_dwordx4 v[88:91], v1, s[4:7], s44 offen offset:1024 sc1
    v_mul_f32 v24, v24, v68
    v_mul_f32 v25, v25, v68
    v_mul_f32 v26, v26, v70
    v_mul_f32 v27, v27, v70
    v_cvt_pk_bf16_f32 v84, v24, v25
    v_cvt_pk_bf16_f32 v85, v26, v27
    v_mul_f32 v36, v36, v72
    v_mul_f32 v37, v37, v72
    v_mul_f32 v38, v38, v74
    v_mul_f32 v39, v39, v74
    v_cvt_pk_bf16_f32 v92, v36, v37
    v_cvt_pk_bf16_f32 v93, v38, v39
    s_mov_b32 exec_lo, 0x0
    s_mov_b32 exec_hi, 0xffff0000
    buffer_store_dwordx2 v[84:85], v134, s[4:7], s45 offen offset:0 sc1
    buffer_store_dwordx2 v[92:93], v134, s[4:7], s45 offen offset:1024 sc1
    s_mov_b64 exec, -1
    s_waitcnt vmcnt(7)
    v_and_b32 v168, v168, v169
    v_and_b32 v170, v170, v171
    v_and_b32 v168, v168, v170
    v_cmp_ne_u32 vcc, 1, v168
    s_cbranch_vccz ok_40
    s_mov_b32 s52, 0
poll_41:
    buffer_load_dwordx4 v[168:171], v135, s[4:7], s86 offen sc1
    s_waitcnt vmcnt(0)
    v_and_b32 v168, v168, v169
    v_and_b32 v170, v170, v171
    v_and_b32 v168, v168, v170
    v_cmp_ne_u32 vcc, 1, v168
    s_cbranch_vccz pdone_42
    s_add_u32 s52, s52, 1
    s_cmp_lt_u32 s52, 20000
    s_cbranch_scc1 poll_41
pdone_42:
ok_40:
    s_lshl_b32 s88, s85, 1
    s_and_b32 s86, s40, 1
    s_add_u32 s88, s88, s86
    s_mul_i32 s88, s88, 36864
    s_add_u32 s88, s88, 7340032
    buffer_load_dwordx4 a[0:3], v1, s[4:7], s88 offen offset:0 sc1
    buffer_load_dwordx4 a[4:7], v1, s[4:7], s88 offen offset:1024 sc1
    buffer_load_dwordx4 a[8:11], v1, s[4:7], s88 offen offset:2048 sc1
    buffer_load_dwordx4 a[12:15], v1, s[4:7], s88 offen offset:3072 sc1
    s_add_u32 s88, s88, 4096
    buffer_load_dwordx4 a[16:19], v1, s[4:7], s88 offen offset:0 sc1
    buffer_load_dwordx4 a[20:23], v1, s[4:7], s88 offen offset:1024 sc1
    buffer_load_dwordx4 a[24:27], v1, s[4:7], s88 offen offset:2048 sc1
    buffer_load_dwordx4 a[28:31], v1, s[4:7], s88 offen offset:3072 sc1
    s_add_u32 s88, s88, 4096
    s_and_b32 s44, s85, 1
    s_lshl_b32 s44, s44, 1
    s_add_u32 s49, s44, s40
    s_add_u32 s47, s49, 32
    s_mul_i32 s47, s47, 18432
    s_add_u32 s47, s47, 7340032
    s_lshl_b32 s87, s94, 2
    s_add_u32 s87, s87, s40
    s_mul_i32 s87, s87, 331776
    s_add_u32 s87, s87, 8388608
    s_and_b32 s44, s40, 1
    s_lshl_b32 s44, s44, 1
    s_add_u32 s45, s44, 1
    s_cmp_lt_u32 s40, 2
    s_cselect_b64 s[76:77], -1, 0
    v_lshl_add_u32 v100, v2, 2, s44
    v_lshlrev_b32 v101, 3, v3
    v_sub_u32 v100, v100, v101
    v_and_b32 v101, 1, v100
    v_lshlrev_b32 v101, 4, v101
    v_mov_b32 v102, 0x3f80
    v_lshlrev_b32 v101, v101, v102
    v_lshrrev_b32 v100, 1, v100
    v_cmp_eq_u32 vcc, 0, v100
    s_nop 1
    v_cndmask_b32 v40, 0, v101, vcc
    v_cmp_eq_u32 vcc, 1, v100
    s_nop 1
    v_cndmask_b32 v41, 0, v101, vcc
    v_cmp_eq_u32 vcc, 2, v100
    s_nop 1
    v_cndmask_b32 v42, 0, v101, vcc
    v_cmp_eq_u32 vcc, 3, v100
    s_nop 1
    v_cndmask_b32 v43, 0, v101, vcc
    v_lshl_add_u32 v100, v2, 2, s49
    v_lshlrev_b32 v101, 3, v3
    v_sub_u32 v100, v100, v101
    v_and_b32 v101, 1, v100
    v_lshlrev_b32 v101, 4, v101
    v_mov_b32 v102, 0x3f80
    v_lshlrev_b32 v101, v101, v102
    v_lshrrev_b32 v100, 1, v100
    v_cmp_eq_u32 vcc, 0, v100
    s_nop 1
    v_cndmask_b32 v48, 0, v101, vcc
    v_cmp_eq_u32 vcc, 1, v100
    s_nop 1
    v_cndmask_b32 v49, 0, v101, vcc
    v_cmp_eq_u32 vcc, 2, v100
    s_nop 1
    v_cndmask_b32 v50, 0, v101, vcc
    v_cmp_eq_u32 vcc, 3, v100
    s_nop 1
    v_cndmask_b32 v51, 0, v101, vcc
    v_lshl_add_u32 v100, v2, 2, s45
    v_lshlrev_b32 v101, 3, v3
    v_sub_u32 v100, v100, v101
    v_and_b32 v101, 1, v100
    v_lshlrev_b32 v101, 4, v101
    v_mov_b32 v102, 0x3f80
    v_lshlrev_b32 v101, v101, v102
    v_lshrrev_b32 v100, 1, v100
    v_cmp_eq_u32 vcc, 0, v100
    s_nop 1
    v_cndmask_b32 v152, 0, v101, vcc
    v_cmp_eq_u32 vcc, 1, v100
    s_nop 1
    v_cndmask_b32 v153, 0, v101, vcc
    v_cmp_eq_u32 vcc, 2, v100
    s_nop 1
    v_cndmask_b32 v154, 0, v101, vcc
    v_cmp_eq_u32 vcc, 3, v100
    s_nop 1
    v_cndmask_b32 v155, 0, v101, vcc
    v_lshl_add_u32 v100, v2, 2, s44
    v_lshlrev_b32 v101, 3, v3
    v_sub_u32 v100, v100, v101
    v_subrev_u32 v100, 32, v100
    v_and_b32 v101, 1, v100
    v_lshlrev_b32 v101, 4, v101
    v_mov_b32 v102, 0x3f80
    v_lshlrev_b32 v101, v101, v102
    v_lshrrev_b32 v100, 1, v100
    v_cmp_eq_u32 vcc, 0, v100
    s_nop 1
    v_cndmask_b32 v44, 0, v101, vcc
    v_cmp_eq_u32 vcc, 1, v100
    s_nop 1
    v_cndmask_b32 v45, 0, v101, vcc
    v_cmp_eq_u32 vcc, 2, v100
    s_nop 1
    v_cndmask_b32 v46, 0, v101, vcc
    v_cmp_eq_u32 vcc, 3, v100
    s_nop 1
    v_cndmask_b32 v47, 0, v101, vcc
    v_lshl_add_u32 v100, v2, 2, s49
    v_lshlrev_b32 v101, 3, v3
    v_sub_u32 v100, v100, v101
    v_subrev_u32 v100, 32, v100
    v_and_b32 v101, 1, v100
    v_lshlrev_b32 v101, 4, v101
    v_mov_b32 v102, 0x3f80
    v_lshlrev_b32 v101, v101, v102
    v_lshrrev_b32 v100, 1, v100
    v_cmp_eq_u32 vcc, 0, v100
    s_nop 1
    v_cndmask_b32 v52, 0, v101, vcc
    v_cmp_eq_u32 vcc, 1, v100
    s_nop 1
    v_cndmask_b32 v53, 0, v101, vcc
    v_cmp_eq_u32 vcc, 2, v100
    s_nop 1
    v_cndmask_b32 v54, 0, v101, vcc
    v_cmp_eq_u32 vcc, 3, v100
    s_nop 1
    v_cndmask_b32 v55, 0, v101, vcc
    v_lshl_add_u32 v100, v2, 2, s45
    v_lshlrev_b32 v101, 3, v3
    v_sub_u32 v100, v100, v101
    v_subrev_u32 v100, 32, v100
    v_and_b32 v101, 1, v100
    v_lshlrev_b32 v101, 4, v101
    v_mov_b32 v102, 0x3f80
    v_lshlrev_b32 v101, v101, v102
    v_lshrrev_b32 v100, 1, v100
    v_cmp_eq_u32 vcc, 0, v100
    s_nop 1
    v_cndmask_b32 v156, 0, v101, vcc
    v_cmp_eq_u32 vcc, 1, v100
    s_nop 1
    v_cndmask_b32 v157, 0, v101, vcc
    v_cmp_eq_u32 vcc, 2, v100
    s_nop 1
    v_cndmask_b32 v158, 0, v101, vcc
    v_cmp_eq_u32 vcc, 3, v100
    s_nop 1
    v_cndmask_b32 v159, 0, v101, vcc
    v_and_b32 v56, 31, v0
    v_lshlrev_b32 v56, 2, v56
    s_lshl_b32 s44, s84, 7
    s_add_u32 s44, s44, 5120
    s_mul_i32 s45, s84, 73728
    s_add_u32 s45, s45, 2097152
    s_lshr_b32 s46, s85, 1
    s_lshl_b32 s46, s46, 10
    v_add_u32 v57, s46, v1
    v_add_u32 v58, 0x10000, v1
    v_add_u32 v59, 0x10000, v57
    v_and_b32 v100, 6, v0
    v_xor_b32 v100, v100, v3
    v_lshlrev_b32 v100, 4, v100
    v_and_b32 v101, 7, v0
    v_lshl_add_u32 v100, v101, 7, v100
    v_bfe_u32 v101, v0, 3, 1
    v_lshl_add_u32 v100, v101, 10, v100
    v_add_u32 v62, 81920, v100
    v_xor_b32 v63, 64, v62
    s_lshr_b32 s46, s40, 1
    s_lshl_b32 s46, s46, 11
    v_add_u32 v150, s46, v1
    v_add_u32 v151, s46, v58
    s_lshl_b32 s46, s46, 1
    v_add_u32 v148, s46, v62
    v_add_u32 v149, s46, v63
    s_waitcnt vmcnt(8)
    s_mov_b64 exec, 1
    buffer_store_dword v14, v6, s[4:7], s48 offen sc1
    s_mov_b64 exec, -1
    buffer_load_dwordx4 a[32:35], v1, s[4:7], s88 offen offset:0 sc1
    buffer_load_dwordx4 a[36:39], v1, s[4:7], s88 offen offset:1024 sc1
    buffer_load_dwordx4 a[40:43], v1, s[4:7], s88 offen offset:2048 sc1
    buffer_load_dwordx4 a[44:47], v1, s[4:7], s88 offen offset:3072 sc1
    s_add_u32 s88, s88, 4096
    buffer_load_dwordx4 a[48:51], v1, s[4:7], s88 offen offset:0 sc1
    buffer_load_dwordx4 a[52:55], v1, s[4:7], s88 offen offset:1024 sc1
    buffer_load_dwordx4 a[56:59], v1, s[4:7], s88 offen offset:2048 sc1
    buffer_load_dwordx4 a[60:63], v1, s[4:7], s88 offen offset:3072 sc1
    s_add_u32 s88, s88, 4096
    buffer_load_dwordx4 a[64:67], v1, s[4:7], s88 offen offset:0 sc1
    buffer_load_dwordx4 a[68:71], v1, s[4:7], s88 offen offset:1024 sc1
    buffer_load_dwordx4 a[72:75], v1, s[4:7], s88 offen offset:2048 sc1
    buffer_load_dwordx4 a[76:79], v1, s[4:7], s88 offen offset:3072 sc1
    s_add_u32 s88, s88, 4096
    buffer_load_dwordx4 a[80:83], v1, s[4:7], s88 offen offset:0 sc1
    buffer_load_dwordx4 a[84:87], v1, s[4:7], s88 offen offset:1024 sc1
    buffer_load_dwordx4 a[88:91], v1, s[4:7], s88 offen offset:2048 sc1
    buffer_load_dwordx4 a[92:95], v1, s[4:7], s88 offen offset:3072 sc1
    s_add_u32 s88, s88, 4096
    buffer_load_dwordx4 a[96:99], v1, s[4:7], s88 offen offset:0 sc1
    buffer_load_dwordx4 a[100:103], v1, s[4:7], s88 offen offset:1024 sc1
    buffer_load_dwordx4 a[104:107], v1, s[4:7], s88 offen offset:2048 sc1
    buffer_load_dwordx4 a[108:111], v1, s[4:7], s88 offen offset:3072 sc1
    s_add_u32 s88, s88, 4096
    buffer_load_dwordx4 a[112:115], v1, s[4:7], s88 offen offset:0 sc1
    buffer_load_dwordx4 a[116:119], v1, s[4:7], s88 offen offset:1024 sc1
    buffer_load_dwordx4 a[120:123], v1, s[4:7], s88 offen offset:2048 sc1
    buffer_load_dwordx4 a[124:127], v1, s[4:7], s88 offen offset:3072 sc1
    s_add_u32 s88, s88, 4096
    buffer_load_dwordx4 a[128:131], v1, s[4:7], s88 offen offset:0 sc1
    buffer_load_dwordx4 a[132:135], v1, s[4:7], s88 offen offset:1024 sc1
    buffer_load_dwordx4 a[136:139], v1, s[4:7], s88 offen offset:2048 sc1
    buffer_load_dwordx4 a[140:143], v1, s[4:7], s88 offen offset:3072 sc1
    s_add_u32 s88, s88, 4096
    s_cmp_ge_u32 s40, 2
    s_cbranch_scc1 nx_43
    buffer_load_dwordx4 a[168:171], v1, s[4:7], s47 offen offset:0 sc1
    buffer_load_dwordx4 a[172:175], v1, s[4:7], s47 offen offset:1024 sc1
    buffer_load_dwordx4 a[176:179], v1, s[4:7], s47 offen offset:2048 sc1
    buffer_load_dwordx4 a[180:183], v1, s[4:7], s47 offen offset:3072 sc1
    s_add_u32 s47, s47, 4096
    buffer_load_dwordx4 a[184:187], v1, s[4:7], s47 offen offset:0 sc1
    buffer_load_dwordx4 a[188:191], v1, s[4:7], s47 offen offset:1024 sc1
    buffer_load_dwordx4 a[192:195], v1, s[4:7], s47 offen offset:2048 sc1
    buffer_load_dwordx4 a[196:199], v1, s[4:7], s47 offen offset:3072 sc1
    s_add_u32 s47, s47, 4096
    buffer_load_dwordx4 a[200:203], v1, s[4:7], s47 offen offset:0 sc1
    buffer_load_dwordx4 a[204:207], v1, s[4:7], s47 offen offset:1024 sc1
    buffer_load_dwordx4 a[208:211], v1, s[4:7], s47 offen offset:2048 sc1
    buffer_load_dwordx4 a[212:215], v1, s[4:7], s47 offen offset:3072 sc1
    s_add_u32 s47, s47, 4096
    buffer_load_dwordx4 a[216:219], v1, s[4:7], s47 offen offset:0 sc1
    buffer_load_dwordx4 a[220:223], v1, s[4:7], s47 offen offset:1024 sc1
    buffer_load_dwordx4 a[224:227], v1, s[4:7], s47 offen offset:2048 sc1
    buffer_load_dwordx4 a[228:231], v1, s[4:7], s47 offen offset:3072 sc1
    s_add_u32 s47, s47, 4096
    buffer_load_dwordx4 a[232:235], v1, s[4:7], s47 offen offset:0 sc1
    buffer_load_dwordx4 a[236:239], v1, s[4:7], s47 offen offset:1024 sc1
nx_43:
    s_cmp_lg_u32 s40, 3
    s_cbranch_scc1 p1_44
    s_mov_b32 s52, 0
poll_45:
    buffer_load_dword v60, v56, s[4:7], s44 offen sc1
    s_waitcnt vmcnt(0)
    v_cmp_ne_u32 vcc, 1, v60
    s_cbranch_vccz pdone_46
    s_add_u32 s52, s52, 1
    s_cmp_lt_u32 s52, 20000
    s_cbranch_scc1 poll_45
pdone_46:
p1_44:
    s_barrier
    s_lshl_b32 s46, s40, 12
    s_add_u32 s46, s46, 0
    s_mov_b32 m0, s46
    s_add_u32 s46, s46, s45
    buffer_load_dwordx4 v1, s[4:7], s46 offen offset:0 sc1 lds
    buffer_load_dwordx4 v1, s[4:7], s46 offen offset:1024 sc1 lds
    buffer_load_dwordx4 v1, s[4:7], s46 offen offset:2048 sc1 lds
    buffer_load_dwordx4 v1, s[4:7], s46 offen offset:3072 sc1 lds
    s_lshl_b32 s46, s40, 12
    s_add_u32 s46, s46, 16384
    s_mov_b32 m0, s46
    s_add_u32 s46, s46, s45
    buffer_load_dwordx4 v1, s[4:7], s46 offen offset:0 sc1 lds
    buffer_load_dwordx4 v1, s[4:7], s46 offen offset:1024 sc1 lds
    buffer_load_dwordx4 v1, s[4:7], s46 offen offset:2048 sc1 lds
    buffer_load_dwordx4 v1, s[4:7], s46 offen offset:3072 sc1 lds
    s_lshl_b32 s46, s40, 12
    s_add_u32 s46, s46, 32768
    s_mov_b32 m0, s46
    s_add_u32 s46, s46, s45
    buffer_load_dwordx4 v1, s[4:7], s46 offen offset:0 sc1 lds
    buffer_load_dwordx4 v1, s[4:7], s46 offen offset:1024 sc1 lds
    buffer_load_dwordx4 v1, s[4:7], s46 offen offset:2048 sc1 lds
    buffer_load_dwordx4 v1, s[4:7], s46 offen offset:3072 sc1 lds
    s_lshl_b32 s46, s40, 12
    s_add_u32 s46, s46, 49152
    s_mov_b32 m0, s46
    s_add_u32 s46, s46, s45
    buffer_load_dwordx4 v1, s[4:7], s46 offen offset:0 sc1 lds
    buffer_load_dwordx4 v1, s[4:7], s46 offen offset:1024 sc1 lds
    buffer_load_dwordx4 v1, s[4:7], s46 offen offset:2048 sc1 lds
    buffer_load_dwordx4 v1, s[4:7], s46 offen offset:3072 sc1 lds
    s_lshl_b32 s46, s40, 11
    s_add_u32 s46, s46, 65536
    s_mov_b32 m0, s46
    s_add_u32 s46, s46, s45
    buffer_load_dwordx4 v1, s[4:7], s46 offen offset:0 sc1 lds
    buffer_load_dwordx4 v1, s[4:7], s46 offen offset:1024 sc1 lds
    v_lshrrev_b32 v146, 2, v0
    v_and_b32 v147, 3, v0
    v_lshlrev_b32 v147, 3, v147
    v_lshl_add_u32 v146, v146, 7, v147
    s_and_b32 s89, s94, 1
    s_lshl_b32 s89, s89, 11
    s_lshr_b32 s46, s94, 1
    s_lshl_b32 s46, s46, 5
    s_add_u32 s89, s89, s46
    s_add_u32 s89, s89, 5120
    ds_read_b128 v[104:107], v148 offset:0
    ds_read_b128 v[112:115], v148 offset:2048
    ds_read_b128 v[136:139], v62 offset:8192
    ds_read_b128 v[108:111], v149 offset:0
    ds_read_b128 v[116:119], v149 offset:2048
    ds_read_b128 v[140:143], v63 offset:8192
    s_waitcnt lgkmcnt(3)
    v_mfma_f32_16x16x32_bf16 v[16:19], v[40:43], v[104:107], 0
    v_mfma_f32_16x16x32_bf16 v[20:23], v[40:43], v[112:115], 0
    v_mfma_f32_16x16x32_bf16 v[24:27], v[152:155], v[104:107], 0
    v_mfma_f32_16x16x32_bf16 v[28:31], v[152:155], v[112:115], 0
    v_mfma_f32_16x16x32_bf16 v[32:35], v[48:51], v[136:139], 0
    s_waitcnt lgkmcnt(0)
    v_mfma_f32_16x16x32_bf16 v[16:19], v[44:47], v[108:111], v[16:19]
    v_mfma_f32_16x16x32_bf16 v[20:23], v[44:47], v[116:119], v[20:23]
    v_mfma_f32_16x16x32_bf16 v[24:27], v[156:159], v[108:111], v[24:27]
    v_mfma_f32_16x16x32_bf16 v[28:31], v[156:159], v[116:119], v[28:31]
    v_mfma_f32_16x16x32_bf16 v[32:35], v[52:55], v[140:143], v[32:35]
    s_waitcnt vmcnt(14)
    s_barrier
    s_mov_b64 exec, s[76:77]
    ds_read_b128 v[72:75], v57 offset:0
    s_mov_b64 exec, -1
    ds_read_b128 v[64:67], v150 offset:0
    ds_read_b128 v[68:71], v150 offset:1024
    s_mov_b64 exec, s[76:77]
    ds_read_b128 v[84:87], v57 offset:4096
    s_mov_b64 exec, -1
    ds_read_b128 v[76:79], v150 offset:4096
    ds_read_b128 v[80:83], v150 offset:5120
    s_waitcnt lgkmcnt(2)
    v_mfma_f32_16x16x32_bf16 v[16:19], a[0:3], v[64:67], v[16:19]
    s_mov_b64 exec, s[76:77]
    ds_read_b128 v[96:99], v57 offset:8192
    s_mov_b64 exec, -1
    v_mfma_f32_16x16x32_bf16 v[20:23], a[0:3], v[68:71], v[20:23]
    ds_read_b128 v[88:91], v150 offset:8192
    v_mfma_f32_16x16x32_bf16 v[24:27], a[72:75], v[64:67], v[24:27]
    ds_read_b128 v[92:95], v150 offset:9216
    v_mfma_f32_16x16x32_bf16 v[28:31], a[72:75], v[68:71], v[28:31]
    v_mfma_f32_16x16x32_bf16 v[32:35], a[168:171], v[72:75], v[32:35]
    s_waitcnt lgkmcnt(2)
    v_mfma_f32_16x16x32_bf16 v[16:19], a[4:7], v[76:79], v[16:19]
    s_mov_b64 exec, s[76:77]
    ds_read_b128 v[72:75], v57 offset:12288
    s_mov_b64 exec, -1
    v_mfma_f32_16x16x32_bf16 v[20:23], a[4:7], v[80:83], v[20:23]
    ds_read_b128 v[64:67], v150 offset:12288
    v_mfma_f32_16x16x32_bf16 v[24:27], a[76:79], v[76:79], v[24:27]
    ds_read_b128 v[68:71], v150 offset:13312
    v_mfma_f32_16x16x32_bf16 v[28:31], a[76:79], v[80:83], v[28:31]
    v_mfma_f32_16x16x32_bf16 v[32:35], a[172:175], v[84:87], v[32:35]
    s_waitcnt lgkmcnt(2)
    v_mfma_f32_16x16x32_bf16 v[16:19], a[8:11], v[88:91], v[16:19]
    s_waitcnt vmcnt(10)
    s_barrier
    v_mfma_f32_16x16x32_bf16 v[20:23], a[8:11], v[92:95], v[20:23]
    s_mov_b64 exec, s[76:77]
    ds_read_b128 v[84:87], v57 offset:16384
    s_mov_b64 exec, -1
    v_mfma_f32_16x16x32_bf16 v[24:27], a[80:83], v[88:91], v[24:27]
    ds_read_b128 v[76:79], v150 offset:16384
    v_mfma_f32_16x16x32_bf16 v[28:31], a[80:83], v[92:95], v[28:31]
    ds_read_b128 v[80:83], v150 offset:17408
    v_mfma_f32_16x16x32_bf16 v[32:35], a[176:179], v[96:99], v[32:35]
    s_waitcnt lgkmcnt(2)
    v_mfma_f32_16x16x32_bf16 v[16:19], a[12:15], v[64:67], v[16:19]
    s_mov_b64 exec, s[76:77]
    ds_read_b128 v[96:99], v57 offset:20480
    s_mov_b64 exec, -1
    v_mfma_f32_16x16x32_bf16 v[20:23], a[12:15], v[68:71], v[20:23]
    ds_read_b128 v[88:91], v150 offset:20480
    v_mfma_f32_16x16x32_bf16 v[24:27], a[84:87], v[64:67], v[24:27]
    ds_read_b128 v[92:95], v150 offset:21504
    v_mfma_f32_16x16x32_bf16 v[28:31], a[84:87], v[68:71], v[28:31]
    v_mfma_f32_16x16x32_bf16 v[32:35], a[180:183], v[72:75], v[32:35]
    s_waitcnt lgkmcnt(2)
    v_mfma_f32_16x16x32_bf16 v[16:19], a[16:19], v[76:79], v[16:19]
    s_mov_b64 exec, s[76:77]
    ds_read_b128 v[72:75], v57 offset:24576
    s_mov_b64 exec, -1
    v_mfma_f32_16x16x32_bf16 v[20:23], a[16:19], v[80:83], v[20:23]
    ds_read_b128 v[64:67], v150 offset:24576
    v_mfma_f32_16x16x32_bf16 v[24:27], a[88:91], v[76:79], v[24:27]
    ds_read_b128 v[68:71], v150 offset:25600
    v_mfma_f32_16x16x32_bf16 v[28:31], a[88:91], v[80:83], v[28:31]
    v_mfma_f32_16x16x32_bf16 v[32:35], a[184:187], v[84:87], v[32:35]
    s_waitcnt lgkmcnt(2)
    v_mfma_f32_16x16x32_bf16 v[16:19], a[20:23], v[88:91], v[16:19]
    s_mov_b64 exec, s[76:77]
    ds_read_b128 v[84:87], v57 offset:28672
    s_mov_b64 exec, -1
    v_mfma_f32_16x16x32_bf16 v[20:23], a[20:23], v[92:95], v[20:23]
    ds_read_b128 v[76:79], v150 offset:28672
    v_mfma_f32_16x16x32_bf16 v[24:27], a[92:95], v[88:91], v[24:27]
    ds_read_b128 v[80:83], v150 offset:29696
    v_mfma_f32_16x16x32_bf16 v[28:31], a[92:95], v[92:95], v[28:31]
    v_mfma_f32_16x16x32_bf16 v[32:35], a[188:191], v[96:99], v[32:35]
    s_waitcnt lgkmcnt(2)
    v_mfma_f32_16x16x32_bf16 v[16:19], a[24:27], v[64:67], v[16:19]
    s_waitcnt vmcnt(6)
    s_barrier
    v_mfma_f32_16x16x32_bf16 v[20:23], a[24:27], v[68:71], v[20:23]
    s_mov_b64 exec, s[76:77]
    ds_read_b128 v[96:99], v57 offset:32768
    s_mov_b64 exec, -1
    v_mfma_f32_16x16x32_bf16 v[24:27], a[96:99], v[64:67], v[24:27]
    ds_read_b128 v[88:91], v150 offset:32768
    v_mfma_f32_16x16x32_bf16 v[28:31], a[96:99], v[68:71], v[28:31]
    ds_read_b128 v[92:95], v150 offset:33792
    v_mfma_f32_16x16x32_bf16 v[32:35], a[192:195], v[72:75], v[32:35]
    s_waitcnt lgkmcnt(2)
    v_mfma_f32_16x16x32_bf16 v[16:19], a[28:31], v[76:79], v[16:19]
    s_mov_b64 exec, s[76:77]
    ds_read_b128 v[72:75], v57 offset:36864
    s_mov_b64 exec, -1
    v_mfma_f32_16x16x32_bf16 v[20:23], a[28:31], v[80:83], v[20:23]
    ds_read_b128 v[64:67], v150 offset:36864
    v_mfma_f32_16x16x32_bf16 v[24:27], a[100:103], v[76:79], v[24:27]
    ds_read_b128 v[68:71], v150 offset:37888
    v_mfma_f32_16x16x32_bf16 v[28:31], a[100:103], v[80:83], v[28:31]
    v_mfma_f32_16x16x32_bf16 v[32:35], a[196:199], v[84:87], v[32:35]
    s_waitcnt lgkmcnt(2)
    v_mfma_f32_16x16x32_bf16 v[16:19], a[32:35], v[88:91], v[16:19]
    s_mov_b64 exec, s[76:77]
    ds_read_b128 v[84:87], v57 offset:40960
    s_mov_b64 exec, -1
    v_mfma_f32_16x16x32_bf16 v[20:23], a[32:35], v[92:95], v[20:23]
    ds_read_b128 v[76:79], v150 offset:40960
    v_mfma_f32_16x16x32_bf16 v[24:27], a[104:107], v[88:91], v[24:27]
    ds_read_b128 v[80:83], v150 offset:41984
    v_mfma_f32_16x16x32_bf16 v[28:31], a[104:107], v[92:95], v[28:31]
    v_mfma_f32_16x16x32_bf16 v[32:35], a[200:203], v[96:99], v[32:35]
    s_waitcnt lgkmcnt(2)
    v_mfma_f32_16x16x32_bf16 v[16:19], a[36:39], v[64:67], v[16:19]
    s_mov_b64 exec, s[76:77]
    ds_read_b128 v[96:99], v57 offset:45056
    s_mov_b64 exec, -1
    v_mfma_f32_16x16x32_bf16 v[20:23], a[36:39], v[68:71], v[20:23]
    ds_read_b128 v[88:91], v150 offset:45056
    v_mfma_f32_16x16x32_bf16 v[24:27], a[108:111], v[64:67], v[24:27]
    ds_read_b128 v[92:95], v150 offset:46080
    v_mfma_f32_16x16x32_bf16 v[28:31], a[108:111], v[68:71], v[28:31]
    buffer_load_dwordx2 v[144:145], v146, s[4:7], s89 offen sc1
    v_mfma_f32_16x16x32_bf16 v[32:35], a[204:207], v[72:75], v[32:35]
    s_waitcnt lgkmcnt(2)
    v_mfma_f32_16x16x32_bf16 v[16:19], a[40:43], v[76:79], v[16:19]
    s_waitcnt vmcnt(3)
    s_barrier
    v_mfma_f32_16x16x32_bf16 v[20:23], a[40:43], v[80:83], v[20:23]
    s_mov_b64 exec, s[76:77]
    ds_read_b128 v[72:75], v57 offset:49152
    s_mov_b64 exec, -1
    v_mfma_f32_16x16x32_bf16 v[24:27], a[112:115], v[76:79], v[24:27]
    ds_read_b128 v[64:67], v150 offset:49152
    v_mfma_f32_16x16x32_bf16 v[28:31], a[112:115], v[80:83], v[28:31]
    ds_read_b128 v[68:71], v150 offset:50176
    v_mfma_f32_16x16x32_bf16 v[32:35], a[208:211], v[84:87], v[32:35]
    s_waitcnt lgkmcnt(2)
    v_mfma_f32_16x16x32_bf16 v[16:19], a[44:47], v[88:91], v[16:19]
    s_mov_b64 exec, s[76:77]
    ds_read_b128 v[84:87], v57 offset:53248
    s_mov_b64 exec, -1
    v_mfma_f32_16x16x32_bf16 v[20:23], a[44:47], v[92:95], v[20:23]
    ds_read_b128 v[76:79], v150 offset:53248
    v_mfma_f32_16x16x32_bf16 v[24:27], a[116:119], v[88:91], v[24:27]
    ds_read_b128 v[80:83], v150 offset:54272
    v_mfma_f32_16x16x32_bf16 v[28:31], a[116:119], v[92:95], v[28:31]
    v_mfma_f32_16x16x32_bf16 v[32:35], a[212:215], v[96:99], v[32:35]
    s_waitcnt lgkmcnt(2)
    v_mfma_f32_16x16x32_bf16 v[16:19], a[48:51], v[64:67], v[16:19]
    s_mov_b64 exec, s[76:77]
    ds_read_b128 v[96:99], v57 offset:57344
    s_mov_b64 exec, -1
    v_mfma_f32_16x16x32_bf16 v[20:23], a[48:51], v[68:71], v[20:23]
    ds_read_b128 v[88:91], v150 offset:57344
    v_mfma_f32_16x16x32_bf16 v[24:27], a[120:123], v[64:67], v[24:27]
    ds_read_b128 v[92:95], v150 offset:58368
    v_mfma_f32_16x16x32_bf16 v[28:31], a[120:123], v[68:71], v[28:31]
    v_mfma_f32_16x16x32_bf16 v[32:35], a[216:219], v[72:75], v[32:35]
    s_waitcnt lgkmcnt(2)
    v_mfma_f32_16x16x32_bf16 v[16:19], a[52:55], v[76:79], v[16:19]
    s_mov_b64 exec, s[76:77]
    ds_read_b128 v[72:75], v57 offset:61440
    s_mov_b64 exec, -1
    v_mfma_f32_16x16x32_bf16 v[20:23], a[52:55], v[80:83], v[20:23]
    ds_read_b128 v[64:67], v150 offset:61440
    v_mfma_f32_16x16x32_bf16 v[24:27], a[124:127], v[76:79], v[24:27]
    ds_read_b128 v[68:71], v150 offset:62464
    v_mfma_f32_16x16x32_bf16 v[28:31], a[124:127], v[80:83], v[28:31]
    v_mfma_f32_16x16x32_bf16 v[32:35], a[220:223], v[84:87], v[32:35]
    s_waitcnt lgkmcnt(2)
    v_mfma_f32_16x16x32_bf16 v[16:19], a[56:59], v[88:91], v[16:19]
    s_waitcnt vmcnt(1)
    s_barrier
    v_mfma_f32_16x16x32_bf16 v[20:23], a[56:59], v[92:95], v[20:23]
    s_mov_b64 exec, s[76:77]
    ds_read_b128 v[84:87], v59 offset:0
    s_mov_b64 exec, -1
    v_mfma_f32_16x16x32_bf16 v[24:27], a[128:131], v[88:91], v[24:27]
    ds_read_b128 v[76:79], v151 offset:0
    v_mfma_f32_16x16x32_bf16 v[28:31], a[128:131], v[92:95], v[28:31]
    ds_read_b128 v[80:83], v151 offset:1024
    v_mfma_f32_16x16x32_bf16 v[32:35], a[224:227], v[96:99], v[32:35]
    s_waitcnt lgkmcnt(2)
    v_mfma_f32_16x16x32_bf16 v[16:19], a[60:63], v[64:67], v[16:19]
    s_mov_b64 exec, s[76:77]
    ds_read_b128 v[96:99], v59 offset:4096
    s_mov_b64 exec, -1
    v_mfma_f32_16x16x32_bf16 v[20:23], a[60:63], v[68:71], v[20:23]
    ds_read_b128 v[88:91], v151 offset:4096
    v_mfma_f32_16x16x32_bf16 v[24:27], a[132:135], v[64:67], v[24:27]
    ds_read_b128 v[92:95], v151 offset:5120
    v_mfma_f32_16x16x32_bf16 v[28:31], a[132:135], v[68:71], v[28:31]
    v_mfma_f32_16x16x32_bf16 v[32:35], a[228:231], v[72:75], v[32:35]
    s_waitcnt lgkmcnt(2)
    v_mfma_f32_16x16x32_bf16 v[16:19], a[64:67], v[76:79], v[16:19]
    v_mfma_f32_16x16x32_bf16 v[20:23], a[64:67], v[80:83], v[20:23]
    v_mfma_f32_16x16x32_bf16 v[24:27], a[136:139], v[76:79], v[24:27]
    v_mfma_f32_16x16x32_bf16 v[28:31], a[136:139], v[80:83], v[28:31]
    v_mfma_f32_16x16x32_bf16 v[32:35], a[232:235], v[84:87], v[32:35]
    s_waitcnt lgkmcnt(0)
    v_mfma_f32_16x16x32_bf16 v[16:19], a[68:71], v[88:91], v[16:19]
    v_mfma_f32_16x16x32_bf16 v[20:23], a[68:71], v[92:95], v[20:23]
    v_mfma_f32_16x16x32_bf16 v[24:27], a[140:143], v[88:91], v[24:27]
    v_mfma_f32_16x16x32_bf16 v[28:31], a[140:143], v[92:95], v[28:31]
    v_mfma_f32_16x16x32_bf16 v[32:35], a[236:239], v[96:99], v[32:35]
    s_waitcnt vmcnt(0)
    v_and_b32 v144, v144, v145
    v_cmp_ne_u32 vcc, 1, v144
    s_cbranch_vccz ok_47
    s_mov_b32 s52, 0
poll_48:
    buffer_load_dwordx2 v[144:145], v146, s[4:7], s89 offen sc1
    s_waitcnt vmcnt(0)
    v_and_b32 v144, v144, v145
    v_cmp_ne_u32 vcc, 1, v144
    s_cbranch_vccz pdone_49
    s_add_u32 s52, s52, 1
    s_cmp_lt_u32 s52, 20000
    s_cbranch_scc1 poll_48
pdone_49:
ok_47:
    s_mul_i32 s44, s84, 73728
    s_add_u32 s44, s44, 4718592
    s_and_b32 s46, s85, 1
    s_add_u32 s46, s46, 16
    s_lshl_b32 s46, s46, 2
    s_lshr_b32 s47, s85, 1
    s_add_u32 s46, s46, s47
    s_lshl_b32 s46, s46, 10
    s_lshl_b32 s47, s40, 9
    s_add_u32 s46, s46, s47
    s_add_u32 s45, s46, s44
    s_lshl_b32 s46, s85, 1
    s_and_b32 s47, s40, 1
    s_add_u32 s46, s46, s47
    s_lshl_b32 s46, s46, 12
    s_lshr_b32 s47, s40, 1
    s_lshl_b32 s47, s47, 11
    s_add_u32 s46, s46, s47
    s_add_u32 s44, s44, s46
    v_lshrrev_b32 v56, 1, v3
    v_lshlrev_b32 v56, 8, v56
    v_lshl_add_u32 v56, v2, 4, v56
    v_and_b32 v57, 1, v3
    v_lshl_add_u32 v4, v57, 10, v56
    v_lshl_add_u32 v5, v57, 3, v56
    s_lshl_b32 s48, s84, 3
    s_add_u32 s48, s48, s85
    s_lshl_b32 s48, s48, 2
    s_add_u32 s48, s48, s40
    s_lshl_b32 s48, s48, 2
    s_add_u32 s48, s48, 9216
    v_cvt_pk_bf16_f32 v40, v16, v17
    v_cvt_pk_bf16_f32 v41, v18, v19
    v_cvt_pk_bf16_f32 v42, v20, v21
    v_cvt_pk_bf16_f32 v43, v22, v23
    s_nop 0
    v_permlane16_swap_b32 v40, v42
    v_permlane16_swap_b32 v41, v43
    buffer_store_dwordx4 v[40:43], v4, s[4:7], s44 offen offset:0 sc1
    v_cvt_pk_bf16_f32 v44, v24, v25
    v_cvt_pk_bf16_f32 v45, v26, v27
    v_cvt_pk_bf16_f32 v46, v28, v29
    v_cvt_pk_bf16_f32 v47, v30, v31
    s_nop 0
    v_permlane16_swap_b32 v44, v46
    v_permlane16_swap_b32 v45, v47
    buffer_store_dwordx4 v[44:47], v4, s[4:7], s44 offen offset:512 sc1
    v_cvt_pk_bf16_f32 v48, v32, v33
    v_cvt_pk_bf16_f32 v49, v34, v35
    s_cmp_ge_u32 s40, 2
    s_cbranch_scc1 nx_50
    buffer_store_dwordx2 v[48:49], v5, s[4:7], s45 offen sc1
nx_50:
    s_add_u32 s86, s87, 0
    buffer_load_dwordx4 a[0:3], v1, s[4:7], s86 offen offset:0 sc1
    buffer_load_dwordx4 a[4:7], v1, s[4:7], s86 offen offset:1024 sc1
    buffer_load_dwordx4 a[8:11], v1, s[4:7], s86 offen offset:2048 sc1
    buffer_load_dwordx4 a[12:15], v1, s[4:7], s86 offen offset:3072 sc1
    s_add_u32 s86, s87, 4096
    buffer_load_dwordx4 a[16:19], v1, s[4:7], s86 offen offset:0 sc1
    buffer_load_dwordx4 a[20:23], v1, s[4:7], s86 offen offset:1024 sc1
    buffer_load_dwordx4 a[24:27], v1, s[4:7], s86 offen offset:2048 sc1
    buffer_load_dwordx4 a[28:31], v1, s[4:7], s86 offen offset:3072 sc1
    s_waitcnt vmcnt(8)
    s_mov_b64 exec, 1
    buffer_store_dword v14, v6, s[4:7], s48 offen sc1
    s_mov_b64 exec, -1
    s_add_u32 s86, s87, 8192
    buffer_load_dwordx4 a[32:35], v1, s[4:7], s86 offen offset:0 sc1
    buffer_load_dwordx4 a[36:39], v1, s[4:7], s86 offen offset:1024 sc1
    buffer_load_dwordx4 a[40:43], v1, s[4:7], s86 offen offset:2048 sc1
    buffer_load_dwordx4 a[44:47], v1, s[4:7], s86 offen offset:3072 sc1
    s_add_u32 s86, s87, 12288
    buffer_load_dwordx4 a[48:51], v1, s[4:7], s86 offen offset:0 sc1
    buffer_load_dwordx4 a[52:55], v1, s[4:7], s86 offen offset:1024 sc1
    buffer_load_dwordx4 a[56:59], v1, s[4:7], s86 offen offset:2048 sc1
    buffer_load_dwordx4 a[60:63], v1, s[4:7], s86 offen offset:3072 sc1
    s_add_u32 s86, s87, 16384
    buffer_load_dwordx4 a[64:67], v1, s[4:7], s86 offen offset:0 sc1
    buffer_load_dwordx4 a[68:71], v1, s[4:7], s86 offen offset:1024 sc1
    buffer_load_dwordx4 a[72:75], v1, s[4:7], s86 offen offset:2048 sc1
    buffer_load_dwordx4 a[76:79], v1, s[4:7], s86 offen offset:3072 sc1
    s_add_u32 s86, s87, 20480
    buffer_load_dwordx4 a[80:83], v1, s[4:7], s86 offen offset:0 sc1
    buffer_load_dwordx4 a[84:87], v1, s[4:7], s86 offen offset:1024 sc1
    buffer_load_dwordx4 a[88:91], v1, s[4:7], s86 offen offset:2048 sc1
    buffer_load_dwordx4 a[92:95], v1, s[4:7], s86 offen offset:3072 sc1
    s_add_u32 s86, s87, 24576
    buffer_load_dwordx4 a[96:99], v1, s[4:7], s86 offen offset:0 sc1
    buffer_load_dwordx4 a[100:103], v1, s[4:7], s86 offen offset:1024 sc1
    buffer_load_dwordx4 a[104:107], v1, s[4:7], s86 offen offset:2048 sc1
    buffer_load_dwordx4 a[108:111], v1, s[4:7], s86 offen offset:3072 sc1
    s_add_u32 s86, s87, 28672
    buffer_load_dwordx4 a[112:115], v1, s[4:7], s86 offen offset:0 sc1
    buffer_load_dwordx4 a[116:119], v1, s[4:7], s86 offen offset:1024 sc1
    buffer_load_dwordx4 a[120:123], v1, s[4:7], s86 offen offset:2048 sc1
    buffer_load_dwordx4 a[124:127], v1, s[4:7], s86 offen offset:3072 sc1
    s_add_u32 s86, s87, 32768
    buffer_load_dwordx4 a[128:131], v1, s[4:7], s86 offen offset:0 sc1
    buffer_load_dwordx4 a[132:135], v1, s[4:7], s86 offen offset:1024 sc1
    buffer_load_dwordx4 a[136:139], v1, s[4:7], s86 offen offset:2048 sc1
    buffer_load_dwordx4 a[140:143], v1, s[4:7], s86 offen offset:3072 sc1
    s_lshl_b32 s44, s95, 7
    s_add_u32 s44, s44, 9216
    s_mul_i32 s48, s95, 73728
    s_lshl_b32 s45, s40, 10
    s_add_u32 s48, s48, s45
    s_add_u32 s48, s48, 4718592
    v_and_b32 v56, 31, v0
    v_lshlrev_b32 v56, 2, v56
    v_lshlrev_b32 v57, 2, v3
    v_sub_u32 v57, v2, v57
    v_and_b32 v58, 1, v57
    v_lshlrev_b32 v58, 4, v58
    v_mov_b32 v59, 0x3f80
    v_lshlrev_b32 v58, v58, v59
    v_lshrrev_b32 v57, 1, v57
    v_cmp_eq_u32 vcc, 0, v57
    s_nop 1
    v_cndmask_b32 v208, 0, v58, vcc
    v_cmp_eq_u32 vcc, 1, v57
    s_nop 1
    v_cndmask_b32 v209, 0, v58, vcc
    v_add_u32 v210, 0x10000, v1
    v_add_u32 v211, 73728, v1
    v_add_u32 v212, 139264, v1
    s_lshl_b32 s46, s40, 12
    v_add_u32 v213, s46, v211
    s_lshr_b32 s46, s40, 1
    s_lshl_b32 s47, s46, 12
    s_and_b32 s89, s40, 1
    s_lshl_b32 s49, s89, 3
    s_add_u32 s47, s47, s49
    v_add_u32 v214, s47, v212
    s_lshl_b32 s46, s46, 10
    s_lshl_b32 s89, s89, 8
    s_add_u32 s89, s89, s46
    s_lshl_b32 s46, s94, 13
    s_add_u32 s89, s89, s46
    s_add_u32 s89, s89, 19922944
    s_mul_i32 s88, s95, 9
    s_lshl_b32 s49, s94, 2
    s_add_u32 s49, s49, s40
    s_lshl_b32 s49, s49, 2
    s_add_u32 s49, s49, 13312
    v_and_b32 v57, 1, v3
    v_lshrrev_b32 v58, 1, v3
    v_lshlrev_b32 v58, 9, v58
    v_lshl_add_u32 v58, v57, 11, v58
    v_lshl_add_u32 v215, v2, 4, v58
    v_add_u32 v216, 0x1000, v215
    v_add_u32 v8, s45, v1
    v_add_u32 v9, 0x10000, v8
    v_add_u32 v217, 147456, v8
    s_lshl_b32 s46, s95, 6
    s_lshl_b32 s47, s40, 4
    s_add_u32 s46, s46, s47
    v_add_u32 v7, s46, v2
    s_movk_i32 s46, 1152
    v_mul_u32_u24 v7, s46, v7
    v_lshl_add_u32 v7, v3, 5, v7
    v_mov_b32 v92, 0x3f803f80
    v_mov_b32 v93, 0x3f803f80
    v_mov_b32 v94, 0x3f803f80
    v_mov_b32 v95, 0x3f803f80
    s_cmp_lg_u32 s40, 0
    s_cbranch_scc1 p1_51
    s_mov_b32 s52, 0
poll_52:
    buffer_load_dword v60, v56, s[4:7], s44 offen sc1
    s_waitcnt vmcnt(0)
    v_cmp_ne_u32 vcc, 1, v60
    s_cbranch_vccz pdone_53
    s_add_u32 s52, s52, 1
    s_cmp_lt_u32 s52, 20000
    s_cbranch_scc1 poll_52
pdone_53:
p1_51:
    s_barrier
    s_mov_b32 s44, s48
    buffer_load_dwordx4 v[16:19], v1, s[4:7], s44 offen sc1
    s_add_u32 s44, s44, 4096
    buffer_load_dwordx4 v[20:23], v1, s[4:7], s44 offen sc1
    s_add_u32 s44, s44, 4096
    buffer_load_dwordx4 v[24:27], v1, s[4:7], s44 offen sc1
    s_add_u32 s44, s44, 4096
    buffer_load_dwordx4 v[28:31], v1, s[4:7], s44 offen sc1
    s_add_u32 s44, s44, 4096
    buffer_load_dwordx4 v[32:35], v1, s[4:7], s44 offen sc1
    s_add_u32 s44, s44, 4096
    buffer_load_dwordx4 v[36:39], v1, s[4:7], s44 offen sc1
    s_add_u32 s44, s44, 4096
    buffer_load_dwordx4 v[40:43], v1, s[4:7], s44 offen sc1
    s_add_u32 s44, s44, 4096
    buffer_load_dwordx4 v[44:47], v1, s[4:7], s44 offen sc1
    s_add_u32 s44, s44, 4096
    buffer_load_dwordx4 v[48:51], v1, s[4:7], s44 offen sc1
    s_add_u32 s44, s44, 4096
    buffer_load_dwordx4 v[52:55], v1, s[4:7], s44 offen sc1
    s_add_u32 s44, s44, 4096
    buffer_load_dwordx4 v[56:59], v1, s[4:7], s44 offen sc1
    s_add_u32 s44, s44, 4096
    buffer_load_dwordx4 v[60:63], v1, s[4:7], s44 offen sc1
    s_add_u32 s44, s44, 4096
    buffer_load_dwordx4 v[64:67], v1, s[4:7], s44 offen sc1
    s_add_u32 s44, s44, 4096
    buffer_load_dwordx4 v[68:71], v1, s[4:7], s44 offen sc1
    s_add_u32 s44, s44, 4096
    buffer_load_dwordx4 v[72:75], v1, s[4:7], s44 offen sc1
    s_add_u32 s44, s44, 4096
    buffer_load_dwordx4 v[76:79], v1, s[4:7], s44 offen sc1
    s_add_u32 s44, s44, 4096
    buffer_load_dwordx4 v[80:83], v1, s[4:7], s44 offen sc1
    s_add_u32 s44, s44, 4096
    buffer_load_dwordx4 v[84:87], v1, s[4:7], s44 offen sc1
    s_add_u32 s86, s87, 36864
    buffer_load_dwordx4 a[144:147], v1, s[4:7], s86 offen offset:0 sc1
    buffer_load_dwordx4 a[148:151], v1, s[4:7], s86 offen offset:1024 sc1
    buffer_load_dwordx4 a[152:155], v1, s[4:7], s86 offen offset:2048 sc1
    buffer_load_dwordx4 a[156:159], v1, s[4:7], s86 offen offset:3072 sc1
    s_waitcnt vmcnt(21)
    v_mfma_f32_16x16x32_bf16 v[88:91], v[92:95], v[16:19], 0
    s_waitcnt vmcnt(20)
    v_mfma_f32_16x16x32_bf16 v[88:91], v[92:95], v[20:23], v[88:91]
    s_waitcnt vmcnt(19)
    v_mfma_f32_16x16x32_bf16 v[88:91], v[92:95], v[24:27], v[88:91]
    s_waitcnt vmcnt(18)
    v_mfma_f32_16x16x32_bf16 v[88:91], v[92:95], v[28:31], v[88:91]
    s_waitcnt vmcnt(17)
    v_mfma_f32_16x16x32_bf16 v[88:91], v[92:95], v[32:35], v[88:91]
    s_waitcnt vmcnt(16)
    v_mfma_f32_16x16x32_bf16 v[88:91], v[92:95], v[36:39], v[88:91]
    s_waitcnt vmcnt(15)
    v_mfma_f32_16x16x32_bf16 v[88:91], v[92:95], v[40:43], v[88:91]
    s_waitcnt vmcnt(14)
    v_mfma_f32_16x16x32_bf16 v[88:91], v[92:95], v[44:47], v[88:91]
    s_waitcnt vmcnt(13)
    v_mfma_f32_16x16x32_bf16 v[88:91], v[92:95], v[48:51], v[88:91]
    s_waitcnt vmcnt(12)
    v_mfma_f32_16x16x32_bf16 v[88:91], v[92:95], v[52:55], v[88:91]
    s_waitcnt vmcnt(11)
    v_mfma_f32_16x16x32_bf16 v[88:91], v[92:95], v[56:59], v[88:91]
    s_waitcnt vmcnt(10)
    v_mfma_f32_16x16x32_bf16 v[88:91], v[92:95], v[60:63], v[88:91]
    s_waitcnt vmcnt(9)
    v_mfma_f32_16x16x32_bf16 v[88:91], v[92:95], v[64:67], v[88:91]
    s_waitcnt vmcnt(8)
    v_mfma_f32_16x16x32_bf16 v[88:91], v[92:95], v[68:71], v[88:91]
    s_waitcnt vmcnt(7)
    v_mfma_f32_16x16x32_bf16 v[88:91], v[92:95], v[72:75], v[88:91]
    s_waitcnt vmcnt(6)
    v_mfma_f32_16x16x32_bf16 v[88:91], v[92:95], v[76:79], v[88:91]
    s_waitcnt vmcnt(5)
    v_mfma_f32_16x16x32_bf16 v[88:91], v[92:95], v[80:83], v[88:91]
    s_waitcnt vmcnt(4)
    v_mfma_f32_16x16x32_bf16 v[88:91], v[92:95], v[84:87], v[88:91]
    s_nop 7
    v_mul_f32 v88, s78, v88
    v_mul_f32 v89, s78, v89
    v_mul_f32 v90, s78, v90
    v_mul_f32 v91, s78, v91
    s_nop 1
    v_mfma_f32_16x16x16_bf16 v[96:99], v[208:209], v[16:17], v[88:91]
    v_mfma_f32_16x16x16_bf16 v[100:103], v[208:209], v[18:19], v[88:91]
    s_add_u32 s86, s87, 40960
    buffer_load_dwordx4 a[160:163], v1, s[4:7], s86 offen offset:0 sc1
    buffer_load_dwordx4 a[164:167], v1, s[4:7], s86 offen offset:1024 sc1
    v_mfma_f32_16x16x16_bf16 v[104:107], v[208:209], v[20:21], v[88:91]
    v_mfma_f32_16x16x16_bf16 v[108:111], v[208:209], v[22:23], v[88:91]
    buffer_load_dwordx4 a[168:171], v1, s[4:7], s86 offen offset:2048 sc1
    buffer_load_dwordx4 a[172:175], v1, s[4:7], s86 offen offset:3072 sc1
    v_cvt_pk_bf16_f32 v128, v96, v97
    v_cvt_pk_bf16_f32 v129, v98, v99
    v_cvt_pk_bf16_f32 v130, v100, v101
    v_cvt_pk_bf16_f32 v131, v102, v103
    ds_write_b128 v8, v[128:131] offset:0
    v_mfma_f32_16x16x16_bf16 v[112:115], v[208:209], v[24:25], v[88:91]
    v_mfma_f32_16x16x16_bf16 v[116:119], v[208:209], v[26:27], v[88:91]
    s_add_u32 s86, s87, 45056
    buffer_load_dwordx4 a[176:179], v1, s[4:7], s86 offen offset:0 sc1
    v_mfma_f32_16x16x32_bf16 v[220:223], v[128:131], v[128:131], 0
    v_cvt_pk_bf16_f32 v132, v104, v105
    v_cvt_pk_bf16_f32 v133, v106, v107
    v_cvt_pk_bf16_f32 v134, v108, v109
    v_cvt_pk_bf16_f32 v135, v110, v111
    ds_write_b128 v8, v[132:135] offset:4096
    v_mfma_f32_16x16x16_bf16 v[96:99], v[208:209], v[28:29], v[88:91]
    v_mfma_f32_16x16x16_bf16 v[100:103], v[208:209], v[30:31], v[88:91]
    buffer_load_dwordx4 a[180:183], v1, s[4:7], s86 offen offset:1024 sc1
    v_mfma_f32_16x16x32_bf16 v[220:223], v[132:135], v[132:135], v[220:223]
    v_cvt_pk_bf16_f32 v136, v112, v113
    v_cvt_pk_bf16_f32 v137, v114, v115
    v_cvt_pk_bf16_f32 v138, v116, v117
    v_cvt_pk_bf16_f32 v139, v118, v119
    ds_write_b128 v8, v[136:139] offset:8192
    v_mfma_f32_16x16x16_bf16 v[104:107], v[208:209], v[32:33], v[88:91]
    v_mfma_f32_16x16x16_bf16 v[108:111], v[208:209], v[34:35], v[88:91]
    buffer_load_dwordx4 a[184:187], v1, s[4:7], s86 offen offset:2048 sc1
    v_mfma_f32_16x16x32_bf16 v[220:223], v[136:139], v[136:139], v[220:223]
    v_cvt_pk_bf16_f32 v140, v96, v97
    v_cvt_pk_bf16_f32 v141, v98, v99
    v_cvt_pk_bf16_f32 v142, v100, v101
    v_cvt_pk_bf16_f32 v143, v102, v103
    ds_write_b128 v8, v[140:143] offset:12288
    v_mfma_f32_16x16x16_bf16 v[112:115], v[208:209], v[36:37], v[88:91]
    v_mfma_f32_16x16x16_bf16 v[116:119], v[208:209], v[38:39], v[88:91]
    buffer_load_dwordx4 a[188:191], v1, s[4:7], s86 offen offset:3072 sc1
    v_mfma_f32_16x16x32_bf16 v[220:223], v[140:143], v[140:143], v[220:223]
    v_cvt_pk_bf16_f32 v128, v104, v105
    v_cvt_pk_bf16_f32 v129, v106, v107
    v_cvt_pk_bf16_f32 v130, v108, v109
    v_cvt_pk_bf16_f32 v131, v110, v111
    ds_write_b128 v8, v[128:131] offset:16384
    v_mfma_f32_16x16x16_bf16 v[96:99], v[208:209], v[40:41], v[88:91]
    v_mfma_f32_16x16x16_bf16 v[100:103], v[208:209], v[42:43], v[88:91]
    s_add_u32 s86, s87, 49152
    buffer_load_dwordx4 a[192:195], v1, s[4:7], s86 offen offset:0 sc1
    v_mfma_f32_16x16x32_bf16 v[220:223], v[128:131], v[128:131], v[220:223]
    v_cvt_pk_bf16_f32 v132, v112, v113
    v_cvt_pk_bf16_f32 v133, v114, v115
    v_cvt_pk_bf16_f32 v134, v116, v117
    v_cvt_pk_bf16_f32 v135, v118, v119
    ds_write_b128 v8, v[132:135] offset:20480
    v_mfma_f32_16x16x16_bf16 v[104:107], v[208:209], v[44:45], v[88:91]
    v_mfma_f32_16x16x16_bf16 v[108:111], v[208:209], v[46:47], v[88:91]
    buffer_load_dwordx4 a[196:199], v1, s[4:7], s86 offen offset:1024 sc1
    v_mfma_f32_16x16x32_bf16 v[220:223], v[132:135], v[132:135], v[220:223]
    v_cvt_pk_bf16_f32 v136, v96, v97
    v_cvt_pk_bf16_f32 v137, v98, v99
    v_cvt_pk_bf16_f32 v138, v100, v101
    v_cvt_pk_bf16_f32 v139, v102, v103
    ds_write_b128 v8, v[136:139] offset:24576
    v_mfma_f32_16x16x16_bf16 v[112:115], v[208:209], v[48:49], v[88:91]
    v_mfma_f32_16x16x16_bf16 v[116:119], v[208:209], v[50:51], v[88:91]
    buffer_load_dwordx4 a[200:203], v1, s[4:7], s86 offen offset:2048 sc1
    v_mfma_f32_16x16x32_bf16 v[220:223], v[136:139], v[136:139], v[220:223]
    v_cvt_pk_bf16_f32 v140, v104, v105
    v_cvt_pk_bf16_f32 v141, v106, v107
    v_cvt_pk_bf16_f32 v142, v108, v109
    v_cvt_pk_bf16_f32 v143, v110, v111
    ds_write_b128 v8, v[140:143] offset:28672
    v_mfma_f32_16x16x16_bf16 v[96:99], v[208:209], v[52:53], v[88:91]
    v_mfma_f32_16x16x16_bf16 v[100:103], v[208:209], v[54:55], v[88:91]
    buffer_load_dwordx4 a[204:207], v1, s[4:7], s86 offen offset:3072 sc1
    v_mfma_f32_16x16x32_bf16 v[220:223], v[140:143], v[140:143], v[220:223]
    v_cvt_pk_bf16_f32 v128, v112, v113
    v_cvt_pk_bf16_f32 v129, v114, v115
    v_cvt_pk_bf16_f32 v130, v116, v117
    v_cvt_pk_bf16_f32 v131, v118, v119
    ds_write_b128 v8, v[128:131] offset:32768
    v_mfma_f32_16x16x16_bf16 v[104:107], v[208:209], v[56:57], v[88:91]
    v_mfma_f32_16x16x16_bf16 v[108:111], v[208:209], v[58:59], v[88:91]
    s_add_u32 s86, s87, 53248
    buffer_load_dwordx4 a[208:211], v1, s[4:7], s86 offen offset:0 sc1
    v_mfma_f32_16x16x32_bf16 v[220:223], v[128:131], v[128:131], v[220:223]
    v_cvt_pk_bf16_f32 v132, v96, v97
    v_cvt_pk_bf16_f32 v133, v98, v99
    v_cvt_pk_bf16_f32 v134, v100, v101
    v_cvt_pk_bf16_f32 v135, v102, v103
    ds_write_b128 v8, v[132:135] offset:36864
    v_mfma_f32_16x16x16_bf16 v[112:115], v[208:209], v[60:61], v[88:91]
    v_mfma_f32_16x16x16_bf16 v[116:119], v[208:209], v[62:63], v[88:91]
    buffer_load_dwordx4 a[212:215], v1, s[4:7], s86 offen offset:1024 sc1
    v_mfma_f32_16x16x32_bf16 v[220:223], v[132:135], v[132:135], v[220:223]
    v_cvt_pk_bf16_f32 v136, v104, v105
    v_cvt_pk_bf16_f32 v137, v106, v107
    v_cvt_pk_bf16_f32 v138, v108, v109
    v_cvt_pk_bf16_f32 v139, v110, v111
    ds_write_b128 v8, v[136:139] offset:40960
    v_mfma_f32_16x16x16_bf16 v[96:99], v[208:209], v[64:65], v[88:91]
    v_mfma_f32_16x16x16_bf16 v[100:103], v[208:209], v[66:67], v[88:91]
    buffer_load_dwordx4 a[216:219], v1, s[4:7], s86 offen offset:2048 sc1
    v_mfma_f32_16x16x32_bf16 v[220:223], v[136:139], v[136:139], v[220:223]
    v_cvt_pk_bf16_f32 v140, v112, v113
    v_cvt_pk_bf16_f32 v141, v114, v115
    v_cvt_pk_bf16_f32 v142, v116, v117
    v_cvt_pk_bf16_f32 v143, v118, v119
    ds_write_b128 v8, v[140:143] offset:45056
    v_mfma_f32_16x16x16_bf16 v[104:107], v[208:209], v[68:69], v[88:91]
    v_mfma_f32_16x16x16_bf16 v[108:111], v[208:209], v[70:71], v[88:91]
    buffer_load_dwordx4 a[220:223], v1, s[4:7], s86 offen offset:3072 sc1
    v_mfma_f32_16x16x32_bf16 v[220:223], v[140:143], v[140:143], v[220:223]
    v_cvt_pk_bf16_f32 v128, v96, v97
    v_cvt_pk_bf16_f32 v129, v98, v99
    v_cvt_pk_bf16_f32 v130, v100, v101
    v_cvt_pk_bf16_f32 v131, v102, v103
    ds_write_b128 v8, v[128:131] offset:49152
    v_mfma_f32_16x16x16_bf16 v[112:115], v[208:209], v[72:73], v[88:91]
    v_mfma_f32_16x16x16_bf16 v[116:119], v[208:209], v[74:75], v[88:91]
    s_add_u32 s86, s87, 57344
    buffer_load_dwordx4 a[224:227], v1, s[4:7], s86 offen offset:0 sc1
    v_mfma_f32_16x16x32_bf16 v[220:223], v[128:131], v[128:131], v[220:223]
    v_cvt_pk_bf16_f32 v132, v104, v105
    v_cvt_pk_bf16_f32 v133, v106, v107
    v_cvt_pk_bf16_f32 v134, v108, v109
    v_cvt_pk_bf16_f32 v135, v110, v111
    ds_write_b128 v8, v[132:135] offset:53248
    v_mfma_f32_16x16x16_bf16 v[96:99], v[208:209], v[76:77], v[88:91]
    v_mfma_f32_16x16x16_bf16 v[100:103], v[208:209], v[78:79], v[88:91]
    buffer_load_dwordx4 a[228:231], v1, s[4:7], s86 offen offset:1024 sc1
    v_mfma_f32_16x16x32_bf16 v[220:223], v[132:135], v[132:135], v[220:223]
    v_cvt_pk_bf16_f32 v136, v112, v113
    v_cvt_pk_bf16_f32 v137, v114, v115
    v_cvt_pk_bf16_f32 v138, v116, v117
    v_cvt_pk_bf16_f32 v139, v118, v119
    ds_write_b128 v8, v[136:139] offset:57344
    v_mfma_f32_16x16x16_bf16 v[104:107], v[208:209], v[80:81], v[88:91]
    v_mfma_f32_16x16x16_bf16 v[108:111], v[208:209], v[82:83], v[88:91]
    buffer_load_dwordx4 a[232:235], v1, s[4:7], s86 offen offset:2048 sc1
    v_mfma_f32_16x16x32_bf16 v[220:223], v[136:139], v[136:139], v[220:223]
    v_cvt_pk_bf16_f32 v140, v96, v97
    v_cvt_pk_bf16_f32 v141, v98, v99
    v_cvt_pk_bf16_f32 v142, v100, v101
    v_cvt_pk_bf16_f32 v143, v102, v103
    ds_write_b128 v8, v[140:143] offset:61440
    v_mfma_f32_16x16x16_bf16 v[112:115], v[208:209], v[84:85], v[88:91]
    v_mfma_f32_16x16x16_bf16 v[116:119], v[208:209], v[86:87], v[88:91]
    buffer_load_dwordx4 a[236:239], v1, s[4:7], s86 offen offset:3072 sc1
    v_mfma_f32_16x16x32_bf16 v[220:223], v[140:143], v[140:143], v[220:223]
    v_cvt_pk_bf16_f32 v128, v104, v105
    v_cvt_pk_bf16_f32 v129, v106, v107
    v_cvt_pk_bf16_f32 v130, v108, v109
    v_cvt_pk_bf16_f32 v131, v110, v111
    ds_write_b128 v9, v[128:131] offset:0
    v_cvt_pk_bf16_f32 v132, v112, v113
    v_cvt_pk_bf16_f32 v133, v114, v115
    v_cvt_pk_bf16_f32 v134, v116, v117
    v_cvt_pk_bf16_f32 v135, v118, v119
    ds_write_b128 v9, v[132:135] offset:4096
    v_mfma_f32_16x16x32_bf16 v[220:223], v[128:131], v[128:131], v[220:223]
    v_mfma_f32_16x16x32_bf16 v[220:223], v[132:135], v[132:135], v[220:223]
    s_waitcnt lgkmcnt(0)
    s_barrier
    ds_read_b128 v[160:163], v1 offset:0
    ds_read_b128 v[164:167], v1 offset:1024
    ds_read_b128 v[168:171], v1 offset:2048
    ds_read_b128 v[172:175], v1 offset:3072
    s_waitcnt lgkmcnt(0)
    v_mfma_f32_16x16x32_bf16 v[16:19], a[0:3], v[160:163], 0
    ds_read_b128 v[176:179], v1 offset:4096
    v_mfma_f32_16x16x32_bf16 v[20:23], a[0:3], v[164:167], 0
    ds_read_b128 v[180:183], v1 offset:5120
    v_mfma_f32_16x16x32_bf16 v[24:27], a[0:3], v[168:171], 0
    ds_read_b128 v[184:187], v1 offset:6144
    v_mfma_f32_16x16x32_bf16 v[28:31], a[0:3], v[172:175], 0
    ds_read_b128 v[188:191], v1 offset:7168
    s_add_u32 s86, s87, 61440
    buffer_load_dwordx4 a[0:3], v1, s[4:7], s86 offen offset:0 sc1
    v_mfma_f32_16x16x32_bf16 v[32:35], a[4:7], v[160:163], 0
    v_mfma_f32_16x16x32_bf16 v[36:39], a[4:7], v[164:167], 0
    v_mfma_f32_16x16x32_bf16 v[40:43], a[4:7], v[168:171], 0
    v_mfma_f32_16x16x32_bf16 v[44:47], a[4:7], v[172:175], 0
    buffer_load_dwordx4 a[4:7], v1, s[4:7], s86 offen offset:1024 sc1
    v_mfma_f32_16x16x32_bf16 v[48:51], a[8:11], v[160:163], 0
    v_mfma_f32_16x16x32_bf16 v[52:55], a[8:11], v[164:167], 0
    v_mfma_f32_16x16x32_bf16 v[56:59], a[8:11], v[168:171], 0
    v_mfma_f32_16x16x32_bf16 v[60:63], a[8:11], v[172:175], 0
    buffer_load_dwordx4 a[8:11], v1, s[4:7], s86 offen offset:2048 sc1
    v_mfma_f32_16x16x32_bf16 v[64:67], a[12:15], v[160:163], 0
    v_mfma_f32_16x16x32_bf16 v[68:71], a[12:15], v[164:167], 0
    v_mfma_f32_16x16x32_bf16 v[72:75], a[12:15], v[168:171], 0
    v_mfma_f32_16x16x32_bf16 v[76:79], a[12:15], v[172:175], 0
    buffer_load_dwordx4 a[12:15], v1, s[4:7], s86 offen offset:3072 sc1
    v_mfma_f32_16x16x32_bf16 v[80:83], a[16:19], v[160:163], 0
    v_mfma_f32_16x16x32_bf16 v[84:87], a[16:19], v[164:167], 0
    v_mfma_f32_16x16x32_bf16 v[88:91], a[16:19], v[168:171], 0
    v_mfma_f32_16x16x32_bf16 v[92:95], a[16:19], v[172:175], 0
    s_add_u32 s86, s87, 65536
    buffer_load_dwordx4 a[16:19], v1, s[4:7], s86 offen offset:0 sc1
    s_waitcnt lgkmcnt(0)
    v_mfma_f32_16x16x32_bf16 v[16:19], a[20:23], v[176:179], v[16:19]
    ds_read_b128 v[160:163], v1 offset:8192
    v_mfma_f32_16x16x32_bf16 v[20:23], a[20:23], v[180:183], v[20:23]
    ds_read_b128 v[164:167], v1 offset:9216
    v_mfma_f32_16x16x32_bf16 v[24:27], a[20:23], v[184:187], v[24:27]
    ds_read_b128 v[168:171], v1 offset:10240
    v_mfma_f32_16x16x32_bf16 v[28:31], a[20:23], v[188:191], v[28:31]
    ds_read_b128 v[172:175], v1 offset:11264
    buffer_load_dwordx4 a[20:23], v1, s[4:7], s86 offen offset:1024 sc1
    v_mfma_f32_16x16x32_bf16 v[32:35], a[24:27], v[176:179], v[32:35]
    v_mfma_f32_16x16x32_bf16 v[36:39], a[24:27], v[180:183], v[36:39]
    v_mfma_f32_16x16x32_bf16 v[40:43], a[24:27], v[184:187], v[40:43]
    v_mfma_f32_16x16x32_bf16 v[44:47], a[24:27], v[188:191], v[44:47]
    buffer_load_dwordx4 a[24:27], v1, s[4:7], s86 offen offset:2048 sc1
    v_mfma_f32_16x16x32_bf16 v[48:51], a[28:31], v[176:179], v[48:51]
    v_mfma_f32_16x16x32_bf16 v[52:55], a[28:31], v[180:183], v[52:55]
    v_mfma_f32_16x16x32_bf16 v[56:59], a[28:31], v[184:187], v[56:59]
    v_mfma_f32_16x16x32_bf16 v[60:63], a[28:31], v[188:191], v[60:63]
    buffer_load_dwordx4 a[28:31], v1, s[4:7], s86 offen offset:3072 sc1
    v_mfma_f32_16x16x32_bf16 v[64:67], a[32:35], v[176:179], v[64:67]
    v_mfma_f32_16x16x32_bf16 v[68:71], a[32:35], v[180:183], v[68:71]
    v_mfma_f32_16x16x32_bf16 v[72:75], a[32:35], v[184:187], v[72:75]
    v_mfma_f32_16x16x32_bf16 v[76:79], a[32:35], v[188:191], v[76:79]
    s_add_u32 s86, s87, 69632
    buffer_load_dwordx4 a[32:35], v1, s[4:7], s86 offen offset:0 sc1
    v_mfma_f32_16x16x32_bf16 v[80:83], a[36:39], v[176:179], v[80:83]
    v_mfma_f32_16x16x32_bf16 v[84:87], a[36:39], v[180:183], v[84:87]
    v_mfma_f32_16x16x32_bf16 v[88:91], a[36:39], v[184:187], v[88:91]
    v_mfma_f32_16x16x32_bf16 v[92:95], a[36:39], v[188:191], v[92:95]
    buffer_load_dwordx4 a[36:39], v1, s[4:7], s86 offen offset:1024 sc1
    s_waitcnt lgkmcnt(0)
    v_mfma_f32_16x16x32_bf16 v[16:19], a[40:43], v[160:163], v[16:19]
    ds_read_b128 v[176:179], v1 offset:12288
    v_mfma_f32_16x16x32_bf16 v[20:23], a[40:43], v[164:167], v[20:23]
    ds_read_b128 v[180:183], v1 offset:13312
    v_mfma_f32_16x16x32_bf16 v[24:27], a[40:43], v[168:171], v[24:27]
    ds_read_b128 v[184:187], v1 offset:14336
    v_mfma_f32_16x16x32_bf16 v[28:31], a[40:43], v[172:175], v[28:31]
    ds_read_b128 v[188:191], v1 offset:15360
    buffer_load_dwordx4 a[40:43], v1, s[4:7], s86 offen offset:2048 sc1
    v_mfma_f32_16x16x32_bf16 v[32:35], a[44:47], v[160:163], v[32:35]
    v_mfma_f32_16x16x32_bf16 v[36:39], a[44:47], v[164:167], v[36:39]
    v_mfma_f32_16x16x32_bf16 v[40:43], a[44:47], v[168:171], v[40:43]
    v_mfma_f32_16x16x32_bf16 v[44:47], a[44:47], v[172:175], v[44:47]
    buffer_load_dwordx4 a[44:47], v1, s[4:7], s86 offen offset:3072 sc1
    v_mfma_f32_16x16x32_bf16 v[48:51], a[48:51], v[160:163], v[48:51]
    v_mfma_f32_16x16x32_bf16 v[52:55], a[48:51], v[164:167], v[52:55]
    v_mfma_f32_16x16x32_bf16 v[56:59], a[48:51], v[168:171], v[56:59]
    v_mfma_f32_16x16x32_bf16 v[60:63], a[48:51], v[172:175], v[60:63]
    s_add_u32 s86, s87, 73728
    buffer_load_dwordx4 a[48:51], v1, s[4:7], s86 offen offset:0 sc1
    v_mfma_f32_16x16x32_bf16 v[64:67], a[52:55], v[160:163], v[64:67]
    v_mfma_f32_16x16x32_bf16 v[68:71], a[52:55], v[164:167], v[68:71]
    v_mfma_f32_16x16x32_bf16 v[72:75], a[52:55], v[168:171], v[72:75]
    v_mfma_f32_16x16x32_bf16 v[76:79], a[52:55], v[172:175], v[76:79]
    buffer_load_dwordx4 a[52:55], v1, s[4:7], s86 offen offset:1024 sc1
    v_mfma_f32_16x16x32_bf16 v[80:83], a[56:59], v[160:163], v[80:83]
    v_mfma_f32_16x16x32_bf16 v[84:87], a[56:59], v[164:167], v[84:87]
    v_mfma_f32_16x16x32_bf16 v[88:91], a[56:59], v[168:171], v[88:91]
    v_mfma_f32_16x16x32_bf16 v[92:95], a[56:59], v[172:175], v[92:95]
    buffer_load_dwordx4 a[56:59], v1, s[4:7], s86 offen offset:2048 sc1
    s_waitcnt lgkmcnt(0)
    v_mfma_f32_16x16x32_bf16 v[16:19], a[60:63], v[176:179], v[16:19]
    ds_read_b128 v[160:163], v1 offset:16384
    v_mfma_f32_16x16x32_bf16 v[20:23], a[60:63], v[180:183], v[20:23]
    ds_read_b128 v[164:167], v1 offset:17408
    v_mfma_f32_16x16x32_bf16 v[24:27], a[60:63], v[184:187], v[24:27]
    ds_read_b128 v[168:171], v1 offset:18432
    v_mfma_f32_16x16x32_bf16 v[28:31], a[60:63], v[188:191], v[28:31]
    ds_read_b128 v[172:175], v1 offset:19456
    buffer_load_dwordx4 a[60:63], v1, s[4:7], s86 offen offset:3072 sc1
    v_mfma_f32_16x16x32_bf16 v[32:35], a[64:67], v[176:179], v[32:35]
    v_mfma_f32_16x16x32_bf16 v[36:39], a[64:67], v[180:183], v[36:39]
    v_mfma_f32_16x16x32_bf16 v[40:43], a[64:67], v[184:187], v[40:43]
    v_mfma_f32_16x16x32_bf16 v[44:47], a[64:67], v[188:191], v[44:47]
    s_add_u32 s86, s87, 77824
    buffer_load_dwordx4 a[64:67], v1, s[4:7], s86 offen offset:0 sc1
    v_mfma_f32_16x16x32_bf16 v[48:51], a[68:71], v[176:179], v[48:51]
    v_mfma_f32_16x16x32_bf16 v[52:55], a[68:71], v[180:183], v[52:55]
    v_mfma_f32_16x16x32_bf16 v[56:59], a[68:71], v[184:187], v[56:59]
    v_mfma_f32_16x16x32_bf16 v[60:63], a[68:71], v[188:191], v[60:63]
    buffer_load_dwordx4 a[68:71], v1, s[4:7], s86 offen offset:1024 sc1
    v_mfma_f32_16x16x32_bf16 v[64:67], a[72:75], v[176:179], v[64:67]
    v_mfma_f32_16x16x32_bf16 v[68:71], a[72:75], v[180:183], v[68:71]
    v_mfma_f32_16x16x32_bf16 v[72:75], a[72:75], v[184:187], v[72:75]
    v_mfma_f32_16x16x32_bf16 v[76:79], a[72:75], v[188:191], v[76:79]
    buffer_load_dwordx4 a[72:75], v1, s[4:7], s86 offen offset:2048 sc1
    v_mfma_f32_16x16x32_bf16 v[80:83], a[76:79], v[176:179], v[80:83]
    v_mfma_f32_16x16x32_bf16 v[84:87], a[76:79], v[180:183], v[84:87]
    v_mfma_f32_16x16x32_bf16 v[88:91], a[76:79], v[184:187], v[88:91]
    v_mfma_f32_16x16x32_bf16 v[92:95], a[76:79], v[188:191], v[92:95]
    buffer_load_dwordx4 a[76:79], v1, s[4:7], s86 offen offset:3072 sc1
    s_waitcnt lgkmcnt(0)
    v_mfma_f32_16x16x32_bf16 v[16:19], a[80:83], v[160:163], v[16:19]
    ds_read_b128 v[176:179], v1 offset:20480
    v_mfma_f32_16x16x32_bf16 v[20:23], a[80:83], v[164:167], v[20:23]
    ds_read_b128 v[180:183], v1 offset:21504
    v_mfma_f32_16x16x32_bf16 v[24:27], a[80:83], v[168:171], v[24:27]
    ds_read_b128 v[184:187], v1 offset:22528
    v_mfma_f32_16x16x32_bf16 v[28:31], a[80:83], v[172:175], v[28:31]
    ds_read_b128 v[188:191], v1 offset:23552
    s_add_u32 s86, s87, 81920
    buffer_load_dwordx4 a[80:83], v1, s[4:7], s86 offen offset:0 sc1
    v_mfma_f32_16x16x32_bf16 v[32:35], a[84:87], v[160:163], v[32:35]
    v_and_b32 v224, 3, v0
    v_mfma_f32_16x16x32_bf16 v[36:39], a[84:87], v[164:167], v[36:39]
    v_lshrrev_b32 v225, 2, v2
    v_mfma_f32_16x16x32_bf16 v[40:43], a[84:87], v[168:171], v[40:43]
    v_cmp_eq_u32 vcc, 1, v224
    v_mfma_f32_16x16x32_bf16 v[44:47], a[84:87], v[172:175], v[44:47]
    s_nop 0
    v_cndmask_b32 v220, v220, v221, vcc
    buffer_load_dwordx4 a[84:87], v1, s[4:7], s86 offen offset:1024 sc1
    v_mfma_f32_16x16x32_bf16 v[48:51], a[88:91], v[160:163], v[48:51]
    v_cmp_eq_u32 vcc, 2, v224
    v_mfma_f32_16x16x32_bf16 v[52:55], a[88:91], v[164:167], v[52:55]
    s_nop 0
    v_cndmask_b32 v220, v220, v222, vcc
    v_mfma_f32_16x16x32_bf16 v[56:59], a[88:91], v[168:171], v[56:59]
    v_cmp_eq_u32 vcc, 3, v224
    v_mfma_f32_16x16x32_bf16 v[60:63], a[88:91], v[172:175], v[60:63]
    s_nop 0
    v_cndmask_b32 v220, v220, v223, vcc
    buffer_load_dwordx4 a[88:91], v1, s[4:7], s86 offen offset:2048 sc1
    v_mfma_f32_16x16x32_bf16 v[64:67], a[92:95], v[160:163], v[64:67]
    v_cmp_eq_u32 vcc, v225, v3
    v_mfma_f32_16x16x32_bf16 v[68:71], a[92:95], v[164:167], v[68:71]
    v_mfma_f32_16x16x32_bf16 v[72:75], a[92:95], v[168:171], v[72:75]
    v_mfma_f32_16x16x32_bf16 v[76:79], a[92:95], v[172:175], v[76:79]
    buffer_load_dwordx4 a[92:95], v1, s[4:7], s86 offen offset:3072 sc1
    v_mfma_f32_16x16x32_bf16 v[80:83], a[96:99], v[160:163], v[80:83]
    v_mfma_f32_16x16x32_bf16 v[84:87], a[96:99], v[164:167], v[84:87]
    v_mfma_f32_16x16x32_bf16 v[88:91], a[96:99], v[168:171], v[88:91]
    v_mfma_f32_16x16x32_bf16 v[92:95], a[96:99], v[172:175], v[92:95]
    s_add_u32 s86, s87, 86016
    buffer_load_dwordx4 a[96:99], v1, s[4:7], s86 offen offset:0 sc1
    s_waitcnt lgkmcnt(0)
    v_mfma_f32_16x16x32_bf16 v[16:19], a[100:103], v[176:179], v[16:19]
    ds_read_b128 v[160:163], v1 offset:24576
    v_mfma_f32_16x16x32_bf16 v[20:23], a[100:103], v[180:183], v[20:23]
    ds_read_b128 v[164:167], v1 offset:25600
    v_mfma_f32_16x16x32_bf16 v[24:27], a[100:103], v[184:187], v[24:27]
    ds_read_b128 v[168:171], v1 offset:26624
    v_mfma_f32_16x16x32_bf16 v[28:31], a[100:103], v[188:191], v[28:31]
    ds_read_b128 v[172:175], v1 offset:27648
    buffer_load_dwordx4 a[100:103], v1, s[4:7], s86 offen offset:1024 sc1
    v_mfma_f32_16x16x32_bf16 v[32:35], a[104:107], v[176:179], v[32:35]
    v_cndmask_b32 v220, 0, v220, vcc
    v_mfma_f32_16x16x32_bf16 v[36:39], a[104:107], v[180:183], v[36:39]
    v_mov_b32 v221, v220
    v_mfma_f32_16x16x32_bf16 v[40:43], a[104:107], v[184:187], v[40:43]
    s_nop 0
    v_permlane16_swap_b32 v220, v221
    v_mfma_f32_16x16x32_bf16 v[44:47], a[104:107], v[188:191], v[44:47]
    v_add_f32 v220, v220, v221
    buffer_load_dwordx4 a[104:107], v1, s[4:7], s86 offen offset:2048 sc1
    v_mfma_f32_16x16x32_bf16 v[48:51], a[108:111], v[176:179], v[48:51]
    v_mov_b32 v221, v220
    v_mfma_f32_16x16x32_bf16 v[52:55], a[108:111], v[180:183], v[52:55]
    s_nop 0
    v_permlane32_swap_b32 v220, v221
    v_mfma_f32_16x16x32_bf16 v[56:59], a[108:111], v[184:187], v[56:59]
    v_add_f32 v220, v220, v221
    v_mfma_f32_16x16x32_bf16 v[60:63], a[108:111], v[188:191], v[60:63]
    v_fma_f32 v220, v220, s79, v15
    buffer_load_dwordx4 a[108:111], v1, s[4:7], s86 offen offset:3072 sc1
    v_mfma_f32_16x16x32_bf16 v[64:67], a[112:115], v[176:179], v[64:67]
    v_rsq_f32 v218, v220
    v_mfma_f32_16x16x32_bf16 v[68:71], a[112:115], v[180:183], v[68:71]
    v_mfma_f32_16x16x32_bf16 v[72:75], a[112:115], v[184:187], v[72:75]
    v_mfma_f32_16x16x32_bf16 v[76:79], a[112:115], v[188:191], v[76:79]
    s_add_u32 s86, s87, 90112
    buffer_load_dwordx4 a[112:115], v1, s[4:7], s86 offen offset:0 sc1
    v_mfma_f32_16x16x32_bf16 v[80:83], a[116:119], v[176:179], v[80:83]
    v_mfma_f32_16x16x32_bf16 v[84:87], a[116:119], v[180:183], v[84:87]
    v_mfma_f32_16x16x32_bf16 v[88:91], a[116:119], v[184:187], v[88:91]
    v_mfma_f32_16x16x32_bf16 v[92:95], a[116:119], v[188:191], v[92:95]
    buffer_load_dwordx4 a[116:119], v1, s[4:7], s86 offen offset:1024 sc1
    s_waitcnt lgkmcnt(0)
    v_mfma_f32_16x16x32_bf16 v[16:19], a[120:123], v[160:163], v[16:19]
    ds_read_b128 v[176:179], v1 offset:28672
    v_mfma_f32_16x16x32_bf16 v[20:23], a[120:123], v[164:167], v[20:23]
    ds_read_b128 v[180:183], v1 offset:29696
    v_mfma_f32_16x16x32_bf16 v[24:27], a[120:123], v[168:171], v[24:27]
    ds_read_b128 v[184:187], v1 offset:30720
    v_mfma_f32_16x16x32_bf16 v[28:31], a[120:123], v[172:175], v[28:31]
    ds_read_b128 v[188:191], v1 offset:31744
    buffer_load_dwordx4 a[120:123], v1, s[4:7], s86 offen offset:2048 sc1
    v_mfma_f32_16x16x32_bf16 v[32:35], a[124:127], v[160:163], v[32:35]
    v_mfma_f32_16x16x32_bf16 v[36:39], a[124:127], v[164:167], v[36:39]
    v_mfma_f32_16x16x32_bf16 v[40:43], a[124:127], v[168:171], v[40:43]
    v_mfma_f32_16x16x32_bf16 v[44:47], a[124:127], v[172:175], v[44:47]
    buffer_load_dwordx4 a[124:127], v1, s[4:7], s86 offen offset:3072 sc1
    v_mfma_f32_16x16x32_bf16 v[48:51], a[128:131], v[160:163], v[48:51]
    v_mfma_f32_16x16x32_bf16 v[52:55], a[128:131], v[164:167], v[52:55]
    v_mfma_f32_16x16x32_bf16 v[56:59], a[128:131], v[168:171], v[56:59]
    v_mfma_f32_16x16x32_bf16 v[60:63], a[128:131], v[172:175], v[60:63]
    s_add_u32 s86, s87, 94208
    buffer_load_dwordx4 a[128:131], v1, s[4:7], s86 offen offset:0 sc1
    v_mfma_f32_16x16x32_bf16 v[64:67], a[132:135], v[160:163], v[64:67]
    v_mfma_f32_16x16x32_bf16 v[68:71], a[132:135], v[164:167], v[68:71]
    v_mfma_f32_16x16x32_bf16 v[72:75], a[132:135], v[168:171], v[72:75]
    v_mfma_f32_16x16x32_bf16 v[76:79], a[132:135], v[172:175], v[76:79]
    buffer_load_dwordx4 a[132:135], v1, s[4:7], s86 offen offset:1024 sc1
    v_mfma_f32_16x16x32_bf16 v[80:83], a[136:139], v[160:163], v[80:83]
    v_mfma_f32_16x16x32_bf16 v[84:87], a[136:139], v[164:167], v[84:87]
    v_mfma_f32_16x16x32_bf16 v[88:91], a[136:139], v[168:171], v[88:91]
    v_mfma_f32_16x16x32_bf16 v[92:95], a[136:139], v[172:175], v[92:95]
    buffer_load_dwordx4 a[136:139], v1, s[4:7], s86 offen offset:2048 sc1
    s_waitcnt lgkmcnt(0)
    v_mfma_f32_16x16x32_bf16 v[16:19], a[140:143], v[176:179], v[16:19]
    ds_read_b128 v[160:163], v1 offset:32768
    v_mfma_f32_16x16x32_bf16 v[20:23], a[140:143], v[180:183], v[20:23]
    ds_read_b128 v[164:167], v1 offset:33792
    v_mfma_f32_16x16x32_bf16 v[24:27], a[140:143], v[184:187], v[24:27]
    ds_read_b128 v[168:171], v1 offset:34816
    v_mfma_f32_16x16x32_bf16 v[28:31], a[140:143], v[188:191], v[28:31]
    ds_read_b128 v[172:175], v1 offset:35840
    buffer_load_dwordx4 a[140:143], v1, s[4:7], s86 offen offset:3072 sc1
    s_waitcnt vmcnt(59)
    v_mfma_f32_16x16x32_bf16 v[32:35], a[144:147], v[176:179], v[32:35]
    v_mfma_f32_16x16x32_bf16 v[36:39], a[144:147], v[180:183], v[36:39]
    v_mfma_f32_16x16x32_bf16 v[40:43], a[144:147], v[184:187], v[40:43]
    v_mfma_f32_16x16x32_bf16 v[44:47], a[144:147], v[188:191], v[44:47]
    s_add_u32 s86, s87, 98304
    buffer_load_dwordx4 a[144:147], v1, s[4:7], s86 offen offset:0 sc1
    s_waitcnt vmcnt(59)
    v_mfma_f32_16x16x32_bf16 v[48:51], a[148:151], v[176:179], v[48:51]
    v_mfma_f32_16x16x32_bf16 v[52:55], a[148:151], v[180:183], v[52:55]
    v_mfma_f32_16x16x32_bf16 v[56:59], a[148:151], v[184:187], v[56:59]
    v_mfma_f32_16x16x32_bf16 v[60:63], a[148:151], v[188:191], v[60:63]
    buffer_load_dwordx4 a[148:151], v1, s[4:7], s86 offen offset:1024 sc1
    s_waitcnt vmcnt(59)
    v_mfma_f32_16x16x32_bf16 v[64:67], a[152:155], v[176:179], v[64:67]
    v_mfma_f32_16x16x32_bf16 v[68:71], a[152:155], v[180:183], v[68:71]
    v_mfma_f32_16x16x32_bf16 v[72:75], a[152:155], v[184:187], v[72:75]
    v_mfma_f32_16x16x32_bf16 v[76:79], a[152:155], v[188:191], v[76:79]
    buffer_load_dwordx4 a[152:155], v1, s[4:7], s86 offen offset:2048 sc1
    s_waitcnt vmcnt(59)
    v_mfma_f32_16x16x32_bf16 v[80:83], a[156:159], v[176:179], v[80:83]
    v_mfma_f32_16x16x32_bf16 v[84:87], a[156:159], v[180:183], v[84:87]
    v_mfma_f32_16x16x32_bf16 v[88:91], a[156:159], v[184:187], v[88:91]
    v_mfma_f32_16x16x32_bf16 v[92:95], a[156:159], v[188:191], v[92:95]
    buffer_load_dwordx4 a[156:159], v1, s[4:7], s86 offen offset:3072 sc1
    s_waitcnt lgkmcnt(0)
    s_waitcnt vmcnt(59)
    v_mfma_f32_16x16x32_bf16 v[16:19], a[160:163], v[160:163], v[16:19]
    ds_read_b128 v[176:179], v1 offset:36864
    v_mfma_f32_16x16x32_bf16 v[20:23], a[160:163], v[164:167], v[20:23]
    ds_read_b128 v[180:183], v1 offset:37888
    v_mfma_f32_16x16x32_bf16 v[24:27], a[160:163], v[168:171], v[24:27]
    ds_read_b128 v[184:187], v1 offset:38912
    v_mfma_f32_16x16x32_bf16 v[28:31], a[160:163], v[172:175], v[28:31]
    ds_read_b128 v[188:191], v1 offset:39936
    s_add_u32 s86, s87, 102400
    buffer_load_dwordx4 a[160:163], v1, s[4:7], s86 offen offset:0 sc1
    s_waitcnt vmcnt(59)
    v_mfma_f32_16x16x32_bf16 v[32:35], a[164:167], v[160:163], v[32:35]
    v_mfma_f32_16x16x32_bf16 v[36:39], a[164:167], v[164:167], v[36:39]
    v_mfma_f32_16x16x32_bf16 v[40:43], a[164:167], v[168:171], v[40:43]
    v_mfma_f32_16x16x32_bf16 v[44:47], a[164:167], v[172:175], v[44:47]
    buffer_load_dwordx4 a[164:167], v1, s[4:7], s86 offen offset:1024 sc1
    s_waitcnt vmcnt(59)
    v_mfma_f32_16x16x32_bf16 v[48:51], a[168:171], v[160:163], v[48:51]
    v_mfma_f32_16x16x32_bf16 v[52:55], a[168:171], v[164:167], v[52:55]
    v_mfma_f32_16x16x32_bf16 v[56:59], a[168:171], v[168:171], v[56:59]
    v_mfma_f32_16x16x32_bf16 v[60:63], a[168:171], v[172:175], v[60:63]
    buffer_load_dwordx4 a[168:171], v1, s[4:7], s86 offen offset:2048 sc1
    s_waitcnt vmcnt(59)
    v_mfma_f32_16x16x32_bf16 v[64:67], a[172:175], v[160:163], v[64:67]
    v_mfma_f32_16x16x32_bf16 v[68:71], a[172:175], v[164:167], v[68:71]
    v_mfma_f32_16x16x32_bf16 v[72:75], a[172:175], v[168:171], v[72:75]
    v_mfma_f32_16x16x32_bf16 v[76:79], a[172:175], v[172:175], v[76:79]
    buffer_load_dwordx4 a[172:175], v1, s[4:7], s86 offen offset:3072 sc1
    s_waitcnt vmcnt(59)
    v_mfma_f32_16x16x32_bf16 v[80:83], a[176:179], v[160:163], v[80:83]
    v_mfma_f32_16x16x32_bf16 v[84:87], a[176:179], v[164:167], v[84:87]
    v_mfma_f32_16x16x32_bf16 v[88:91], a[176:179], v[168:171], v[88:91]
    v_mfma_f32_16x16x32_bf16 v[92:95], a[176:179], v[172:175], v[92:95]
    s_add_u32 s86, s87, 106496
    buffer_load_dwordx4 a[176:179], v1, s[4:7], s86 offen offset:0 sc1
    s_waitcnt lgkmcnt(0)
    s_waitcnt vmcnt(59)
    v_mfma_f32_16x16x32_bf16 v[16:19], a[180:183], v[176:179], v[16:19]
    ds_read_b128 v[160:163], v1 offset:40960
    v_mfma_f32_16x16x32_bf16 v[20:23], a[180:183], v[180:183], v[20:23]
    ds_read_b128 v[164:167], v1 offset:41984
    v_mfma_f32_16x16x32_bf16 v[24:27], a[180:183], v[184:187], v[24:27]
    ds_read_b128 v[168:171], v1 offset:43008
    v_mfma_f32_16x16x32_bf16 v[28:31], a[180:183], v[188:191], v[28:31]
    ds_read_b128 v[172:175], v1 offset:44032
    buffer_load_dwordx4 a[180:183], v1, s[4:7], s86 offen offset:1024 sc1
    s_waitcnt vmcnt(59)
    v_mfma_f32_16x16x32_bf16 v[32:35], a[184:187], v[176:179], v[32:35]
    v_mfma_f32_16x16x32_bf16 v[36:39], a[184:187], v[180:183], v[36:39]
    v_mfma_f32_16x16x32_bf16 v[40:43], a[184:187], v[184:187], v[40:43]
    v_mfma_f32_16x16x32_bf16 v[44:47], a[184:187], v[188:191], v[44:47]
    buffer_load_dwordx4 a[184:187], v1, s[4:7], s86 offen offset:2048 sc1
    s_waitcnt vmcnt(59)
    v_mfma_f32_16x16x32_bf16 v[48:51], a[188:191], v[176:179], v[48:51]
    v_mfma_f32_16x16x32_bf16 v[52:55], a[188:191], v[180:183], v[52:55]
    v_mfma_f32_16x16x32_bf16 v[56:59], a[188:191], v[184:187], v[56:59]
    v_mfma_f32_16x16x32_bf16 v[60:63], a[188:191], v[188:191], v[60:63]
    buffer_load_dwordx4 a[188:191], v1, s[4:7], s86 offen offset:3072 sc1
    s_waitcnt vmcnt(59)
    v_mfma_f32_16x16x32_bf16 v[64:67], a[192:195], v[176:179], v[64:67]
    v_mfma_f32_16x16x32_bf16 v[68:71], a[192:195], v[180:183], v[68:71]
    v_mfma_f32_16x16x32_bf16 v[72:75], a[192:195], v[184:187], v[72:75]
    v_mfma_f32_16x16x32_bf16 v[76:79], a[192:195], v[188:191], v[76:79]
    s_add_u32 s86, s87, 110592
    buffer_load_dwordx4 a[192:195], v1, s[4:7], s86 offen offset:0 sc1
    s_waitcnt vmcnt(59)
    v_mfma_f32_16x16x32_bf16 v[80:83], a[196:199], v[176:179], v[80:83]
    v_mfma_f32_16x16x32_bf16 v[84:87], a[196:199], v[180:183], v[84:87]
    v_mfma_f32_16x16x32_bf16 v[88:91], a[196:199], v[184:187], v[88:91]
    v_mfma_f32_16x16x32_bf16 v[92:95], a[196:199], v[188:191], v[92:95]
    buffer_load_dwordx4 a[196:199], v1, s[4:7], s86 offen offset:1024 sc1
    s_waitcnt lgkmcnt(0)
    s_waitcnt vmcnt(59)
    v_mfma_f32_16x16x32_bf16 v[16:19], a[200:203], v[160:163], v[16:19]
    ds_read_b128 v[176:179], v1 offset:45056
    v_mfma_f32_16x16x32_bf16 v[20:23], a[200:203], v[164:167], v[20:23]
    ds_read_b128 v[180:183], v1 offset:46080
    v_mfma_f32_16x16x32_bf16 v[24:27], a[200:203], v[168:171], v[24:27]
    ds_read_b128 v[184:187], v1 offset:47104
    v_mfma_f32_16x16x32_bf16 v[28:31], a[200:203], v[172:175], v[28:31]
    ds_read_b128 v[188:191], v1 offset:48128
    buffer_load_dwordx4 a[200:203], v1, s[4:7], s86 offen offset:2048 sc1
    s_waitcnt vmcnt(59)
    v_mfma_f32_16x16x32_bf16 v[32:35], a[204:207], v[160:163], v[32:35]
    v_mfma_f32_16x16x32_bf16 v[36:39], a[204:207], v[164:167], v[36:39]
    v_mfma_f32_16x16x32_bf16 v[40:43], a[204:207], v[168:171], v[40:43]
    v_mfma_f32_16x16x32_bf16 v[44:47], a[204:207], v[172:175], v[44:47]
    buffer_load_dwordx4 a[204:207], v1, s[4:7], s86 offen offset:3072 sc1
    s_waitcnt vmcnt(59)
    v_mfma_f32_16x16x32_bf16 v[48:51], a[208:211], v[160:163], v[48:51]
    v_mfma_f32_16x16x32_bf16 v[52:55], a[208:211], v[164:167], v[52:55]
    v_mfma_f32_16x16x32_bf16 v[56:59], a[208:211], v[168:171], v[56:59]
    v_mfma_f32_16x16x32_bf16 v[60:63], a[208:211], v[172:175], v[60:63]
    s_add_u32 s86, s87, 114688
    buffer_load_dwordx4 a[208:211], v1, s[4:7], s86 offen offset:0 sc1
    s_waitcnt vmcnt(59)
    v_mfma_f32_16x16x32_bf16 v[64:67], a[212:215], v[160:163], v[64:67]
    v_mfma_f32_16x16x32_bf16 v[68:71], a[212:215], v[164:167], v[68:71]
    v_mfma_f32_16x16x32_bf16 v[72:75], a[212:215], v[168:171], v[72:75]
    v_mfma_f32_16x16x32_bf16 v[76:79], a[212:215], v[172:175], v[76:79]
    buffer_load_dwordx4 a[212:215], v1, s[4:7], s86 offen offset:1024 sc1
    s_waitcnt vmcnt(59)
    v_mfma_f32_16x16x32_bf16 v[80:83], a[216:219], v[160:163], v[80:83]
    v_mfma_f32_16x16x32_bf16 v[84:87], a[216:219], v[164:167], v[84:87]
    v_mfma_f32_16x16x32_bf16 v[88:91], a[216:219], v[168:171], v[88:91]
    v_mfma_f32_16x16x32_bf16 v[92:95], a[216:219], v[172:175], v[92:95]
    buffer_load_dwordx4 a[216:219], v1, s[4:7], s86 offen offset:2048 sc1
    s_waitcnt lgkmcnt(0)
    s_waitcnt vmcnt(59)
    v_mfma_f32_16x16x32_bf16 v[16:19], a[220:223], v[176:179], v[16:19]
    ds_read_b128 v[160:163], v1 offset:49152
    v_mfma_f32_16x16x32_bf16 v[20:23], a[220:223], v[180:183], v[20:23]
    ds_read_b128 v[164:167], v1 offset:50176
    v_mfma_f32_16x16x32_bf16 v[24:27], a[220:223], v[184:187], v[24:27]
    ds_read_b128 v[168:171], v1 offset:51200
    v_mfma_f32_16x16x32_bf16 v[28:31], a[220:223], v[188:191], v[28:31]
    ds_read_b128 v[172:175], v1 offset:52224
    buffer_load_dwordx4 a[220:223], v1, s[4:7], s86 offen offset:3072 sc1
    s_waitcnt vmcnt(59)
    v_mfma_f32_16x16x32_bf16 v[32:35], a[224:227], v[176:179], v[32:35]
    v_mfma_f32_16x16x32_bf16 v[36:39], a[224:227], v[180:183], v[36:39]
    v_mfma_f32_16x16x32_bf16 v[40:43], a[224:227], v[184:187], v[40:43]
    v_mfma_f32_16x16x32_bf16 v[44:47], a[224:227], v[188:191], v[44:47]
    s_add_u32 s86, s87, 118784
    buffer_load_dwordx4 a[224:227], v1, s[4:7], s86 offen offset:0 sc1
    s_waitcnt vmcnt(59)
    v_mfma_f32_16x16x32_bf16 v[48:51], a[228:231], v[176:179], v[48:51]
    v_mfma_f32_16x16x32_bf16 v[52:55], a[228:231], v[180:183], v[52:55]
    v_mfma_f32_16x16x32_bf16 v[56:59], a[228:231], v[184:187], v[56:59]
    v_mfma_f32_16x16x32_bf16 v[60:63], a[228:231], v[188:191], v[60:63]
    buffer_load_dwordx4 a[228:231], v1, s[4:7], s86 offen offset:1024 sc1
    s_waitcnt vmcnt(59)
    v_mfma_f32_16x16x32_bf16 v[64:67], a[232:235], v[176:179], v[64:67]
    v_mfma_f32_16x16x32_bf16 v[68:71], a[232:235], v[180:183], v[68:71]
    v_mfma_f32_16x16x32_bf16 v[72:75], a[232:235], v[184:187], v[72:75]
    v_mfma_f32_16x16x32_bf16 v[76:79], a[232:235], v[188:191], v[76:79]
    buffer_load_dwordx4 a[232:235], v1, s[4:7], s86 offen offset:2048 sc1
    s_waitcnt vmcnt(59)
    v_mfma_f32_16x16x32_bf16 v[80:83], a[236:239], v[176:179], v[80:83]
    v_mfma_f32_16x16x32_bf16 v[84:87], a[236:239], v[180:183], v[84:87]
    v_mfma_f32_16x16x32_bf16 v[88:91], a[236:239], v[184:187], v[88:91]
    v_mfma_f32_16x16x32_bf16 v[92:95], a[236:239], v[188:191], v[92:95]
    buffer_load_dwordx4 a[236:239], v1, s[4:7], s86 offen offset:3072 sc1
    s_waitcnt lgkmcnt(0)
    s_waitcnt vmcnt(59)
    v_mfma_f32_16x16x32_bf16 v[16:19], a[0:3], v[160:163], v[16:19]
    ds_read_b128 v[176:179], v1 offset:53248
    v_mfma_f32_16x16x32_bf16 v[20:23], a[0:3], v[164:167], v[20:23]
    ds_read_b128 v[180:183], v1 offset:54272
    v_mfma_f32_16x16x32_bf16 v[24:27], a[0:3], v[168:171], v[24:27]
    ds_read_b128 v[184:187], v1 offset:55296
    v_mfma_f32_16x16x32_bf16 v[28:31], a[0:3], v[172:175], v[28:31]
    ds_read_b128 v[188:191], v1 offset:56320
    s_add_u32 s86, s87, 122880
    buffer_load_dwordx4 a[0:3], v1, s[4:7], s86 offen offset:0 sc1
    s_waitcnt vmcnt(59)
    v_mfma_f32_16x16x32_bf16 v[32:35], a[4:7], v[160:163], v[32:35]
    v_mfma_f32_16x16x32_bf16 v[36:39], a[4:7], v[164:167], v[36:39]
    v_mfma_f32_16x16x32_bf16 v[40:43], a[4:7], v[168:171], v[40:43]
    v_mfma_f32_16x16x32_bf16 v[44:47], a[4:7], v[172:175], v[44:47]
    buffer_load_dwordx4 a[4:7], v1, s[4:7], s86 offen offset:1024 sc1
    s_waitcnt vmcnt(59)
    v_mfma_f32_16x16x32_bf16 v[48:51], a[8:11], v[160:163], v[48:51]
    v_mfma_f32_16x16x32_bf16 v[52:55], a[8:11], v[164:167], v[52:55]
    v_mfma_f32_16x16x32_bf16 v[56:59], a[8:11], v[168:171], v[56:59]
    v_mfma_f32_16x16x32_bf16 v[60:63], a[8:11], v[172:175], v[60:63]
    buffer_load_dwordx4 a[8:11], v1, s[4:7], s86 offen offset:2048 sc1
    s_waitcnt vmcnt(59)
    v_mfma_f32_16x16x32_bf16 v[64:67], a[12:15], v[160:163], v[64:67]
    v_mfma_f32_16x16x32_bf16 v[68:71], a[12:15], v[164:167], v[68:71]
    v_mfma_f32_16x16x32_bf16 v[72:75], a[12:15], v[168:171], v[72:75]
    v_mfma_f32_16x16x32_bf16 v[76:79], a[12:15], v[172:175], v[76:79]
    buffer_load_dwordx4 a[12:15], v1, s[4:7], s86 offen offset:3072 sc1
    s_waitcnt vmcnt(59)
    v_mfma_f32_16x16x32_bf16 v[80:83], a[16:19], v[160:163], v[80:83]
    v_mfma_f32_16x16x32_bf16 v[84:87], a[16:19], v[164:167], v[84:87]
    v_mfma_f32_16x16x32_bf16 v[88:91], a[16:19], v[168:171], v[88:91]
    v_mfma_f32_16x16x32_bf16 v[92:95], a[16:19], v[172:175], v[92:95]
    s_add_u32 s86, s87, 126976
    buffer_load_dwordx4 a[16:19], v1, s[4:7], s86 offen offset:0 sc1
    s_waitcnt lgkmcnt(0)
    s_waitcnt vmcnt(59)
    v_mfma_f32_16x16x32_bf16 v[16:19], a[20:23], v[176:179], v[16:19]
    ds_read_b128 v[160:163], v1 offset:57344
    v_mfma_f32_16x16x32_bf16 v[20:23], a[20:23], v[180:183], v[20:23]
    ds_read_b128 v[164:167], v1 offset:58368
    v_mfma_f32_16x16x32_bf16 v[24:27], a[20:23], v[184:187], v[24:27]
    ds_read_b128 v[168:171], v1 offset:59392
    v_mfma_f32_16x16x32_bf16 v[28:31], a[20:23], v[188:191], v[28:31]
    ds_read_b128 v[172:175], v1 offset:60416
    buffer_load_dwordx4 a[20:23], v1, s[4:7], s86 offen offset:1024 sc1
    s_waitcnt vmcnt(59)
    v_mfma_f32_16x16x32_bf16 v[32:35], a[24:27], v[176:179], v[32:35]
    v_mfma_f32_16x16x32_bf16 v[36:39], a[24:27], v[180:183], v[36:39]
    v_mfma_f32_16x16x32_bf16 v[40:43], a[24:27], v[184:187], v[40:43]
    v_mfma_f32_16x16x32_bf16 v[44:47], a[24:27], v[188:191], v[44:47]
    buffer_load_dwordx4 a[24:27], v1, s[4:7], s86 offen offset:2048 sc1
    s_waitcnt vmcnt(59)
    v_mfma_f32_16x16x32_bf16 v[48:51], a[28:31], v[176:179], v[48:51]
    v_mfma_f32_16x16x32_bf16 v[52:55], a[28:31], v[180:183], v[52:55]
    v_mfma_f32_16x16x32_bf16 v[56:59], a[28:31], v[184:187], v[56:59]
    v_mfma_f32_16x16x32_bf16 v[60:63], a[28:31], v[188:191], v[60:63]
    buffer_load_dwordx4 a[28:31], v1, s[4:7], s86 offen offset:3072 sc1
    s_waitcnt vmcnt(59)
    v_mfma_f32_16x16x32_bf16 v[64:67], a[32:35], v[176:179], v[64:67]
    v_mfma_f32_16x16x32_bf16 v[68:71], a[32:35], v[180:183], v[68:71]
    v_mfma_f32_16x16x32_bf16 v[72:75], a[32:35], v[184:187], v[72:75]
    v_mfma_f32_16x16x32_bf16 v[76:79], a[32:35], v[188:191], v[76:79]
    s_add_u32 s86, s87, 131072
    buffer_load_dwordx4 a[32:35], v1, s[4:7], s86 offen offset:0 sc1
    s_waitcnt vmcnt(59)
    v_mfma_f32_16x16x32_bf16 v[80:83], a[36:39], v[176:179], v[80:83]
    v_mfma_f32_16x16x32_bf16 v[84:87], a[36:39], v[180:183], v[84:87]
    v_mfma_f32_16x16x32_bf16 v[88:91], a[36:39], v[184:187], v[88:91]
    v_mfma_f32_16x16x32_bf16 v[92:95], a[36:39], v[188:191], v[92:95]
    buffer_load_dwordx4 a[36:39], v1, s[4:7], s86 offen offset:1024 sc1
    s_waitcnt lgkmcnt(0)
    s_waitcnt vmcnt(59)
    v_mfma_f32_16x16x32_bf16 v[16:19], a[40:43], v[160:163], v[16:19]
    ds_read_b128 v[176:179], v1 offset:61440
    v_mfma_f32_16x16x32_bf16 v[20:23], a[40:43], v[164:167], v[20:23]
    ds_read_b128 v[180:183], v1 offset:62464
    v_mfma_f32_16x16x32_bf16 v[24:27], a[40:43], v[168:171], v[24:27]
    ds_read_b128 v[184:187], v1 offset:63488
    v_mfma_f32_16x16x32_bf16 v[28:31], a[40:43], v[172:175], v[28:31]
    ds_read_b128 v[188:191], v1 offset:64512
    buffer_load_dwordx4 a[40:43], v1, s[4:7], s86 offen offset:2048 sc1
    s_waitcnt vmcnt(59)
    v_mfma_f32_16x16x32_bf16 v[32:35], a[44:47], v[160:163], v[32:35]
    v_mfma_f32_16x16x32_bf16 v[36:39], a[44:47], v[164:167], v[36:39]
    v_mfma_f32_16x16x32_bf16 v[40:43], a[44:47], v[168:171], v[40:43]
    v_mfma_f32_16x16x32_bf16 v[44:47], a[44:47], v[172:175], v[44:47]
    buffer_load_dwordx4 a[44:47], v1, s[4:7], s86 offen offset:3072 sc1
    s_waitcnt vmcnt(59)
    v_mfma_f32_16x16x32_bf16 v[48:51], a[48:51], v[160:163], v[48:51]
    v_mfma_f32_16x16x32_bf16 v[52:55], a[48:51], v[164:167], v[52:55]
    v_mfma_f32_16x16x32_bf16 v[56:59], a[48:51], v[168:171], v[56:59]
    v_mfma_f32_16x16x32_bf16 v[60:63], a[48:51], v[172:175], v[60:63]
    s_add_u32 s86, s87, 135168
    buffer_load_dwordx4 a[48:51], v1, s[4:7], s86 offen offset:0 sc1
    s_waitcnt vmcnt(59)
    v_mfma_f32_16x16x32_bf16 v[64:67], a[52:55], v[160:163], v[64:67]
    v_mfma_f32_16x16x32_bf16 v[68:71], a[52:55], v[164:167], v[68:71]
    v_mfma_f32_16x16x32_bf16 v[72:75], a[52:55], v[168:171], v[72:75]
    v_mfma_f32_16x16x32_bf16 v[76:79], a[52:55], v[172:175], v[76:79]
    buffer_load_dwordx4 a[52:55], v1, s[4:7], s86 offen offset:1024 sc1
    s_waitcnt vmcnt(59)
    v_mfma_f32_16x16x32_bf16 v[80:83], a[56:59], v[160:163], v[80:83]
    v_mfma_f32_16x16x32_bf16 v[84:87], a[56:59], v[164:167], v[84:87]
    v_mfma_f32_16x16x32_bf16 v[88:91], a[56:59], v[168:171], v[88:91]
    v_mfma_f32_16x16x32_bf16 v[92:95], a[56:59], v[172:175], v[92:95]
    buffer_load_dwordx4 a[56:59], v1, s[4:7], s86 offen offset:2048 sc1
    s_waitcnt lgkmcnt(0)
    s_waitcnt vmcnt(59)
    v_mfma_f32_16x16x32_bf16 v[16:19], a[60:63], v[176:179], v[16:19]
    ds_read_b128 v[160:163], v210 offset:0
    v_mfma_f32_16x16x32_bf16 v[20:23], a[60:63], v[180:183], v[20:23]
    ds_read_b128 v[164:167], v210 offset:1024
    v_mfma_f32_16x16x32_bf16 v[24:27], a[60:63], v[184:187], v[24:27]
    ds_read_b128 v[168:171], v210 offset:2048
    v_mfma_f32_16x16x32_bf16 v[28:31], a[60:63], v[188:191], v[28:31]
    ds_read_b128 v[172:175], v210 offset:3072
    buffer_load_dwordx4 a[60:63], v1, s[4:7], s86 offen offset:3072 sc1
    s_waitcnt vmcnt(59)
    v_mfma_f32_16x16x32_bf16 v[32:35], a[64:67], v[176:179], v[32:35]
    v_mfma_f32_16x16x32_bf16 v[36:39], a[64:67], v[180:183], v[36:39]
    v_mfma_f32_16x16x32_bf16 v[40:43], a[64:67], v[184:187], v[40:43]
    v_mfma_f32_16x16x32_bf16 v[44:47], a[64:67], v[188:191], v[44:47]
    s_add_u32 s86, s87, 139264
    buffer_load_dwordx4 a[64:67], v1, s[4:7], s86 offen offset:0 sc1
    s_waitcnt vmcnt(59)
    v_mfma_f32_16x16x32_bf16 v[48:51], a[68:71], v[176:179], v[48:51]
    v_mfma_f32_16x16x32_bf16 v[52:55], a[68:71], v[180:183], v[52:55]
    v_mfma_f32_16x16x32_bf16 v[56:59], a[68:71], v[184:187], v[56:59]
    v_mfma_f32_16x16x32_bf16 v[60:63], a[68:71], v[188:191], v[60:63]
    buffer_load_dwordx4 a[68:71], v1, s[4:7], s86 offen offset:1024 sc1
    s_waitcnt vmcnt(59)
    v_mfma_f32_16x16x32_bf16 v[64:67], a[72:75], v[176:179], v[64:67]
    v_mfma_f32_16x16x32_bf16 v[68:71], a[72:75], v[180:183], v[68:71]
    v_mfma_f32_16x16x32_bf16 v[72:75], a[72:75], v[184:187], v[72:75]
    v_mfma_f32_16x16x32_bf16 v[76:79], a[72:75], v[188:191], v[76:79]
    buffer_load_dwordx4 a[72:75], v1, s[4:7], s86 offen offset:2048 sc1
    s_waitcnt vmcnt(59)
    v_mfma_f32_16x16x32_bf16 v[80:83], a[76:79], v[176:179], v[80:83]
    v_mfma_f32_16x16x32_bf16 v[84:87], a[76:79], v[180:183], v[84:87]
    v_mfma_f32_16x16x32_bf16 v[88:91], a[76:79], v[184:187], v[88:91]
    v_mfma_f32_16x16x32_bf16 v[92:95], a[76:79], v[188:191], v[92:95]
    buffer_load_dwordx4 a[76:79], v1, s[4:7], s86 offen offset:3072 sc1
    s_waitcnt lgkmcnt(0)
    s_waitcnt vmcnt(59)
    v_mfma_f32_16x16x32_bf16 v[16:19], a[80:83], v[160:163], v[16:19]
    ds_read_b128 v[176:179], v210 offset:4096
    v_mfma_f32_16x16x32_bf16 v[20:23], a[80:83], v[164:167], v[20:23]
    ds_read_b128 v[180:183], v210 offset:5120
    v_mfma_f32_16x16x32_bf16 v[24:27], a[80:83], v[168:171], v[24:27]
    ds_read_b128 v[184:187], v210 offset:6144
    v_mfma_f32_16x16x32_bf16 v[28:31], a[80:83], v[172:175], v[28:31]
    ds_read_b128 v[188:191], v210 offset:7168
    s_add_u32 s86, s87, 143360
    buffer_load_dwordx4 a[80:83], v1, s[4:7], s86 offen offset:0 sc1
    s_waitcnt vmcnt(59)
    v_mfma_f32_16x16x32_bf16 v[32:35], a[84:87], v[160:163], v[32:35]
    v_mfma_f32_16x16x32_bf16 v[36:39], a[84:87], v[164:167], v[36:39]
    v_mfma_f32_16x16x32_bf16 v[40:43], a[84:87], v[168:171], v[40:43]
    v_mfma_f32_16x16x32_bf16 v[44:47], a[84:87], v[172:175], v[44:47]
    buffer_load_dwordx4 a[84:87], v1, s[4:7], s86 offen offset:1024 sc1
    s_waitcnt vmcnt(59)
    v_mfma_f32_16x16x32_bf16 v[48:51], a[88:91], v[160:163], v[48:51]
    v_mfma_f32_16x16x32_bf16 v[52:55], a[88:91], v[164:167], v[52:55]
    v_mfma_f32_16x16x32_bf16 v[56:59], a[88:91], v[168:171], v[56:59]
    v_mfma_f32_16x16x32_bf16 v[60:63], a[88:91], v[172:175], v[60:63]
    buffer_load_dwordx4 a[88:91], v1, s[4:7], s86 offen offset:2048 sc1
    s_waitcnt vmcnt(59)
    v_mfma_f32_16x16x32_bf16 v[64:67], a[92:95], v[160:163], v[64:67]
    v_mfma_f32_16x16x32_bf16 v[68:71], a[92:95], v[164:167], v[68:71]
    v_mfma_f32_16x16x32_bf16 v[72:75], a[92:95], v[168:171], v[72:75]
    v_mfma_f32_16x16x32_bf16 v[76:79], a[92:95], v[172:175], v[76:79]
    buffer_load_dwordx4 a[92:95], v1, s[4:7], s86 offen offset:3072 sc1
    s_waitcnt vmcnt(59)
    v_mfma_f32_16x16x32_bf16 v[80:83], a[96:99], v[160:163], v[80:83]
    v_mfma_f32_16x16x32_bf16 v[84:87], a[96:99], v[164:167], v[84:87]
    v_mfma_f32_16x16x32_bf16 v[88:91], a[96:99], v[168:171], v[88:91]
    v_mfma_f32_16x16x32_bf16 v[92:95], a[96:99], v[172:175], v[92:95]
    s_add_u32 s86, s87, 147456
    buffer_load_dwordx4 a[96:99], v1, s[4:7], s86 offen offset:0 sc1
    s_waitcnt lgkmcnt(0)
    s_waitcnt vmcnt(59)
    v_mfma_f32_16x16x32_bf16 v[16:19], a[100:103], v[176:179], v[16:19]
    ds_read_b128 v[160:163], v1 offset:0
    v_mfma_f32_16x16x32_bf16 v[20:23], a[100:103], v[180:183], v[20:23]
    ds_read_b128 v[164:167], v1 offset:1024
    v_mfma_f32_16x16x32_bf16 v[24:27], a[100:103], v[184:187], v[24:27]
    ds_read_b128 v[168:171], v1 offset:2048
    v_mfma_f32_16x16x32_bf16 v[28:31], a[100:103], v[188:191], v[28:31]
    ds_read_b128 v[172:175], v1 offset:3072
    buffer_load_dwordx4 a[100:103], v1, s[4:7], s86 offen offset:1024 sc1
    s_waitcnt vmcnt(59)
    v_mfma_f32_16x16x32_bf16 v[32:35], a[104:107], v[176:179], v[32:35]
    v_mfma_f32_16x16x32_bf16 v[36:39], a[104:107], v[180:183], v[36:39]
    v_mfma_f32_16x16x32_bf16 v[40:43], a[104:107], v[184:187], v[40:43]
    v_mfma_f32_16x16x32_bf16 v[44:47], a[104:107], v[188:191], v[44:47]
    buffer_load_dwordx4 a[104:107], v1, s[4:7], s86 offen offset:2048 sc1
    s_waitcnt vmcnt(59)
    v_mfma_f32_16x16x32_bf16 v[48:51], a[108:111], v[176:179], v[48:51]
    v_mfma_f32_16x16x32_bf16 v[52:55], a[108:111], v[180:183], v[52:55]
    v_mfma_f32_16x16x32_bf16 v[56:59], a[108:111], v[184:187], v[56:59]
    v_mfma_f32_16x16x32_bf16 v[60:63], a[108:111], v[188:191], v[60:63]
    buffer_load_dwordx4 a[108:111], v1, s[4:7], s86 offen offset:3072 sc1
    s_waitcnt vmcnt(59)
    v_mfma_f32_16x16x32_bf16 v[64:67], a[112:115], v[176:179], v[64:67]
    v_mfma_f32_16x16x32_bf16 v[68:71], a[112:115], v[180:183], v[68:71]
    v_mfma_f32_16x16x32_bf16 v[72:75], a[112:115], v[184:187], v[72:75]
    v_mfma_f32_16x16x32_bf16 v[76:79], a[112:115], v[188:191], v[76:79]
    s_add_u32 s86, s87, 151552
    buffer_load_dwordx4 a[112:115], v1, s[4:7], s86 offen offset:0 sc1
    s_waitcnt vmcnt(59)
    v_mfma_f32_16x16x32_bf16 v[80:83], a[116:119], v[176:179], v[80:83]
    v_mfma_f32_16x16x32_bf16 v[84:87], a[116:119], v[180:183], v[84:87]
    v_mfma_f32_16x16x32_bf16 v[88:91], a[116:119], v[184:187], v[88:91]
    v_mfma_f32_16x16x32_bf16 v[92:95], a[116:119], v[188:191], v[92:95]
    buffer_load_dwordx4 a[116:119], v1, s[4:7], s86 offen offset:1024 sc1
    s_waitcnt lgkmcnt(0)
    s_waitcnt vmcnt(59)
    v_mfma_f32_16x16x32_bf16 v[96:99], a[120:123], v[160:163], 0
    ds_read_b128 v[176:179], v1 offset:4096
    v_cvt_pk_bf16_f32 v192, v16, v17
    v_mfma_f32_16x16x32_bf16 v[100:103], a[120:123], v[164:167], 0
    ds_read_b128 v[180:183], v1 offset:5120
    v_cvt_pk_bf16_f32 v193, v18, v19
    v_mfma_f32_16x16x32_bf16 v[104:107], a[120:123], v[168:171], 0
    ds_read_b128 v[184:187], v1 offset:6144
    v_cvt_pk_bf16_f32 v194, v32, v33
    v_mfma_f32_16x16x32_bf16 v[108:111], a[120:123], v[172:175], 0
    ds_read_b128 v[188:191], v1 offset:7168
    buffer_load_dwordx4 a[120:123], v1, s[4:7], s86 offen offset:2048 sc1
    s_waitcnt vmcnt(59)
    v_mfma_f32_16x16x32_bf16 v[112:115], a[124:127], v[160:163], 0
    v_cvt_pk_bf16_f32 v195, v34, v35
    v_pk_max_i16 v192, v192, 0
    v_mfma_f32_16x16x32_bf16 v[116:119], a[124:127], v[164:167], 0
    v_pk_max_i16 v193, v193, 0
    v_pk_max_i16 v194, v194, 0
    v_mfma_f32_16x16x32_bf16 v[120:123], a[124:127], v[168:171], 0
    v_pk_max_i16 v195, v195, 0
    ds_write_b128 v213, v[192:195] offset:0
    v_mfma_f32_16x16x32_bf16 v[124:127], a[124:127], v[172:175], 0
    buffer_load_dwordx4 a[124:127], v1, s[4:7], s86 offen offset:3072 sc1
    s_waitcnt vmcnt(59)
    v_mfma_f32_16x16x32_bf16 v[128:131], a[128:131], v[160:163], 0
    v_cvt_pk_bf16_f32 v196, v20, v21
    v_cvt_pk_bf16_f32 v197, v22, v23
    v_mfma_f32_16x16x32_bf16 v[132:135], a[128:131], v[164:167], 0
    v_cvt_pk_bf16_f32 v198, v36, v37
    v_cvt_pk_bf16_f32 v199, v38, v39
    v_mfma_f32_16x16x32_bf16 v[136:139], a[128:131], v[168:171], 0
    v_pk_max_i16 v196, v196, 0
    v_pk_max_i16 v197, v197, 0
    v_mfma_f32_16x16x32_bf16 v[140:143], a[128:131], v[172:175], 0
    s_add_u32 s86, s87, 155648
    buffer_load_dwordx4 a[128:131], v1, s[4:7], s86 offen offset:0 sc1
    s_waitcnt vmcnt(59)
    v_mfma_f32_16x16x32_bf16 v[144:147], a[132:135], v[160:163], 0
    v_pk_max_i16 v198, v198, 0
    v_pk_max_i16 v199, v199, 0
    v_mfma_f32_16x16x32_bf16 v[148:151], a[132:135], v[164:167], 0
    ds_write_b128 v213, v[196:199] offset:1024
    v_cvt_pk_bf16_f32 v200, v24, v25
    v_mfma_f32_16x16x32_bf16 v[152:155], a[132:135], v[168:171], 0
    v_cvt_pk_bf16_f32 v201, v26, v27
    v_cvt_pk_bf16_f32 v202, v40, v41
    v_mfma_f32_16x16x32_bf16 v[156:159], a[132:135], v[172:175], 0
    buffer_load_dwordx4 a[132:135], v1, s[4:7], s86 offen offset:1024 sc1
    s_waitcnt lgkmcnt(2)
    s_waitcnt vmcnt(59)
    v_mfma_f32_16x16x32_bf16 v[96:99], a[136:139], v[176:179], v[96:99]
    ds_read_b128 v[160:163], v1 offset:8192
    v_cvt_pk_bf16_f32 v203, v42, v43
    v_mfma_f32_16x16x32_bf16 v[100:103], a[136:139], v[180:183], v[100:103]
    ds_read_b128 v[164:167], v1 offset:9216
    v_pk_max_i16 v200, v200, 0
    v_mfma_f32_16x16x32_bf16 v[104:107], a[136:139], v[184:187], v[104:107]
    ds_read_b128 v[168:171], v1 offset:10240
    v_pk_max_i16 v201, v201, 0
    v_mfma_f32_16x16x32_bf16 v[108:111], a[136:139], v[188:191], v[108:111]
    ds_read_b128 v[172:175], v1 offset:11264
    buffer_load_dwordx4 a[136:139], v1, s[4:7], s86 offen offset:2048 sc1
    s_waitcnt vmcnt(59)
    v_mfma_f32_16x16x32_bf16 v[112:115], a[140:143], v[176:179], v[112:115]
    v_pk_max_i16 v202, v202, 0
    v_pk_max_i16 v203, v203, 0
    v_mfma_f32_16x16x32_bf16 v[116:119], a[140:143], v[180:183], v[116:119]
    ds_write_b128 v213, v[200:203] offset:2048
    v_cvt_pk_bf16_f32 v204, v28, v29
    v_mfma_f32_16x16x32_bf16 v[120:123], a[140:143], v[184:187], v[120:123]
    v_cvt_pk_bf16_f32 v205, v30, v31
    v_cvt_pk_bf16_f32 v206, v44, v45
    v_mfma_f32_16x16x32_bf16 v[124:127], a[140:143], v[188:191], v[124:127]
    buffer_load_dwordx4 a[140:143], v1, s[4:7], s86 offen offset:3072 sc1
    s_waitcnt vmcnt(59)
    v_mfma_f32_16x16x32_bf16 v[128:131], a[144:147], v[176:179], v[128:131]
    v_cvt_pk_bf16_f32 v207, v46, v47
    v_pk_max_i16 v204, v204, 0
    v_mfma_f32_16x16x32_bf16 v[132:135], a[144:147], v[180:183], v[132:135]
    v_pk_max_i16 v205, v205, 0
    v_pk_max_i16 v206, v206, 0
    v_mfma_f32_16x16x32_bf16 v[136:139], a[144:147], v[184:187], v[136:139]
    v_pk_max_i16 v207, v207, 0
    ds_write_b128 v213, v[204:207] offset:3072
    v_mfma_f32_16x16x32_bf16 v[140:143], a[144:147], v[188:191], v[140:143]
    s_add_u32 s86, s87, 159744
    buffer_load_dwordx4 a[144:147], v1, s[4:7], s86 offen offset:0 sc1
    s_waitcnt vmcnt(59)
    v_mfma_f32_16x16x32_bf16 v[144:147], a[148:151], v[176:179], v[144:147]
    v_cvt_pk_bf16_f32 v192, v48, v49
    v_cvt_pk_bf16_f32 v193, v50, v51
    v_mfma_f32_16x16x32_bf16 v[148:151], a[148:151], v[180:183], v[148:151]
    v_cvt_pk_bf16_f32 v194, v64, v65
    v_cvt_pk_bf16_f32 v195, v66, v67
    v_mfma_f32_16x16x32_bf16 v[152:155], a[148:151], v[184:187], v[152:155]
    v_pk_max_i16 v192, v192, 0
    v_pk_max_i16 v193, v193, 0
    v_mfma_f32_16x16x32_bf16 v[156:159], a[148:151], v[188:191], v[156:159]
    buffer_load_dwordx4 a[148:151], v1, s[4:7], s86 offen offset:1024 sc1
    s_waitcnt lgkmcnt(2)
    s_waitcnt vmcnt(59)
    v_mfma_f32_16x16x32_bf16 v[96:99], a[152:155], v[160:163], v[96:99]
    ds_read_b128 v[176:179], v1 offset:12288
    v_pk_max_i16 v194, v194, 0
    v_mfma_f32_16x16x32_bf16 v[100:103], a[152:155], v[164:167], v[100:103]
    ds_read_b128 v[180:183], v1 offset:13312
    v_pk_max_i16 v195, v195, 0
    v_mfma_f32_16x16x32_bf16 v[104:107], a[152:155], v[168:171], v[104:107]
    ds_read_b128 v[184:187], v1 offset:14336
    ds_write_b128 v213, v[192:195] offset:16384
    v_mfma_f32_16x16x32_bf16 v[108:111], a[152:155], v[172:175], v[108:111]
    ds_read_b128 v[188:191], v1 offset:15360
    buffer_load_dwordx4 a[152:155], v1, s[4:7], s86 offen offset:2048 sc1
    s_waitcnt vmcnt(59)
    v_mfma_f32_16x16x32_bf16 v[112:115], a[156:159], v[160:163], v[112:115]
    v_cvt_pk_bf16_f32 v196, v52, v53
    v_cvt_pk_bf16_f32 v197, v54, v55
    v_mfma_f32_16x16x32_bf16 v[116:119], a[156:159], v[164:167], v[116:119]
    v_cvt_pk_bf16_f32 v198, v68, v69
    v_cvt_pk_bf16_f32 v199, v70, v71
    v_mfma_f32_16x16x32_bf16 v[120:123], a[156:159], v[168:171], v[120:123]
    v_pk_max_i16 v196, v196, 0
    v_pk_max_i16 v197, v197, 0
    v_mfma_f32_16x16x32_bf16 v[124:127], a[156:159], v[172:175], v[124:127]
    buffer_load_dwordx4 a[156:159], v1, s[4:7], s86 offen offset:3072 sc1
    s_waitcnt vmcnt(59)
    v_mfma_f32_16x16x32_bf16 v[128:131], a[160:163], v[160:163], v[128:131]
    v_pk_max_i16 v198, v198, 0
    v_pk_max_i16 v199, v199, 0
    v_mfma_f32_16x16x32_bf16 v[132:135], a[160:163], v[164:167], v[132:135]
    ds_write_b128 v213, v[196:199] offset:17408
    v_cvt_pk_bf16_f32 v200, v56, v57
    v_mfma_f32_16x16x32_bf16 v[136:139], a[160:163], v[168:171], v[136:139]
    v_cvt_pk_bf16_f32 v201, v58, v59
    v_cvt_pk_bf16_f32 v202, v72, v73
    v_mfma_f32_16x16x32_bf16 v[140:143], a[160:163], v[172:175], v[140:143]
    s_add_u32 s86, s87, 163840
    buffer_load_dwordx4 a[160:163], v1, s[4:7], s86 offen offset:0 sc1
    s_waitcnt vmcnt(59)
    v_mfma_f32_16x16x32_bf16 v[144:147], a[164:167], v[160:163], v[144:147]
    v_cvt_pk_bf16_f32 v203, v74, v75
    v_pk_max_i16 v200, v200, 0
    v_mfma_f32_16x16x32_bf16 v[148:151], a[164:167], v[164:167], v[148:151]
    v_pk_max_i16 v201, v201, 0
    v_pk_max_i16 v202, v202, 0
    v_mfma_f32_16x16x32_bf16 v[152:155], a[164:167], v[168:171], v[152:155]
    v_pk_max_i16 v203, v203, 0
    ds_write_b128 v213, v[200:203] offset:18432
    v_mfma_f32_16x16x32_bf16 v[156:159], a[164:167], v[172:175], v[156:159]
    buffer_load_dwordx4 a[164:167], v1, s[4:7], s86 offen offset:1024 sc1
    s_waitcnt lgkmcnt(2)
    s_waitcnt vmcnt(59)
    v_mfma_f32_16x16x32_bf16 v[96:99], a[168:171], v[176:179], v[96:99]
    ds_read_b128 v[160:163], v1 offset:16384
    v_cvt_pk_bf16_f32 v204, v60, v61
    v_mfma_f32_16x16x32_bf16 v[100:103], a[168:171], v[180:183], v[100:103]
    ds_read_b128 v[164:167], v1 offset:17408
    v_cvt_pk_bf16_f32 v205, v62, v63
    v_mfma_f32_16x16x32_bf16 v[104:107], a[168:171], v[184:187], v[104:107]
    ds_read_b128 v[168:171], v1 offset:18432
    v_cvt_pk_bf16_f32 v206, v76, v77
    v_mfma_f32_16x16x32_bf16 v[108:111], a[168:171], v[188:191], v[108:111]
    ds_read_b128 v[172:175], v1 offset:19456
    buffer_load_dwordx4 a[168:171], v1, s[4:7], s86 offen offset:2048 sc1
    s_waitcnt vmcnt(59)
    v_mfma_f32_16x16x32_bf16 v[112:115], a[172:175], v[176:179], v[112:115]
    v_cvt_pk_bf16_f32 v207, v78, v79
    v_pk_max_i16 v204, v204, 0
    v_mfma_f32_16x16x32_bf16 v[116:119], a[172:175], v[180:183], v[116:119]
    v_pk_max_i16 v205, v205, 0
    v_pk_max_i16 v206, v206, 0
    v_mfma_f32_16x16x32_bf16 v[120:123], a[172:175], v[184:187], v[120:123]
    v_pk_max_i16 v207, v207, 0
    ds_write_b128 v213, v[204:207] offset:19456
    v_mfma_f32_16x16x32_bf16 v[124:127], a[172:175], v[188:191], v[124:127]
    buffer_load_dwordx4 a[172:175], v1, s[4:7], s86 offen offset:3072 sc1
    s_waitcnt vmcnt(59)
    v_mfma_f32_16x16x32_bf16 v[128:131], a[176:179], v[176:179], v[128:131]
    v_cvt_pk_bf16_f32 v192, v80, v81
    v_cvt_pk_bf16_f32 v193, v82, v83
    v_mfma_f32_16x16x32_bf16 v[132:135], a[176:179], v[180:183], v[132:135]
    v_pk_max_i16 v192, v192, 0
    v_pk_max_i16 v193, v193, 0
    v_mfma_f32_16x16x32_bf16 v[136:139], a[176:179], v[184:187], v[136:139]
    ds_write_b64 v214, v[192:193] offset:0
    v_cvt_pk_bf16_f32 v196, v84, v85
    v_mfma_f32_16x16x32_bf16 v[140:143], a[176:179], v[188:191], v[140:143]
    s_add_u32 s86, s87, 167936
    buffer_load_dwordx4 a[176:179], v1, s[4:7], s86 offen offset:0 sc1
    s_waitcnt vmcnt(59)
    v_mfma_f32_16x16x32_bf16 v[144:147], a[180:183], v[176:179], v[144:147]
    v_cvt_pk_bf16_f32 v197, v86, v87
    v_pk_max_i16 v196, v196, 0
    v_mfma_f32_16x16x32_bf16 v[148:151], a[180:183], v[180:183], v[148:151]
    v_pk_max_i16 v197, v197, 0
    ds_write_b64 v214, v[196:197] offset:1024
    v_mfma_f32_16x16x32_bf16 v[152:155], a[180:183], v[184:187], v[152:155]
    v_cvt_pk_bf16_f32 v200, v88, v89
    v_cvt_pk_bf16_f32 v201, v90, v91
    v_mfma_f32_16x16x32_bf16 v[156:159], a[180:183], v[188:191], v[156:159]
    buffer_load_dwordx4 a[180:183], v1, s[4:7], s86 offen offset:1024 sc1
    s_waitcnt lgkmcnt(3)
    s_waitcnt vmcnt(59)
    v_mfma_f32_16x16x32_bf16 v[96:99], a[184:187], v[160:163], v[96:99]
    ds_read_b128 v[176:179], v1 offset:20480
    v_pk_max_i16 v200, v200, 0
    v_mfma_f32_16x16x32_bf16 v[100:103], a[184:187], v[164:167], v[100:103]
    ds_read_b128 v[180:183], v1 offset:21504
    v_pk_max_i16 v201, v201, 0
    v_mfma_f32_16x16x32_bf16 v[104:107], a[184:187], v[168:171], v[104:107]
    ds_read_b128 v[184:187], v1 offset:22528
    ds_write_b64 v214, v[200:201] offset:2048
    v_mfma_f32_16x16x32_bf16 v[108:111], a[184:187], v[172:175], v[108:111]
    ds_read_b128 v[188:191], v1 offset:23552
    buffer_load_dwordx4 a[184:187], v1, s[4:7], s86 offen offset:2048 sc1
    s_waitcnt vmcnt(59)
    v_mfma_f32_16x16x32_bf16 v[112:115], a[188:191], v[160:163], v[112:115]
    v_cvt_pk_bf16_f32 v204, v92, v93
    v_cvt_pk_bf16_f32 v205, v94, v95
    v_mfma_f32_16x16x32_bf16 v[116:119], a[188:191], v[164:167], v[116:119]
    v_pk_max_i16 v204, v204, 0
    v_pk_max_i16 v205, v205, 0
    v_mfma_f32_16x16x32_bf16 v[120:123], a[188:191], v[168:171], v[120:123]
    ds_write_b64 v214, v[204:205] offset:3072
    v_mfma_f32_16x16x32_bf16 v[124:127], a[188:191], v[172:175], v[124:127]
    buffer_load_dwordx4 a[188:191], v1, s[4:7], s86 offen offset:3072 sc1
    s_waitcnt vmcnt(59)
    v_mfma_f32_16x16x32_bf16 v[128:131], a[192:195], v[160:163], v[128:131]
    v_mfma_f32_16x16x32_bf16 v[132:135], a[192:195], v[164:167], v[132:135]
    v_mfma_f32_16x16x32_bf16 v[136:139], a[192:195], v[168:171], v[136:139]
    v_mfma_f32_16x16x32_bf16 v[140:143], a[192:195], v[172:175], v[140:143]
    s_add_u32 s86, s87, 172032
    buffer_load_dwordx4 a[192:195], v1, s[4:7], s86 offen offset:0 sc1
    s_waitcnt vmcnt(59)
    v_mfma_f32_16x16x32_bf16 v[144:147], a[196:199], v[160:163], v[144:147]
    v_mfma_f32_16x16x32_bf16 v[148:151], a[196:199], v[164:167], v[148:151]
    v_mfma_f32_16x16x32_bf16 v[152:155], a[196:199], v[168:171], v[152:155]
    v_mfma_f32_16x16x32_bf16 v[156:159], a[196:199], v[172:175], v[156:159]
    buffer_load_dwordx4 a[196:199], v1, s[4:7], s86 offen offset:1024 sc1
    s_waitcnt lgkmcnt(1)
    s_waitcnt vmcnt(59)
    v_mfma_f32_16x16x32_bf16 v[96:99], a[200:203], v[176:179], v[96:99]
    ds_read_b128 v[160:163], v1 offset:24576
    v_mfma_f32_16x16x32_bf16 v[100:103], a[200:203], v[180:183], v[100:103]
    ds_read_b128 v[164:167], v1 offset:25600
    v_mfma_f32_16x16x32_bf16 v[104:107], a[200:203], v[184:187], v[104:107]
    ds_read_b128 v[168:171], v1 offset:26624
    v_mfma_f32_16x16x32_bf16 v[108:111], a[200:203], v[188:191], v[108:111]
    ds_read_b128 v[172:175], v1 offset:27648
    buffer_load_dwordx4 a[200:203], v1, s[4:7], s86 offen offset:2048 sc1
    s_waitcnt vmcnt(59)
    v_mfma_f32_16x16x32_bf16 v[112:115], a[204:207], v[176:179], v[112:115]
    v_mfma_f32_16x16x32_bf16 v[116:119], a[204:207], v[180:183], v[116:119]
    v_mfma_f32_16x16x32_bf16 v[120:123], a[204:207], v[184:187], v[120:123]
    v_mfma_f32_16x16x32_bf16 v[124:127], a[204:207], v[188:191], v[124:127]
    buffer_load_dwordx4 a[204:207], v1, s[4:7], s86 offen offset:3072 sc1
    s_waitcnt vmcnt(59)
    v_mfma_f32_16x16x32_bf16 v[128:131], a[208:211], v[176:179], v[128:131]
    v_mfma_f32_16x16x32_bf16 v[132:135], a[208:211], v[180:183], v[132:135]
    v_mfma_f32_16x16x32_bf16 v[136:139], a[208:211], v[184:187], v[136:139]
    v_mfma_f32_16x16x32_bf16 v[140:143], a[208:211], v[188:191], v[140:143]
    s_add_u32 s86, s87, 176128
    buffer_load_dwordx4 a[208:211], v1, s[4:7], s86 offen offset:0 sc1
    s_waitcnt vmcnt(59)
    v_mfma_f32_16x16x32_bf16 v[144:147], a[212:215], v[176:179], v[144:147]
    v_mfma_f32_16x16x32_bf16 v[148:151], a[212:215], v[180:183], v[148:151]
    v_mfma_f32_16x16x32_bf16 v[152:155], a[212:215], v[184:187], v[152:155]
    v_mfma_f32_16x16x32_bf16 v[156:159], a[212:215], v[188:191], v[156:159]
    buffer_load_dwordx4 a[212:215], v1, s[4:7], s86 offen offset:1024 sc1
    s_waitcnt lgkmcnt(0)
    s_waitcnt vmcnt(59)
    v_mfma_f32_16x16x32_bf16 v[96:99], a[216:219], v[160:163], v[96:99]
    ds_read_b128 v[176:179], v1 offset:28672
    v_mfma_f32_16x16x32_bf16 v[100:103], a[216:219], v[164:167], v[100:103]
    ds_read_b128 v[180:183], v1 offset:29696
    v_mfma_f32_16x16x32_bf16 v[104:107], a[216:219], v[168:171], v[104:107]
    ds_read_b128 v[184:187], v1 offset:30720
    v_mfma_f32_16x16x32_bf16 v[108:111], a[216:219], v[172:175], v[108:111]
    ds_read_b128 v[188:191], v1 offset:31744
    buffer_load_dwordx4 a[216:219], v1, s[4:7], s86 offen offset:2048 sc1
    s_waitcnt vmcnt(59)
    v_mfma_f32_16x16x32_bf16 v[112:115], a[220:223], v[160:163], v[112:115]
    v_mfma_f32_16x16x32_bf16 v[116:119], a[220:223], v[164:167], v[116:119]
    v_mfma_f32_16x16x32_bf16 v[120:123], a[220:223], v[168:171], v[120:123]
    v_mfma_f32_16x16x32_bf16 v[124:127], a[220:223], v[172:175], v[124:127]
    buffer_load_dwordx4 a[220:223], v1, s[4:7], s86 offen offset:3072 sc1
    s_waitcnt vmcnt(59)
    v_mfma_f32_16x16x32_bf16 v[128:131], a[224:227], v[160:163], v[128:131]
    v_mfma_f32_16x16x32_bf16 v[132:135], a[224:227], v[164:167], v[132:135]
    v_mfma_f32_16x16x32_bf16 v[136:139], a[224:227], v[168:171], v[136:139]
    v_mfma_f32_16x16x32_bf16 v[140:143], a[224:227], v[172:175], v[140:143]
    s_add_u32 s86, s87, 180224
    buffer_load_dwordx4 a[224:227], v1, s[4:7], s86 offen offset:0 sc1
    s_waitcnt vmcnt(59)
    v_mfma_f32_16x16x32_bf16 v[144:147], a[228:231], v[160:163], v[144:147]
    v_mfma_f32_16x16x32_bf16 v[148:151], a[228:231], v[164:167], v[148:151]
    v_mfma_f32_16x16x32_bf16 v[152:155], a[228:231], v[168:171], v[152:155]
    v_mfma_f32_16x16x32_bf16 v[156:159], a[228:231], v[172:175], v[156:159]
    buffer_load_dwordx4 a[228:231], v1, s[4:7], s86 offen offset:1024 sc1
    s_waitcnt lgkmcnt(0)
    s_waitcnt vmcnt(59)
    v_mfma_f32_16x16x32_bf16 v[96:99], a[232:235], v[176:179], v[96:99]
    ds_read_b128 v[160:163], v1 offset:32768
    v_mfma_f32_16x16x32_bf16 v[100:103], a[232:235], v[180:183], v[100:103]
    ds_read_b128 v[164:167], v1 offset:33792
    v_mfma_f32_16x16x32_bf16 v[104:107], a[232:235], v[184:187], v[104:107]
    ds_read_b128 v[168:171], v1 offset:34816
    v_mfma_f32_16x16x32_bf16 v[108:111], a[232:235], v[188:191], v[108:111]
    ds_read_b128 v[172:175], v1 offset:35840
    buffer_load_dwordx4 a[232:235], v1, s[4:7], s86 offen offset:2048 sc1
    s_waitcnt vmcnt(59)
    v_mfma_f32_16x16x32_bf16 v[112:115], a[236:239], v[176:179], v[112:115]
    v_mfma_f32_16x16x32_bf16 v[116:119], a[236:239], v[180:183], v[116:119]
    v_mfma_f32_16x16x32_bf16 v[120:123], a[236:239], v[184:187], v[120:123]
    v_mfma_f32_16x16x32_bf16 v[124:127], a[236:239], v[188:191], v[124:127]
    buffer_load_dwordx4 a[236:239], v1, s[4:7], s86 offen offset:3072 sc1
    s_waitcnt vmcnt(59)
    v_mfma_f32_16x16x32_bf16 v[128:131], a[0:3], v[176:179], v[128:131]
    v_mfma_f32_16x16x32_bf16 v[132:135], a[0:3], v[180:183], v[132:135]
    v_mfma_f32_16x16x32_bf16 v[136:139], a[0:3], v[184:187], v[136:139]
    v_mfma_f32_16x16x32_bf16 v[140:143], a[0:3], v[188:191], v[140:143]
    s_add_u32 s86, s87, 184320
    buffer_load_dwordx4 a[0:3], v1, s[4:7], s86 offen offset:0 sc1
    s_waitcnt vmcnt(59)
    v_mfma_f32_16x16x32_bf16 v[144:147], a[4:7], v[176:179], v[144:147]
    v_mfma_f32_16x16x32_bf16 v[148:151], a[4:7], v[180:183], v[148:151]
    v_mfma_f32_16x16x32_bf16 v[152:155], a[4:7], v[184:187], v[152:155]
    v_mfma_f32_16x16x32_bf16 v[156:159], a[4:7], v[188:191], v[156:159]
    buffer_load_dwordx4 a[4:7], v1, s[4:7], s86 offen offset:1024 sc1
    s_waitcnt lgkmcnt(0)
    s_waitcnt vmcnt(59)
    v_mfma_f32_16x16x32_bf16 v[96:99], a[8:11], v[160:163], v[96:99]
    ds_read_b128 v[176:179], v1 offset:36864
    v_mfma_f32_16x16x32_bf16 v[100:103], a[8:11], v[164:167], v[100:103]
    ds_read_b128 v[180:183], v1 offset:37888
    v_mfma_f32_16x16x32_bf16 v[104:107], a[8:11], v[168:171], v[104:107]
    ds_read_b128 v[184:187], v1 offset:38912
    v_mfma_f32_16x16x32_bf16 v[108:111], a[8:11], v[172:175], v[108:111]
    ds_read_b128 v[188:191], v1 offset:39936
    buffer_load_dwordx4 a[8:11], v1, s[4:7], s86 offen offset:2048 sc1
    s_waitcnt vmcnt(59)
    v_mfma_f32_16x16x32_bf16 v[112:115], a[12:15], v[160:163], v[112:115]
    v_mfma_f32_16x16x32_bf16 v[116:119], a[12:15], v[164:167], v[116:119]
    v_mfma_f32_16x16x32_bf16 v[120:123], a[12:15], v[168:171], v[120:123]
    v_mfma_f32_16x16x32_bf16 v[124:127], a[12:15], v[172:175], v[124:127]
    buffer_load_dwordx4 a[12:15], v1, s[4:7], s86 offen offset:3072 sc1
    s_waitcnt vmcnt(59)
    v_mfma_f32_16x16x32_bf16 v[128:131], a[16:19], v[160:163], v[128:131]
    v_mfma_f32_16x16x32_bf16 v[132:135], a[16:19], v[164:167], v[132:135]
    v_mfma_f32_16x16x32_bf16 v[136:139], a[16:19], v[168:171], v[136:139]
    v_mfma_f32_16x16x32_bf16 v[140:143], a[16:19], v[172:175], v[140:143]
    s_add_u32 s86, s87, 188416
    buffer_load_dwordx4 a[16:19], v1, s[4:7], s86 offen offset:0 sc1
    s_waitcnt vmcnt(59)
    v_mfma_f32_16x16x32_bf16 v[144:147], a[20:23], v[160:163], v[144:147]
    v_mfma_f32_16x16x32_bf16 v[148:151], a[20:23], v[164:167], v[148:151]
    v_mfma_f32_16x16x32_bf16 v[152:155], a[20:23], v[168:171], v[152:155]
    v_mfma_f32_16x16x32_bf16 v[156:159], a[20:23], v[172:175], v[156:159]
    buffer_load_dwordx4 a[20:23], v1, s[4:7], s86 offen offset:1024 sc1
    s_waitcnt lgkmcnt(0)
    s_waitcnt vmcnt(59)
    v_mfma_f32_16x16x32_bf16 v[96:99], a[24:27], v[176:179], v[96:99]
    ds_read_b128 v[160:163], v1 offset:40960
    v_mfma_f32_16x16x32_bf16 v[100:103], a[24:27], v[180:183], v[100:103]
    ds_read_b128 v[164:167], v1 offset:41984
    v_mfma_f32_16x16x32_bf16 v[104:107], a[24:27], v[184:187], v[104:107]
    ds_read_b128 v[168:171], v1 offset:43008
    v_mfma_f32_16x16x32_bf16 v[108:111], a[24:27], v[188:191], v[108:111]
    ds_read_b128 v[172:175], v1 offset:44032
    buffer_load_dwordx4 a[24:27], v1, s[4:7], s86 offen offset:2048 sc1
    s_waitcnt vmcnt(59)
    v_mfma_f32_16x16x32_bf16 v[112:115], a[28:31], v[176:179], v[112:115]
    v_mfma_f32_16x16x32_bf16 v[116:119], a[28:31], v[180:183], v[116:119]
    v_mfma_f32_16x16x32_bf16 v[120:123], a[28:31], v[184:187], v[120:123]
    v_mfma_f32_16x16x32_bf16 v[124:127], a[28:31], v[188:191], v[124:127]
    buffer_load_dwordx4 a[28:31], v1, s[4:7], s86 offen offset:3072 sc1
    s_waitcnt vmcnt(59)
    v_mfma_f32_16x16x32_bf16 v[128:131], a[32:35], v[176:179], v[128:131]
    v_mfma_f32_16x16x32_bf16 v[132:135], a[32:35], v[180:183], v[132:135]
    v_mfma_f32_16x16x32_bf16 v[136:139], a[32:35], v[184:187], v[136:139]
    v_mfma_f32_16x16x32_bf16 v[140:143], a[32:35], v[188:191], v[140:143]
    s_add_u32 s86, s87, 192512
    buffer_load_dwordx4 a[32:35], v1, s[4:7], s86 offen offset:0 sc1
    s_waitcnt vmcnt(59)
    v_mfma_f32_16x16x32_bf16 v[144:147], a[36:39], v[176:179], v[144:147]
    v_mfma_f32_16x16x32_bf16 v[148:151], a[36:39], v[180:183], v[148:151]
    v_mfma_f32_16x16x32_bf16 v[152:155], a[36:39], v[184:187], v[152:155]
    v_mfma_f32_16x16x32_bf16 v[156:159], a[36:39], v[188:191], v[156:159]
    buffer_load_dwordx4 a[36:39], v1, s[4:7], s86 offen offset:1024 sc1
    s_waitcnt lgkmcnt(0)
    s_waitcnt vmcnt(59)
    v_mfma_f32_16x16x32_bf16 v[96:99], a[40:43], v[160:163], v[96:99]
    ds_read_b128 v[176:179], v1 offset:45056
    v_mfma_f32_16x16x32_bf16 v[100:103], a[40:43], v[164:167], v[100:103]
    ds_read_b128 v[180:183], v1 offset:46080
    v_mfma_f32_16x16x32_bf16 v[104:107], a[40:43], v[168:171], v[104:107]
    ds_read_b128 v[184:187], v1 offset:47104
    v_mfma_f32_16x16x32_bf16 v[108:111], a[40:43], v[172:175], v[108:111]
    ds_read_b128 v[188:191], v1 offset:48128
    buffer_load_dwordx4 a[40:43], v1, s[4:7], s86 offen offset:2048 sc1
    s_waitcnt vmcnt(59)
    v_mfma_f32_16x16x32_bf16 v[112:115], a[44:47], v[160:163], v[112:115]
    v_mfma_f32_16x16x32_bf16 v[116:119], a[44:47], v[164:167], v[116:119]
    v_mfma_f32_16x16x32_bf16 v[120:123], a[44:47], v[168:171], v[120:123]
    v_mfma_f32_16x16x32_bf16 v[124:127], a[44:47], v[172:175], v[124:127]
    buffer_load_dwordx4 a[44:47], v1, s[4:7], s86 offen offset:3072 sc1
    s_waitcnt vmcnt(59)
    v_mfma_f32_16x16x32_bf16 v[128:131], a[48:51], v[160:163], v[128:131]
    v_mfma_f32_16x16x32_bf16 v[132:135], a[48:51], v[164:167], v[132:135]
    v_mfma_f32_16x16x32_bf16 v[136:139], a[48:51], v[168:171], v[136:139]
    v_mfma_f32_16x16x32_bf16 v[140:143], a[48:51], v[172:175], v[140:143]
    s_add_u32 s86, s87, 196608
    buffer_load_dwordx4 a[48:51], v1, s[4:7], s86 offen offset:0 sc1
    s_waitcnt vmcnt(59)
    v_mfma_f32_16x16x32_bf16 v[144:147], a[52:55], v[160:163], v[144:147]
    v_mfma_f32_16x16x32_bf16 v[148:151], a[52:55], v[164:167], v[148:151]
    v_mfma_f32_16x16x32_bf16 v[152:155], a[52:55], v[168:171], v[152:155]
    v_mfma_f32_16x16x32_bf16 v[156:159], a[52:55], v[172:175], v[156:159]
    buffer_load_dwordx4 a[52:55], v1, s[4:7], s86 offen offset:1024 sc1
    s_waitcnt lgkmcnt(0)
    s_waitcnt vmcnt(59)
    v_mfma_f32_16x16x32_bf16 v[96:99], a[56:59], v[176:179], v[96:99]
    ds_read_b128 v[160:163], v1 offset:49152
    v_mfma_f32_16x16x32_bf16 v[100:103], a[56:59], v[180:183], v[100:103]
    ds_read_b128 v[164:167], v1 offset:50176
    v_mfma_f32_16x16x32_bf16 v[104:107], a[56:59], v[184:187], v[104:107]
    ds_read_b128 v[168:171], v1 offset:51200
    v_mfma_f32_16x16x32_bf16 v[108:111], a[56:59], v[188:191], v[108:111]
    ds_read_b128 v[172:175], v1 offset:52224
    buffer_load_dwordx4 a[56:59], v1, s[4:7], s86 offen offset:2048 sc1
    s_waitcnt vmcnt(59)
    v_mfma_f32_16x16x32_bf16 v[112:115], a[60:63], v[176:179], v[112:115]
    v_mfma_f32_16x16x32_bf16 v[116:119], a[60:63], v[180:183], v[116:119]
    v_mfma_f32_16x16x32_bf16 v[120:123], a[60:63], v[184:187], v[120:123]
    v_mfma_f32_16x16x32_bf16 v[124:127], a[60:63], v[188:191], v[124:127]
    buffer_load_dwordx4 a[60:63], v1, s[4:7], s86 offen offset:3072 sc1
    s_waitcnt vmcnt(59)
    v_mfma_f32_16x16x32_bf16 v[128:131], a[64:67], v[176:179], v[128:131]
    v_mfma_f32_16x16x32_bf16 v[132:135], a[64:67], v[180:183], v[132:135]
    v_mfma_f32_16x16x32_bf16 v[136:139], a[64:67], v[184:187], v[136:139]
    v_mfma_f32_16x16x32_bf16 v[140:143], a[64:67], v[188:191], v[140:143]
    s_add_u32 s86, s87, 200704
    buffer_load_dwordx4 a[64:67], v1, s[4:7], s86 offen offset:0 sc1
    s_waitcnt vmcnt(59)
    v_mfma_f32_16x16x32_bf16 v[144:147], a[68:71], v[176:179], v[144:147]
    v_mfma_f32_16x16x32_bf16 v[148:151], a[68:71], v[180:183], v[148:151]
    v_mfma_f32_16x16x32_bf16 v[152:155], a[68:71], v[184:187], v[152:155]
    v_mfma_f32_16x16x32_bf16 v[156:159], a[68:71], v[188:191], v[156:159]
    buffer_load_dwordx4 a[68:71], v1, s[4:7], s86 offen offset:1024 sc1
    s_waitcnt lgkmcnt(0)
    s_waitcnt vmcnt(59)
    v_mfma_f32_16x16x32_bf16 v[96:99], a[72:75], v[160:163], v[96:99]
    ds_read_b128 v[176:179], v1 offset:53248
    v_mfma_f32_16x16x32_bf16 v[100:103], a[72:75], v[164:167], v[100:103]
    ds_read_b128 v[180:183], v1 offset:54272
    v_mfma_f32_16x16x32_bf16 v[104:107], a[72:75], v[168:171], v[104:107]
    ds_read_b128 v[184:187], v1 offset:55296
    v_mfma_f32_16x16x32_bf16 v[108:111], a[72:75], v[172:175], v[108:111]
    ds_read_b128 v[188:191], v1 offset:56320
    buffer_load_dwordx4 a[72:75], v1, s[4:7], s86 offen offset:2048 sc1
    s_waitcnt vmcnt(59)
    v_mfma_f32_16x16x32_bf16 v[112:115], a[76:79], v[160:163], v[112:115]
    v_mfma_f32_16x16x32_bf16 v[116:119], a[76:79], v[164:167], v[116:119]
    v_mfma_f32_16x16x32_bf16 v[120:123], a[76:79], v[168:171], v[120:123]
    v_mfma_f32_16x16x32_bf16 v[124:127], a[76:79], v[172:175], v[124:127]
    buffer_load_dwordx4 a[76:79], v1, s[4:7], s86 offen offset:3072 sc1
    s_waitcnt vmcnt(59)
    v_mfma_f32_16x16x32_bf16 v[128:131], a[80:83], v[160:163], v[128:131]
    v_mfma_f32_16x16x32_bf16 v[132:135], a[80:83], v[164:167], v[132:135]
    v_mfma_f32_16x16x32_bf16 v[136:139], a[80:83], v[168:171], v[136:139]
    v_mfma_f32_16x16x32_bf16 v[140:143], a[80:83], v[172:175], v[140:143]
    s_add_u32 s86, s87, 204800
    buffer_load_dwordx4 a[80:83], v1, s[4:7], s86 offen offset:0 sc1
    s_waitcnt vmcnt(59)
    v_mfma_f32_16x16x32_bf16 v[144:147], a[84:87], v[160:163], v[144:147]
    v_mfma_f32_16x16x32_bf16 v[148:151], a[84:87], v[164:167], v[148:151]
    v_mfma_f32_16x16x32_bf16 v[152:155], a[84:87], v[168:171], v[152:155]
    v_mfma_f32_16x16x32_bf16 v[156:159], a[84:87], v[172:175], v[156:159]
    buffer_load_dwordx4 a[84:87], v1, s[4:7], s86 offen offset:1024 sc1
    s_waitcnt lgkmcnt(0)
    s_waitcnt vmcnt(59)
    v_mfma_f32_16x16x32_bf16 v[96:99], a[88:91], v[176:179], v[96:99]
    ds_read_b128 v[160:163], v1 offset:57344
    v_mfma_f32_16x16x32_bf16 v[100:103], a[88:91], v[180:183], v[100:103]
    ds_read_b128 v[164:167], v1 offset:58368
    v_mfma_f32_16x16x32_bf16 v[104:107], a[88:91], v[184:187], v[104:107]
    ds_read_b128 v[168:171], v1 offset:59392
    v_mfma_f32_16x16x32_bf16 v[108:111], a[88:91], v[188:191], v[108:111]
    ds_read_b128 v[172:175], v1 offset:60416
    buffer_load_dwordx4 a[88:91], v1, s[4:7], s86 offen offset:2048 sc1
    s_waitcnt vmcnt(59)
    v_mfma_f32_16x16x32_bf16 v[112:115], a[92:95], v[176:179], v[112:115]
    v_mfma_f32_16x16x32_bf16 v[116:119], a[92:95], v[180:183], v[116:119]
    v_mfma_f32_16x16x32_bf16 v[120:123], a[92:95], v[184:187], v[120:123]
    v_mfma_f32_16x16x32_bf16 v[124:127], a[92:95], v[188:191], v[124:127]
    buffer_load_dwordx4 a[92:95], v1, s[4:7], s86 offen offset:3072 sc1
    s_waitcnt vmcnt(59)
    v_mfma_f32_16x16x32_bf16 v[128:131], a[96:99], v[176:179], v[128:131]
    v_mfma_f32_16x16x32_bf16 v[132:135], a[96:99], v[180:183], v[132:135]
    v_mfma_f32_16x16x32_bf16 v[136:139], a[96:99], v[184:187], v[136:139]
    v_mfma_f32_16x16x32_bf16 v[140:143], a[96:99], v[188:191], v[140:143]
    s_add_u32 s86, s87, 208896
    buffer_load_dwordx4 a[96:99], v1, s[4:7], s86 offen offset:0 sc1
    s_waitcnt vmcnt(59)
    v_mfma_f32_16x16x32_bf16 v[144:147], a[100:103], v[176:179], v[144:147]
    v_mfma_f32_16x16x32_bf16 v[148:151], a[100:103], v[180:183], v[148:151]
    v_mfma_f32_16x16x32_bf16 v[152:155], a[100:103], v[184:187], v[152:155]
    v_mfma_f32_16x16x32_bf16 v[156:159], a[100:103], v[188:191], v[156:159]
    buffer_load_dwordx4 a[100:103], v1, s[4:7], s86 offen offset:1024 sc1
    s_waitcnt lgkmcnt(0)
    s_waitcnt vmcnt(59)
    v_mfma_f32_16x16x32_bf16 v[96:99], a[104:107], v[160:163], v[96:99]
    ds_read_b128 v[176:179], v1 offset:61440
    v_mfma_f32_16x16x32_bf16 v[100:103], a[104:107], v[164:167], v[100:103]
    ds_read_b128 v[180:183], v1 offset:62464
    v_mfma_f32_16x16x32_bf16 v[104:107], a[104:107], v[168:171], v[104:107]
    ds_read_b128 v[184:187], v1 offset:63488
    v_mfma_f32_16x16x32_bf16 v[108:111], a[104:107], v[172:175], v[108:111]
    ds_read_b128 v[188:191], v1 offset:64512
    buffer_load_dwordx4 a[104:107], v1, s[4:7], s86 offen offset:2048 sc1
    s_waitcnt vmcnt(59)
    v_mfma_f32_16x16x32_bf16 v[112:115], a[108:111], v[160:163], v[112:115]
    v_mfma_f32_16x16x32_bf16 v[116:119], a[108:111], v[164:167], v[116:119]
    v_mfma_f32_16x16x32_bf16 v[120:123], a[108:111], v[168:171], v[120:123]
    v_mfma_f32_16x16x32_bf16 v[124:127], a[108:111], v[172:175], v[124:127]
    buffer_load_dwordx4 a[108:111], v1, s[4:7], s86 offen offset:3072 sc1
    s_waitcnt vmcnt(59)
    v_mfma_f32_16x16x32_bf16 v[128:131], a[112:115], v[160:163], v[128:131]
    v_mfma_f32_16x16x32_bf16 v[132:135], a[112:115], v[164:167], v[132:135]
    v_mfma_f32_16x16x32_bf16 v[136:139], a[112:115], v[168:171], v[136:139]
    v_mfma_f32_16x16x32_bf16 v[140:143], a[112:115], v[172:175], v[140:143]
    s_add_u32 s86, s87, 212992
    buffer_load_dwordx4 a[112:115], v1, s[4:7], s86 offen offset:0 sc1
    s_waitcnt vmcnt(59)
    v_mfma_f32_16x16x32_bf16 v[144:147], a[116:119], v[160:163], v[144:147]
    v_mfma_f32_16x16x32_bf16 v[148:151], a[116:119], v[164:167], v[148:151]
    v_mfma_f32_16x16x32_bf16 v[152:155], a[116:119], v[168:171], v[152:155]
    v_mfma_f32_16x16x32_bf16 v[156:159], a[116:119], v[172:175], v[156:159]
    buffer_load_dwordx4 a[116:119], v1, s[4:7], s86 offen offset:1024 sc1
    s_waitcnt lgkmcnt(0)
    s_waitcnt vmcnt(59)
    v_mfma_f32_16x16x32_bf16 v[96:99], a[120:123], v[176:179], v[96:99]
    ds_read_b128 v[160:163], v210 offset:0
    v_mfma_f32_16x16x32_bf16 v[100:103], a[120:123], v[180:183], v[100:103]
    ds_read_b128 v[164:167], v210 offset:1024
    v_mfma_f32_16x16x32_bf16 v[104:107], a[120:123], v[184:187], v[104:107]
    ds_read_b128 v[168:171], v210 offset:2048
    v_mfma_f32_16x16x32_bf16 v[108:111], a[120:123], v[188:191], v[108:111]
    ds_read_b128 v[172:175], v210 offset:3072
    buffer_load_dwordx4 a[120:123], v1, s[4:7], s86 offen offset:2048 sc1
    s_waitcnt vmcnt(59)
    v_mfma_f32_16x16x32_bf16 v[112:115], a[124:127], v[176:179], v[112:115]
    v_mfma_f32_16x16x32_bf16 v[116:119], a[124:127], v[180:183], v[116:119]
    v_mfma_f32_16x16x32_bf16 v[120:123], a[124:127], v[184:187], v[120:123]
    v_mfma_f32_16x16x32_bf16 v[124:127], a[124:127], v[188:191], v[124:127]
    buffer_load_dwordx4 a[124:127], v1, s[4:7], s86 offen offset:3072 sc1
    s_waitcnt vmcnt(59)
    v_mfma_f32_16x16x32_bf16 v[128:131], a[128:131], v[176:179], v[128:131]
    v_mfma_f32_16x16x32_bf16 v[132:135], a[128:131], v[180:183], v[132:135]
    v_mfma_f32_16x16x32_bf16 v[136:139], a[128:131], v[184:187], v[136:139]
    v_mfma_f32_16x16x32_bf16 v[140:143], a[128:131], v[188:191], v[140:143]
    s_add_u32 s86, s87, 217088
    buffer_load_dwordx4 a[128:131], v1, s[4:7], s86 offen offset:0 sc1
    s_waitcnt vmcnt(59)
    v_mfma_f32_16x16x32_bf16 v[144:147], a[132:135], v[176:179], v[144:147]
    v_mfma_f32_16x16x32_bf16 v[148:151], a[132:135], v[180:183], v[148:151]
    v_mfma_f32_16x16x32_bf16 v[152:155], a[132:135], v[184:187], v[152:155]
    v_mfma_f32_16x16x32_bf16 v[156:159], a[132:135], v[188:191], v[156:159]
    buffer_load_dwordx4 a[132:135], v1, s[4:7], s86 offen offset:1024 sc1
    s_waitcnt lgkmcnt(0)
    s_waitcnt vmcnt(59)
    v_mfma_f32_16x16x32_bf16 v[96:99], a[136:139], v[160:163], v[96:99]
    ds_read_b128 v[176:179], v210 offset:4096
    v_mfma_f32_16x16x32_bf16 v[100:103], a[136:139], v[164:167], v[100:103]
    ds_read_b128 v[180:183], v210 offset:5120
    v_mfma_f32_16x16x32_bf16 v[104:107], a[136:139], v[168:171], v[104:107]
    ds_read_b128 v[184:187], v210 offset:6144
    v_mfma_f32_16x16x32_bf16 v[108:111], a[136:139], v[172:175], v[108:111]
    ds_read_b128 v[188:191], v210 offset:7168
    buffer_load_dwordx4 a[136:139], v1, s[4:7], s86 offen offset:2048 sc1
    s_waitcnt vmcnt(59)
    v_mfma_f32_16x16x32_bf16 v[112:115], a[140:143], v[160:163], v[112:115]
    v_mfma_f32_16x16x32_bf16 v[116:119], a[140:143], v[164:167], v[116:119]
    v_mfma_f32_16x16x32_bf16 v[120:123], a[140:143], v[168:171], v[120:123]
    v_mfma_f32_16x16x32_bf16 v[124:127], a[140:143], v[172:175], v[124:127]
    buffer_load_dwordx4 a[140:143], v1, s[4:7], s86 offen offset:3072 sc1
    s_waitcnt vmcnt(59)
    v_mfma_f32_16x16x32_bf16 v[128:131], a[144:147], v[160:163], v[128:131]
    v_mfma_f32_16x16x32_bf16 v[132:135], a[144:147], v[164:167], v[132:135]
    v_mfma_f32_16x16x32_bf16 v[136:139], a[144:147], v[168:171], v[136:139]
    v_mfma_f32_16x16x32_bf16 v[140:143], a[144:147], v[172:175], v[140:143]
    s_add_u32 s86, s87, 221184
    buffer_load_dwordx4 a[144:147], v1, s[4:7], s86 offen offset:0 sc1
    s_waitcnt vmcnt(59)
    v_mfma_f32_16x16x32_bf16 v[144:147], a[148:151], v[160:163], v[144:147]
    v_mfma_f32_16x16x32_bf16 v[148:151], a[148:151], v[164:167], v[148:151]
    v_mfma_f32_16x16x32_bf16 v[152:155], a[148:151], v[168:171], v[152:155]
    v_mfma_f32_16x16x32_bf16 v[156:159], a[148:151], v[172:175], v[156:159]
    buffer_load_dwordx4 a[148:151], v1, s[4:7], s86 offen offset:1024 sc1
    s_waitcnt lgkmcnt(0)
    s_waitcnt vmcnt(59)
    v_mfma_f32_16x16x32_bf16 v[96:99], a[152:155], v[176:179], v[96:99]
    s_barrier
    v_mfma_f32_16x16x32_bf16 v[100:103], a[152:155], v[180:183], v[100:103]
    ds_read_b128 v[160:163], v211 offset:0
    v_mfma_f32_16x16x32_bf16 v[104:107], a[152:155], v[184:187], v[104:107]
    ds_read_b128 v[164:167], v211 offset:1024
    v_mfma_f32_16x16x32_bf16 v[108:111], a[152:155], v[188:191], v[108:111]
    ds_read_b128 v[168:171], v211 offset:2048
    buffer_load_dwordx4 a[152:155], v1, s[4:7], s86 offen offset:2048 sc1
    s_waitcnt vmcnt(59)
    v_mfma_f32_16x16x32_bf16 v[112:115], a[156:159], v[176:179], v[112:115]
    ds_read_b128 v[172:175], v211 offset:3072
    v_mfma_f32_16x16x32_bf16 v[116:119], a[156:159], v[180:183], v[116:119]
    v_mfma_f32_16x16x32_bf16 v[120:123], a[156:159], v[184:187], v[120:123]
    v_mfma_f32_16x16x32_bf16 v[124:127], a[156:159], v[188:191], v[124:127]
    buffer_load_dwordx4 a[156:159], v1, s[4:7], s86 offen offset:3072 sc1
    s_waitcnt vmcnt(59)
    v_mfma_f32_16x16x32_bf16 v[128:131], a[160:163], v[176:179], v[128:131]
    v_mfma_f32_16x16x32_bf16 v[132:135], a[160:163], v[180:183], v[132:135]
    v_mfma_f32_16x16x32_bf16 v[136:139], a[160:163], v[184:187], v[136:139]
    v_mfma_f32_16x16x32_bf16 v[140:143], a[160:163], v[188:191], v[140:143]
    s_add_u32 s86, s87, 225280
    buffer_load_dwordx4 a[160:163], v1, s[4:7], s86 offen offset:0 sc1
    s_waitcnt vmcnt(59)
    v_mfma_f32_16x16x32_bf16 v[144:147], a[164:167], v[176:179], v[144:147]
    v_mfma_f32_16x16x32_bf16 v[148:151], a[164:167], v[180:183], v[148:151]
    v_mfma_f32_16x16x32_bf16 v[152:155], a[164:167], v[184:187], v[152:155]
    v_mfma_f32_16x16x32_bf16 v[156:159], a[164:167], v[188:191], v[156:159]
    buffer_load_dwordx4 a[164:167], v1, s[4:7], s86 offen offset:1024 sc1
    s_waitcnt lgkmcnt(0)
    s_waitcnt vmcnt(59)
    v_mfma_f32_16x16x32_bf16 v[16:19], a[168:171], v[160:163], 0
    ds_read_b128 v[176:179], v211 offset:4096
    v_cvt_pk_bf16_f32 v192, v96, v97
    v_mfma_f32_16x16x32_bf16 v[20:23], a[168:171], v[164:167], 0
    ds_read_b128 v[180:183], v211 offset:5120
    v_cvt_pk_bf16_f32 v193, v98, v99
    v_mfma_f32_16x16x32_bf16 v[24:27], a[168:171], v[168:171], 0
    ds_read_b128 v[184:187], v211 offset:6144
    v_cvt_pk_bf16_f32 v194, v112, v113
    v_mfma_f32_16x16x32_bf16 v[28:31], a[168:171], v[172:175], 0
    ds_read_b128 v[188:191], v211 offset:7168
    buffer_load_dwordx4 a[168:171], v1, s[4:7], s86 offen offset:2048 sc1
    s_waitcnt vmcnt(59)
    v_mfma_f32_16x16x32_bf16 v[32:35], a[172:175], v[160:163], 0
    v_cvt_pk_bf16_f32 v195, v114, v115
    v_pk_max_i16 v192, v192, 0
    v_mfma_f32_16x16x32_bf16 v[36:39], a[172:175], v[164:167], 0
    v_pk_max_i16 v193, v193, 0
    v_pk_max_i16 v194, v194, 0
    v_mfma_f32_16x16x32_bf16 v[40:43], a[172:175], v[168:171], 0
    v_pk_max_i16 v195, v195, 0
    ds_write_b128 v213, v[192:195] offset:32768
    v_mfma_f32_16x16x32_bf16 v[44:47], a[172:175], v[172:175], 0
    buffer_load_dwordx4 a[172:175], v1, s[4:7], s86 offen offset:3072 sc1
    s_waitcnt vmcnt(59)
    v_mfma_f32_16x16x32_bf16 v[48:51], a[176:179], v[160:163], 0
    v_cvt_pk_bf16_f32 v196, v100, v101
    v_cvt_pk_bf16_f32 v197, v102, v103
    v_mfma_f32_16x16x32_bf16 v[52:55], a[176:179], v[164:167], 0
    v_cvt_pk_bf16_f32 v198, v116, v117
    v_cvt_pk_bf16_f32 v199, v118, v119
    v_mfma_f32_16x16x32_bf16 v[56:59], a[176:179], v[168:171], 0
    v_pk_max_i16 v196, v196, 0
    v_pk_max_i16 v197, v197, 0
    v_mfma_f32_16x16x32_bf16 v[60:63], a[176:179], v[172:175], 0
    s_add_u32 s86, s87, 229376
    buffer_load_dwordx4 a[176:179], v1, s[4:7], s86 offen offset:0 sc1
    s_waitcnt lgkmcnt(1)
    s_waitcnt vmcnt(59)
    v_mfma_f32_16x16x32_bf16 v[16:19], a[180:183], v[176:179], v[16:19]
    ds_read_b128 v[160:163], v211 offset:8192
    v_pk_max_i16 v198, v198, 0
    v_mfma_f32_16x16x32_bf16 v[20:23], a[180:183], v[180:183], v[20:23]
    ds_read_b128 v[164:167], v211 offset:9216
    v_pk_max_i16 v199, v199, 0
    v_mfma_f32_16x16x32_bf16 v[24:27], a[180:183], v[184:187], v[24:27]
    ds_read_b128 v[168:171], v211 offset:10240
    ds_write_b128 v213, v[196:199] offset:33792
    v_mfma_f32_16x16x32_bf16 v[28:31], a[180:183], v[188:191], v[28:31]
    ds_read_b128 v[172:175], v211 offset:11264
    buffer_load_dwordx4 a[180:183], v1, s[4:7], s86 offen offset:1024 sc1
    s_waitcnt vmcnt(59)
    v_mfma_f32_16x16x32_bf16 v[32:35], a[184:187], v[176:179], v[32:35]
    v_cvt_pk_bf16_f32 v200, v104, v105
    v_cvt_pk_bf16_f32 v201, v106, v107
    v_mfma_f32_16x16x32_bf16 v[36:39], a[184:187], v[180:183], v[36:39]
    v_cvt_pk_bf16_f32 v202, v120, v121
    v_cvt_pk_bf16_f32 v203, v122, v123
    v_mfma_f32_16x16x32_bf16 v[40:43], a[184:187], v[184:187], v[40:43]
    v_pk_max_i16 v200, v200, 0
    v_pk_max_i16 v201, v201, 0
    v_mfma_f32_16x16x32_bf16 v[44:47], a[184:187], v[188:191], v[44:47]
    buffer_load_dwordx4 a[184:187], v1, s[4:7], s86 offen offset:2048 sc1
    s_waitcnt vmcnt(59)
    v_mfma_f32_16x16x32_bf16 v[48:51], a[188:191], v[176:179], v[48:51]
    v_pk_max_i16 v202, v202, 0
    v_pk_max_i16 v203, v203, 0
    v_mfma_f32_16x16x32_bf16 v[52:55], a[188:191], v[180:183], v[52:55]
    ds_write_b128 v213, v[200:203] offset:34816
    v_cvt_pk_bf16_f32 v204, v108, v109
    v_mfma_f32_16x16x32_bf16 v[56:59], a[188:191], v[184:187], v[56:59]
    v_cvt_pk_bf16_f32 v205, v110, v111
    v_cvt_pk_bf16_f32 v206, v124, v125
    v_mfma_f32_16x16x32_bf16 v[60:63], a[188:191], v[188:191], v[60:63]
    buffer_load_dwordx4 a[188:191], v1, s[4:7], s86 offen offset:3072 sc1
    s_waitcnt lgkmcnt(1)
    s_waitcnt vmcnt(59)
    v_mfma_f32_16x16x32_bf16 v[16:19], a[192:195], v[160:163], v[16:19]
    ds_read_b128 v[176:179], v211 offset:12288
    v_cvt_pk_bf16_f32 v207, v126, v127
    v_mfma_f32_16x16x32_bf16 v[20:23], a[192:195], v[164:167], v[20:23]
    ds_read_b128 v[180:183], v211 offset:13312
    v_pk_max_i16 v204, v204, 0
    v_mfma_f32_16x16x32_bf16 v[24:27], a[192:195], v[168:171], v[24:27]
    ds_read_b128 v[184:187], v211 offset:14336
    v_pk_max_i16 v205, v205, 0
    v_mfma_f32_16x16x32_bf16 v[28:31], a[192:195], v[172:175], v[28:31]
    ds_read_b128 v[188:191], v211 offset:15360
    s_add_u32 s86, s87, 233472
    buffer_load_dwordx4 a[192:195], v1, s[4:7], s86 offen offset:0 sc1
    s_waitcnt vmcnt(59)
    v_mfma_f32_16x16x32_bf16 v[32:35], a[196:199], v[160:163], v[32:35]
    v_pk_max_i16 v206, v206, 0
    v_pk_max_i16 v207, v207, 0
    v_mfma_f32_16x16x32_bf16 v[36:39], a[196:199], v[164:167], v[36:39]
    ds_write_b128 v213, v[204:207] offset:35840
    v_cvt_pk_bf16_f32 v192, v128, v129
    v_mfma_f32_16x16x32_bf16 v[40:43], a[196:199], v[168:171], v[40:43]
    v_cvt_pk_bf16_f32 v193, v130, v131
    v_cvt_pk_bf16_f32 v194, v144, v145
    v_mfma_f32_16x16x32_bf16 v[44:47], a[196:199], v[172:175], v[44:47]
    buffer_load_dwordx4 a[196:199], v1, s[4:7], s86 offen offset:1024 sc1
    s_waitcnt vmcnt(59)
    v_mfma_f32_16x16x32_bf16 v[48:51], a[200:203], v[160:163], v[48:51]
    v_cvt_pk_bf16_f32 v195, v146, v147
    v_pk_max_i16 v192, v192, 0
    v_mfma_f32_16x16x32_bf16 v[52:55], a[200:203], v[164:167], v[52:55]
    v_pk_max_i16 v193, v193, 0
    v_pk_max_i16 v194, v194, 0
    v_mfma_f32_16x16x32_bf16 v[56:59], a[200:203], v[168:171], v[56:59]
    v_pk_max_i16 v195, v195, 0
    ds_write_b128 v213, v[192:195] offset:49152
    v_mfma_f32_16x16x32_bf16 v[60:63], a[200:203], v[172:175], v[60:63]
    buffer_load_dwordx4 a[200:203], v1, s[4:7], s86 offen offset:2048 sc1
    s_waitcnt lgkmcnt(2)
    s_waitcnt vmcnt(59)
    v_mfma_f32_16x16x32_bf16 v[16:19], a[204:207], v[176:179], v[16:19]
    ds_read_b128 v[160:163], v211 offset:16384
    v_cvt_pk_bf16_f32 v196, v132, v133
    v_mfma_f32_16x16x32_bf16 v[20:23], a[204:207], v[180:183], v[20:23]
    ds_read_b128 v[164:167], v211 offset:17408
    v_cvt_pk_bf16_f32 v197, v134, v135
    v_mfma_f32_16x16x32_bf16 v[24:27], a[204:207], v[184:187], v[24:27]
    ds_read_b128 v[168:171], v211 offset:18432
    v_cvt_pk_bf16_f32 v198, v148, v149
    v_mfma_f32_16x16x32_bf16 v[28:31], a[204:207], v[188:191], v[28:31]
    ds_read_b128 v[172:175], v211 offset:19456
    buffer_load_dwordx4 a[204:207], v1, s[4:7], s86 offen offset:3072 sc1
    s_waitcnt vmcnt(59)
    v_mfma_f32_16x16x32_bf16 v[32:35], a[208:211], v[176:179], v[32:35]
    v_cvt_pk_bf16_f32 v199, v150, v151
    v_pk_max_i16 v196, v196, 0
    v_mfma_f32_16x16x32_bf16 v[36:39], a[208:211], v[180:183], v[36:39]
    v_pk_max_i16 v197, v197, 0
    v_pk_max_i16 v198, v198, 0
    v_mfma_f32_16x16x32_bf16 v[40:43], a[208:211], v[184:187], v[40:43]
    v_pk_max_i16 v199, v199, 0
    ds_write_b128 v213, v[196:199] offset:50176
    v_mfma_f32_16x16x32_bf16 v[44:47], a[208:211], v[188:191], v[44:47]
    s_add_u32 s86, s87, 237568
    buffer_load_dwordx4 a[208:211], v1, s[4:7], s86 offen offset:0 sc1
    s_waitcnt vmcnt(59)
    v_mfma_f32_16x16x32_bf16 v[48:51], a[212:215], v[176:179], v[48:51]
    v_cvt_pk_bf16_f32 v200, v136, v137
    v_cvt_pk_bf16_f32 v201, v138, v139
    v_mfma_f32_16x16x32_bf16 v[52:55], a[212:215], v[180:183], v[52:55]
    v_cvt_pk_bf16_f32 v202, v152, v153
    v_cvt_pk_bf16_f32 v203, v154, v155
    v_mfma_f32_16x16x32_bf16 v[56:59], a[212:215], v[184:187], v[56:59]
    v_pk_max_i16 v200, v200, 0
    v_pk_max_i16 v201, v201, 0
    v_mfma_f32_16x16x32_bf16 v[60:63], a[212:215], v[188:191], v[60:63]
    buffer_load_dwordx4 a[212:215], v1, s[4:7], s86 offen offset:1024 sc1
    s_waitcnt lgkmcnt(1)
    s_waitcnt vmcnt(59)
    v_mfma_f32_16x16x32_bf16 v[16:19], a[216:219], v[160:163], v[16:19]
    ds_read_b128 v[176:179], v211 offset:20480
    v_pk_max_i16 v202, v202, 0
    v_mfma_f32_16x16x32_bf16 v[20:23], a[216:219], v[164:167], v[20:23]
    ds_read_b128 v[180:183], v211 offset:21504
    v_pk_max_i16 v203, v203, 0
    v_mfma_f32_16x16x32_bf16 v[24:27], a[216:219], v[168:171], v[24:27]
    ds_read_b128 v[184:187], v211 offset:22528
    ds_write_b128 v213, v[200:203] offset:51200
    v_mfma_f32_16x16x32_bf16 v[28:31], a[216:219], v[172:175], v[28:31]
    ds_read_b128 v[188:191], v211 offset:23552
    buffer_load_dwordx4 a[216:219], v1, s[4:7], s86 offen offset:2048 sc1
    s_waitcnt vmcnt(59)
    v_mfma_f32_16x16x32_bf16 v[32:35], a[220:223], v[160:163], v[32:35]
    v_cvt_pk_bf16_f32 v204, v140, v141
    v_cvt_pk_bf16_f32 v205, v142, v143
    v_mfma_f32_16x16x32_bf16 v[36:39], a[220:223], v[164:167], v[36:39]
    v_cvt_pk_bf16_f32 v206, v156, v157
    v_cvt_pk_bf16_f32 v207, v158, v159
    v_mfma_f32_16x16x32_bf16 v[40:43], a[220:223], v[168:171], v[40:43]
    v_pk_max_i16 v204, v204, 0
    v_pk_max_i16 v205, v205, 0
    v_mfma_f32_16x16x32_bf16 v[44:47], a[220:223], v[172:175], v[44:47]
    buffer_load_dwordx4 a[220:223], v1, s[4:7], s86 offen offset:3072 sc1
    s_waitcnt vmcnt(59)
    v_mfma_f32_16x16x32_bf16 v[48:51], a[224:227], v[160:163], v[48:51]
    v_pk_max_i16 v206, v206, 0
    v_pk_max_i16 v207, v207, 0
    v_mfma_f32_16x16x32_bf16 v[52:55], a[224:227], v[164:167], v[52:55]
    ds_write_b128 v213, v[204:207] offset:52224
    v_mfma_f32_16x16x32_bf16 v[56:59], a[224:227], v[168:171], v[56:59]
    v_mfma_f32_16x16x32_bf16 v[60:63], a[224:227], v[172:175], v[60:63]
    s_add_u32 s86, s87, 241664
    buffer_load_dwordx4 a[224:227], v1, s[4:7], s86 offen offset:0 sc1
    s_waitcnt lgkmcnt(1)
    s_waitcnt vmcnt(59)
    v_mfma_f32_16x16x32_bf16 v[16:19], a[228:231], v[176:179], v[16:19]
    ds_read_b128 v[160:163], v211 offset:24576
    v_mfma_f32_16x16x32_bf16 v[20:23], a[228:231], v[180:183], v[20:23]
    ds_read_b128 v[164:167], v211 offset:25600
    v_mfma_f32_16x16x32_bf16 v[24:27], a[228:231], v[184:187], v[24:27]
    ds_read_b128 v[168:171], v211 offset:26624
    v_mfma_f32_16x16x32_bf16 v[28:31], a[228:231], v[188:191], v[28:31]
    ds_read_b128 v[172:175], v211 offset:27648
    buffer_load_dwordx4 a[228:231], v1, s[4:7], s86 offen offset:1024 sc1
    s_waitcnt vmcnt(59)
    v_mfma_f32_16x16x32_bf16 v[32:35], a[232:235], v[176:179], v[32:35]
    v_mfma_f32_16x16x32_bf16 v[36:39], a[232:235], v[180:183], v[36:39]
    v_mfma_f32_16x16x32_bf16 v[40:43], a[232:235], v[184:187], v[40:43]
    v_mfma_f32_16x16x32_bf16 v[44:47], a[232:235], v[188:191], v[44:47]
    buffer_load_dwordx4 a[232:235], v1, s[4:7], s86 offen offset:2048 sc1
    s_waitcnt vmcnt(59)
    v_mfma_f32_16x16x32_bf16 v[48:51], a[236:239], v[176:179], v[48:51]
    v_mfma_f32_16x16x32_bf16 v[52:55], a[236:239], v[180:183], v[52:55]
    v_mfma_f32_16x16x32_bf16 v[56:59], a[236:239], v[184:187], v[56:59]
    v_mfma_f32_16x16x32_bf16 v[60:63], a[236:239], v[188:191], v[60:63]
    buffer_load_dwordx4 a[236:239], v1, s[4:7], s86 offen offset:3072 sc1
    s_waitcnt lgkmcnt(0)
    s_waitcnt vmcnt(59)
    v_mfma_f32_16x16x32_bf16 v[16:19], a[0:3], v[160:163], v[16:19]
    ds_read_b128 v[176:179], v211 offset:28672
    v_mfma_f32_16x16x32_bf16 v[20:23], a[0:3], v[164:167], v[20:23]
    ds_read_b128 v[180:183], v211 offset:29696
    v_mfma_f32_16x16x32_bf16 v[24:27], a[0:3], v[168:171], v[24:27]
    ds_read_b128 v[184:187], v211 offset:30720
    v_mfma_f32_16x16x32_bf16 v[28:31], a[0:3], v[172:175], v[28:31]
    ds_read_b128 v[188:191], v211 offset:31744
    s_add_u32 s86, s87, 245760
    buffer_load_dwordx4 a[0:3], v1, s[4:7], s86 offen offset:0 sc1
    s_waitcnt vmcnt(59)
    v_mfma_f32_16x16x32_bf16 v[32:35], a[4:7], v[160:163], v[32:35]
    v_mfma_f32_16x16x32_bf16 v[36:39], a[4:7], v[164:167], v[36:39]
    v_mfma_f32_16x16x32_bf16 v[40:43], a[4:7], v[168:171], v[40:43]
    v_mfma_f32_16x16x32_bf16 v[44:47], a[4:7], v[172:175], v[44:47]
    buffer_load_dwordx4 a[4:7], v1, s[4:7], s86 offen offset:1024 sc1
    s_waitcnt vmcnt(59)
    v_mfma_f32_16x16x32_bf16 v[48:51], a[8:11], v[160:163], v[48:51]
    v_mfma_f32_16x16x32_bf16 v[52:55], a[8:11], v[164:167], v[52:55]
    v_mfma_f32_16x16x32_bf16 v[56:59], a[8:11], v[168:171], v[56:59]
    v_mfma_f32_16x16x32_bf16 v[60:63], a[8:11], v[172:175], v[60:63]
    buffer_load_dwordx4 a[8:11], v1, s[4:7], s86 offen offset:2048 sc1
    s_waitcnt lgkmcnt(0)
    s_waitcnt vmcnt(59)
    v_mfma_f32_16x16x32_bf16 v[16:19], a[12:15], v[176:179], v[16:19]
    ds_read_b128 v[160:163], v212 offset:0
    v_mfma_f32_16x16x32_bf16 v[20:23], a[12:15], v[180:183], v[20:23]
    ds_read_b128 v[164:167], v212 offset:1024
    v_mfma_f32_16x16x32_bf16 v[24:27], a[12:15], v[184:187], v[24:27]
    ds_read_b128 v[168:171], v212 offset:2048
    v_mfma_f32_16x16x32_bf16 v[28:31], a[12:15], v[188:191], v[28:31]
    ds_read_b128 v[172:175], v212 offset:3072
    buffer_load_dwordx4 a[12:15], v1, s[4:7], s86 offen offset:3072 sc1
    s_waitcnt vmcnt(59)
    v_mfma_f32_16x16x32_bf16 v[32:35], a[16:19], v[176:179], v[32:35]
    v_mfma_f32_16x16x32_bf16 v[36:39], a[16:19], v[180:183], v[36:39]
    v_mfma_f32_16x16x32_bf16 v[40:43], a[16:19], v[184:187], v[40:43]
    v_mfma_f32_16x16x32_bf16 v[44:47], a[16:19], v[188:191], v[44:47]
    s_add_u32 s86, s87, 249856
    buffer_load_dwordx4 a[16:19], v1, s[4:7], s86 offen offset:0 sc1
    s_waitcnt vmcnt(59)
    v_mfma_f32_16x16x32_bf16 v[48:51], a[20:23], v[176:179], v[48:51]
    v_mfma_f32_16x16x32_bf16 v[52:55], a[20:23], v[180:183], v[52:55]
    v_mfma_f32_16x16x32_bf16 v[56:59], a[20:23], v[184:187], v[56:59]
    v_mfma_f32_16x16x32_bf16 v[60:63], a[20:23], v[188:191], v[60:63]
    buffer_load_dwordx4 a[20:23], v1, s[4:7], s86 offen offset:1024 sc1
    s_waitcnt lgkmcnt(0)
    s_waitcnt vmcnt(59)
    v_mfma_f32_16x16x32_bf16 v[16:19], a[24:27], v[160:163], v[16:19]
    ds_read_b128 v[176:179], v212 offset:4096
    v_mfma_f32_16x16x32_bf16 v[20:23], a[24:27], v[164:167], v[20:23]
    ds_read_b128 v[180:183], v212 offset:5120
    v_mfma_f32_16x16x32_bf16 v[24:27], a[24:27], v[168:171], v[24:27]
    ds_read_b128 v[184:187], v212 offset:6144
    v_mfma_f32_16x16x32_bf16 v[28:31], a[24:27], v[172:175], v[28:31]
    ds_read_b128 v[188:191], v212 offset:7168
    buffer_load_dwordx4 a[24:27], v1, s[4:7], s86 offen offset:2048 sc1
    s_waitcnt vmcnt(59)
    v_mfma_f32_16x16x32_bf16 v[32:35], a[28:31], v[160:163], v[32:35]
    v_mfma_f32_16x16x32_bf16 v[36:39], a[28:31], v[164:167], v[36:39]
    v_mfma_f32_16x16x32_bf16 v[40:43], a[28:31], v[168:171], v[40:43]
    v_mfma_f32_16x16x32_bf16 v[44:47], a[28:31], v[172:175], v[44:47]
    buffer_load_dwordx4 a[28:31], v1, s[4:7], s86 offen offset:3072 sc1
    s_waitcnt vmcnt(59)
    v_mfma_f32_16x16x32_bf16 v[48:51], a[32:35], v[160:163], v[48:51]
    v_mfma_f32_16x16x32_bf16 v[52:55], a[32:35], v[164:167], v[52:55]
    v_mfma_f32_16x16x32_bf16 v[56:59], a[32:35], v[168:171], v[56:59]
    v_mfma_f32_16x16x32_bf16 v[60:63], a[32:35], v[172:175], v[60:63]
    s_add_u32 s86, s87, 253952
    buffer_load_dwordx4 a[32:35], v1, s[4:7], s86 offen offset:0 sc1
    s_waitcnt lgkmcnt(0)
    s_waitcnt vmcnt(59)
    v_mfma_f32_16x16x32_bf16 v[16:19], a[36:39], v[176:179], v[16:19]
    s_barrier
    v_mfma_f32_16x16x32_bf16 v[20:23], a[36:39], v[180:183], v[20:23]
    ds_read_b128 v[160:163], v211 offset:32768
    v_mfma_f32_16x16x32_bf16 v[24:27], a[36:39], v[184:187], v[24:27]
    ds_read_b128 v[164:167], v211 offset:33792
    v_mfma_f32_16x16x32_bf16 v[28:31], a[36:39], v[188:191], v[28:31]
    ds_read_b128 v[168:171], v211 offset:34816
    buffer_load_dwordx4 a[36:39], v1, s[4:7], s86 offen offset:1024 sc1
    s_waitcnt vmcnt(59)
    v_mfma_f32_16x16x32_bf16 v[32:35], a[40:43], v[176:179], v[32:35]
    ds_read_b128 v[172:175], v211 offset:35840
    v_mfma_f32_16x16x32_bf16 v[36:39], a[40:43], v[180:183], v[36:39]
    v_mfma_f32_16x16x32_bf16 v[40:43], a[40:43], v[184:187], v[40:43]
    v_mfma_f32_16x16x32_bf16 v[44:47], a[40:43], v[188:191], v[44:47]
    buffer_load_dwordx4 a[40:43], v1, s[4:7], s86 offen offset:2048 sc1
    s_waitcnt vmcnt(59)
    v_mfma_f32_16x16x32_bf16 v[48:51], a[44:47], v[176:179], v[48:51]
    v_mfma_f32_16x16x32_bf16 v[52:55], a[44:47], v[180:183], v[52:55]
    v_mfma_f32_16x16x32_bf16 v[56:59], a[44:47], v[184:187], v[56:59]
    v_mfma_f32_16x16x32_bf16 v[60:63], a[44:47], v[188:191], v[60:63]
    buffer_load_dwordx4 a[44:47], v1, s[4:7], s86 offen offset:3072 sc1
    s_waitcnt lgkmcnt(0)
    s_waitcnt vmcnt(59)
    v_mfma_f32_16x16x32_bf16 v[16:19], a[48:51], v[160:163], v[16:19]
    ds_read_b128 v[176:179], v211 offset:36864
    v_mfma_f32_16x16x32_bf16 v[20:23], a[48:51], v[164:167], v[20:23]
    ds_read_b128 v[180:183], v211 offset:37888
    v_mfma_f32_16x16x32_bf16 v[24:27], a[48:51], v[168:171], v[24:27]
    ds_read_b128 v[184:187], v211 offset:38912
    v_mfma_f32_16x16x32_bf16 v[28:31], a[48:51], v[172:175], v[28:31]
    ds_read_b128 v[188:191], v211 offset:39936
    s_add_u32 s86, s87, 258048
    buffer_load_dwordx4 a[48:51], v1, s[4:7], s86 offen offset:0 sc1
    s_waitcnt vmcnt(59)
    v_mfma_f32_16x16x32_bf16 v[32:35], a[52:55], v[160:163], v[32:35]
    v_mfma_f32_16x16x32_bf16 v[36:39], a[52:55], v[164:167], v[36:39]
    v_mfma_f32_16x16x32_bf16 v[40:43], a[52:55], v[168:171], v[40:43]
    v_mfma_f32_16x16x32_bf16 v[44:47], a[52:55], v[172:175], v[44:47]
    buffer_load_dwordx4 a[52:55], v1, s[4:7], s86 offen offset:1024 sc1
    s_waitcnt vmcnt(59)
    v_mfma_f32_16x16x32_bf16 v[48:51], a[56:59], v[160:163], v[48:51]
    v_mfma_f32_16x16x32_bf16 v[52:55], a[56:59], v[164:167], v[52:55]
    v_mfma_f32_16x16x32_bf16 v[56:59], a[56:59], v[168:171], v[56:59]
    v_mfma_f32_16x16x32_bf16 v[60:63], a[56:59], v[172:175], v[60:63]
    buffer_load_dwordx4 a[56:59], v1, s[4:7], s86 offen offset:2048 sc1
    s_waitcnt lgkmcnt(0)
    s_waitcnt vmcnt(59)
    v_mfma_f32_16x16x32_bf16 v[16:19], a[60:63], v[176:179], v[16:19]
    ds_read_b128 v[160:163], v211 offset:40960
    v_mfma_f32_16x16x32_bf16 v[20:23], a[60:63], v[180:183], v[20:23]
    ds_read_b128 v[164:167], v211 offset:41984
    v_mfma_f32_16x16x32_bf16 v[24:27], a[60:63], v[184:187], v[24:27]
    ds_read_b128 v[168:171], v211 offset:43008
    v_mfma_f32_16x16x32_bf16 v[28:31], a[60:63], v[188:191], v[28:31]
    ds_read_b128 v[172:175], v211 offset:44032
    buffer_load_dwordx4 a[60:63], v1, s[4:7], s86 offen offset:3072 sc1
    s_waitcnt vmcnt(59)
    v_mfma_f32_16x16x32_bf16 v[32:35], a[64:67], v[176:179], v[32:35]
    v_mfma_f32_16x16x32_bf16 v[36:39], a[64:67], v[180:183], v[36:39]
    v_mfma_f32_16x16x32_bf16 v[40:43], a[64:67], v[184:187], v[40:43]
    v_mfma_f32_16x16x32_bf16 v[44:47], a[64:67], v[188:191], v[44:47]
    s_add_u32 s86, s87, 262144
    buffer_load_dwordx4 a[64:67], v1, s[4:7], s86 offen offset:0 sc1
    s_waitcnt vmcnt(59)
    v_mfma_f32_16x16x32_bf16 v[48:51], a[68:71], v[176:179], v[48:51]
    v_mfma_f32_16x16x32_bf16 v[52:55], a[68:71], v[180:183], v[52:55]
    v_mfma_f32_16x16x32_bf16 v[56:59], a[68:71], v[184:187], v[56:59]
    v_mfma_f32_16x16x32_bf16 v[60:63], a[68:71], v[188:191], v[60:63]
    buffer_load_dwordx4 a[68:71], v1, s[4:7], s86 offen offset:1024 sc1
    s_waitcnt lgkmcnt(0)
    s_waitcnt vmcnt(59)
    v_mfma_f32_16x16x32_bf16 v[16:19], a[72:75], v[160:163], v[16:19]
    ds_read_b128 v[176:179], v211 offset:45056
    v_mfma_f32_16x16x32_bf16 v[20:23], a[72:75], v[164:167], v[20:23]
    ds_read_b128 v[180:183], v211 offset:46080
    v_mfma_f32_16x16x32_bf16 v[24:27], a[72:75], v[168:171], v[24:27]
    ds_read_b128 v[184:187], v211 offset:47104
    v_mfma_f32_16x16x32_bf16 v[28:31], a[72:75], v[172:175], v[28:31]
    ds_read_b128 v[188:191], v211 offset:48128
    buffer_load_dwordx4 a[72:75], v1, s[4:7], s86 offen offset:2048 sc1
    s_waitcnt vmcnt(59)
    v_mfma_f32_16x16x32_bf16 v[32:35], a[76:79], v[160:163], v[32:35]
    v_mfma_f32_16x16x32_bf16 v[36:39], a[76:79], v[164:167], v[36:39]
    v_mfma_f32_16x16x32_bf16 v[40:43], a[76:79], v[168:171], v[40:43]
    v_mfma_f32_16x16x32_bf16 v[44:47], a[76:79], v[172:175], v[44:47]
    buffer_load_dwordx4 a[76:79], v1, s[4:7], s86 offen offset:3072 sc1
    s_waitcnt vmcnt(59)
    v_mfma_f32_16x16x32_bf16 v[48:51], a[80:83], v[160:163], v[48:51]
    v_mfma_f32_16x16x32_bf16 v[52:55], a[80:83], v[164:167], v[52:55]
    v_mfma_f32_16x16x32_bf16 v[56:59], a[80:83], v[168:171], v[56:59]
    v_mfma_f32_16x16x32_bf16 v[60:63], a[80:83], v[172:175], v[60:63]
    s_add_u32 s86, s87, 266240
    buffer_load_dwordx4 a[80:83], v1, s[4:7], s86 offen offset:0 sc1
    s_waitcnt lgkmcnt(0)
    s_waitcnt vmcnt(59)
    v_mfma_f32_16x16x32_bf16 v[16:19], a[84:87], v[176:179], v[16:19]
    ds_read_b128 v[160:163], v211 offset:49152
    v_mfma_f32_16x16x32_bf16 v[20:23], a[84:87], v[180:183], v[20:23]
    ds_read_b128 v[164:167], v211 offset:50176
    v_mfma_f32_16x16x32_bf16 v[24:27], a[84:87], v[184:187], v[24:27]
    ds_read_b128 v[168:171], v211 offset:51200
    v_mfma_f32_16x16x32_bf16 v[28:31], a[84:87], v[188:191], v[28:31]
    ds_read_b128 v[172:175], v211 offset:52224
    buffer_load_dwordx4 a[84:87], v1, s[4:7], s86 offen offset:1024 sc1
    s_waitcnt vmcnt(59)
    v_mfma_f32_16x16x32_bf16 v[32:35], a[88:91], v[176:179], v[32:35]
    v_mfma_f32_16x16x32_bf16 v[36:39], a[88:91], v[180:183], v[36:39]
    v_mfma_f32_16x16x32_bf16 v[40:43], a[88:91], v[184:187], v[40:43]
    v_mfma_f32_16x16x32_bf16 v[44:47], a[88:91], v[188:191], v[44:47]
    buffer_load_dwordx4 a[88:91], v1, s[4:7], s86 offen offset:2048 sc1
    s_waitcnt vmcnt(59)
    v_mfma_f32_16x16x32_bf16 v[48:51], a[92:95], v[176:179], v[48:51]
    v_mfma_f32_16x16x32_bf16 v[52:55], a[92:95], v[180:183], v[52:55]
    v_mfma_f32_16x16x32_bf16 v[56:59], a[92:95], v[184:187], v[56:59]
    v_mfma_f32_16x16x32_bf16 v[60:63], a[92:95], v[188:191], v[60:63]
    buffer_load_dwordx4 a[92:95], v1, s[4:7], s86 offen offset:3072 sc1
    s_waitcnt lgkmcnt(0)
    s_waitcnt vmcnt(59)
    v_mfma_f32_16x16x32_bf16 v[16:19], a[96:99], v[160:163], v[16:19]
    ds_read_b128 v[176:179], v211 offset:53248
    v_mfma_f32_16x16x32_bf16 v[20:23], a[96:99], v[164:167], v[20:23]
    ds_read_b128 v[180:183], v211 offset:54272
    v_mfma_f32_16x16x32_bf16 v[24:27], a[96:99], v[168:171], v[24:27]
    ds_read_b128 v[184:187], v211 offset:55296
    v_mfma_f32_16x16x32_bf16 v[28:31], a[96:99], v[172:175], v[28:31]
    ds_read_b128 v[188:191], v211 offset:56320
    s_add_u32 s86, s87, 270336
    buffer_load_dwordx4 a[96:99], v1, s[4:7], s86 offen offset:0 sc1
    s_waitcnt vmcnt(59)
    v_mfma_f32_16x16x32_bf16 v[32:35], a[100:103], v[160:163], v[32:35]
    v_mfma_f32_16x16x32_bf16 v[36:39], a[100:103], v[164:167], v[36:39]
    v_mfma_f32_16x16x32_bf16 v[40:43], a[100:103], v[168:171], v[40:43]
    v_mfma_f32_16x16x32_bf16 v[44:47], a[100:103], v[172:175], v[44:47]
    buffer_load_dwordx4 a[100:103], v1, s[4:7], s86 offen offset:1024 sc1
    s_waitcnt vmcnt(59)
    v_mfma_f32_16x16x32_bf16 v[48:51], a[104:107], v[160:163], v[48:51]
    v_mfma_f32_16x16x32_bf16 v[52:55], a[104:107], v[164:167], v[52:55]
    v_mfma_f32_16x16x32_bf16 v[56:59], a[104:107], v[168:171], v[56:59]
    v_mfma_f32_16x16x32_bf16 v[60:63], a[104:107], v[172:175], v[60:63]
    buffer_load_dwordx4 a[104:107], v1, s[4:7], s86 offen offset:2048 sc1
    s_waitcnt lgkmcnt(0)
    s_waitcnt vmcnt(59)
    v_mfma_f32_16x16x32_bf16 v[16:19], a[108:111], v[176:179], v[16:19]
    ds_read_b128 v[160:163], v211 offset:57344
    v_mfma_f32_16x16x32_bf16 v[20:23], a[108:111], v[180:183], v[20:23]
    ds_read_b128 v[164:167], v211 offset:58368
    v_mfma_f32_16x16x32_bf16 v[24:27], a[108:111], v[184:187], v[24:27]
    ds_read_b128 v[168:171], v211 offset:59392
    v_mfma_f32_16x16x32_bf16 v[28:31], a[108:111], v[188:191], v[28:31]
    ds_read_b128 v[172:175], v211 offset:60416
    buffer_load_dwordx4 a[108:111], v1, s[4:7], s86 offen offset:3072 sc1
    s_waitcnt vmcnt(59)
    v_mfma_f32_16x16x32_bf16 v[32:35], a[112:115], v[176:179], v[32:35]
    v_mfma_f32_16x16x32_bf16 v[36:39], a[112:115], v[180:183], v[36:39]
    v_mfma_f32_16x16x32_bf16 v[40:43], a[112:115], v[184:187], v[40:43]
    v_mfma_f32_16x16x32_bf16 v[44:47], a[112:115], v[188:191], v[44:47]
    s_add_u32 s86, s87, 274432
    buffer_load_dwordx4 a[112:115], v1, s[4:7], s86 offen offset:0 sc1
    s_waitcnt vmcnt(59)
    v_mfma_f32_16x16x32_bf16 v[48:51], a[116:119], v[176:179], v[48:51]
    v_mfma_f32_16x16x32_bf16 v[52:55], a[116:119], v[180:183], v[52:55]
    v_mfma_f32_16x16x32_bf16 v[56:59], a[116:119], v[184:187], v[56:59]
    v_mfma_f32_16x16x32_bf16 v[60:63], a[116:119], v[188:191], v[60:63]
    buffer_load_dwordx4 a[116:119], v1, s[4:7], s86 offen offset:1024 sc1
    s_waitcnt lgkmcnt(0)
    s_waitcnt vmcnt(59)
    v_mfma_f32_16x16x32_bf16 v[16:19], a[120:123], v[160:163], v[16:19]
    ds_read_b128 v[176:179], v211 offset:61440
    v_mfma_f32_16x16x32_bf16 v[20:23], a[120:123], v[164:167], v[20:23]
    ds_read_b128 v[180:183], v211 offset:62464
    v_mfma_f32_16x16x32_bf16 v[24:27], a[120:123], v[168:171], v[24:27]
    ds_read_b128 v[184:187], v211 offset:63488
    v_mfma_f32_16x16x32_bf16 v[28:31], a[120:123], v[172:175], v[28:31]
    ds_read_b128 v[188:191], v211 offset:64512
    buffer_load_dwordx4 a[120:123], v1, s[4:7], s86 offen offset:2048 sc1
    s_waitcnt vmcnt(59)
    v_mfma_f32_16x16x32_bf16 v[32:35], a[124:127], v[160:163], v[32:35]
    v_mfma_f32_16x16x32_bf16 v[36:39], a[124:127], v[164:167], v[36:39]
    v_mfma_f32_16x16x32_bf16 v[40:43], a[124:127], v[168:171], v[40:43]
    v_mfma_f32_16x16x32_bf16 v[44:47], a[124:127], v[172:175], v[44:47]
    buffer_load_dwordx4 a[124:127], v1, s[4:7], s86 offen offset:3072 sc1
    s_waitcnt vmcnt(59)
    v_mfma_f32_16x16x32_bf16 v[48:51], a[128:131], v[160:163], v[48:51]
    v_mfma_f32_16x16x32_bf16 v[52:55], a[128:131], v[164:167], v[52:55]
    v_mfma_f32_16x16x32_bf16 v[56:59], a[128:131], v[168:171], v[56:59]
    v_mfma_f32_16x16x32_bf16 v[60:63], a[128:131], v[172:175], v[60:63]
    s_add_u32 s86, s87, 278528
    buffer_load_dwordx4 a[128:131], v1, s[4:7], s86 offen offset:0 sc1
    s_waitcnt lgkmcnt(0)
    s_waitcnt vmcnt(59)
    v_mfma_f32_16x16x32_bf16 v[16:19], a[132:135], v[176:179], v[16:19]
    ds_read_b128 v[160:163], v211 offset:0
    v_mfma_f32_16x16x32_bf16 v[20:23], a[132:135], v[180:183], v[20:23]
    ds_read_b128 v[164:167], v211 offset:1024
    v_mfma_f32_16x16x32_bf16 v[24:27], a[132:135], v[184:187], v[24:27]
    ds_read_b128 v[168:171], v211 offset:2048
    v_mfma_f32_16x16x32_bf16 v[28:31], a[132:135], v[188:191], v[28:31]
    ds_read_b128 v[172:175], v211 offset:3072
    buffer_load_dwordx4 a[132:135], v1, s[4:7], s86 offen offset:1024 sc1
    s_waitcnt vmcnt(59)
    v_mfma_f32_16x16x32_bf16 v[32:35], a[136:139], v[176:179], v[32:35]
    v_mfma_f32_16x16x32_bf16 v[36:39], a[136:139], v[180:183], v[36:39]
    v_mfma_f32_16x16x32_bf16 v[40:43], a[136:139], v[184:187], v[40:43]
    v_mfma_f32_16x16x32_bf16 v[44:47], a[136:139], v[188:191], v[44:47]
    buffer_load_dwordx4 a[136:139], v1, s[4:7], s86 offen offset:2048 sc1
    s_waitcnt vmcnt(59)
    v_mfma_f32_16x16x32_bf16 v[48:51], a[140:143], v[176:179], v[48:51]
    v_mfma_f32_16x16x32_bf16 v[52:55], a[140:143], v[180:183], v[52:55]
    v_mfma_f32_16x16x32_bf16 v[56:59], a[140:143], v[184:187], v[56:59]
    v_mfma_f32_16x16x32_bf16 v[60:63], a[140:143], v[188:191], v[60:63]
    buffer_load_dwordx4 a[140:143], v1, s[4:7], s86 offen offset:3072 sc1
    s_waitcnt lgkmcnt(0)
    s_waitcnt vmcnt(59)
    v_mfma_f32_16x16x32_bf16 v[96:99], a[144:147], v[160:163], 0
    ds_read_b128 v[176:179], v211 offset:4096
    s_add_u32 s44, s88, 8
    s_lshl_b32 s44, s44, 16
    s_add_u32 s44, s44, s89
    v_mfma_f32_16x16x32_bf16 v[100:103], a[144:147], v[164:167], 0
    ds_read_b128 v[180:183], v211 offset:5120
    v_cvt_pk_bf16_f32 v192, v16, v17
    v_mfma_f32_16x16x32_bf16 v[104:107], a[144:147], v[168:171], 0
    ds_read_b128 v[184:187], v211 offset:6144
    v_cvt_pk_bf16_f32 v193, v18, v19
    v_mfma_f32_16x16x32_bf16 v[108:111], a[144:147], v[172:175], 0
    ds_read_b128 v[188:191], v211 offset:7168
    s_add_u32 s86, s87, 282624
    buffer_load_dwordx4 a[144:147], v1, s[4:7], s86 offen offset:0 sc1
    s_waitcnt vmcnt(59)
    v_mfma_f32_16x16x32_bf16 v[112:115], a[148:151], v[160:163], 0
    v_cvt_pk_bf16_f32 v194, v20, v21
    v_cvt_pk_bf16_f32 v195, v22, v23
    v_mfma_f32_16x16x32_bf16 v[116:119], a[148:151], v[164:167], 0
    v_permlane16_swap_b32 v192, v194
    v_permlane16_swap_b32 v193, v195
    v_mfma_f32_16x16x32_bf16 v[120:123], a[148:151], v[168:171], 0
    buffer_store_dwordx4 v[192:195], v215, s[4:7], s44 offen sc1
    v_cvt_pk_bf16_f32 v196, v24, v25
    v_mfma_f32_16x16x32_bf16 v[124:127], a[148:151], v[172:175], 0
    buffer_load_dwordx4 a[148:151], v1, s[4:7], s86 offen offset:1024 sc1
    s_waitcnt vmcnt(60)
    v_mfma_f32_16x16x32_bf16 v[128:131], a[152:155], v[160:163], 0
    v_cvt_pk_bf16_f32 v197, v26, v27
    v_cvt_pk_bf16_f32 v198, v28, v29
    v_mfma_f32_16x16x32_bf16 v[132:135], a[152:155], v[164:167], 0
    v_cvt_pk_bf16_f32 v199, v30, v31
    v_permlane16_swap_b32 v196, v198
    v_mfma_f32_16x16x32_bf16 v[136:139], a[152:155], v[168:171], 0
    v_permlane16_swap_b32 v197, v199
    buffer_store_dwordx4 v[196:199], v216, s[4:7], s44 offen sc1
    v_mfma_f32_16x16x32_bf16 v[140:143], a[152:155], v[172:175], 0
    buffer_load_dwordx4 a[152:155], v1, s[4:7], s86 offen offset:2048 sc1
    s_waitcnt lgkmcnt(0)
    s_waitcnt vmcnt(61)
    v_mfma_f32_16x16x32_bf16 v[96:99], a[156:159], v[176:179], v[96:99]
    ds_read_b128 v[160:163], v211 offset:8192
    s_add_u32 s44, s94, 1
    s_and_b32 s44, s44, 7
    s_add_u32 s44, s44, s88
    s_lshl_b32 s44, s44, 16
    s_add_u32 s44, s44, s89
    v_mfma_f32_16x16x32_bf16 v[100:103], a[156:159], v[180:183], v[100:103]
    ds_read_b128 v[164:167], v211 offset:9216
    v_cvt_pk_bf16_f32 v200, v32, v33
    v_mfma_f32_16x16x32_bf16 v[104:107], a[156:159], v[184:187], v[104:107]
    ds_read_b128 v[168:171], v211 offset:10240
    v_cvt_pk_bf16_f32 v201, v34, v35
    v_mfma_f32_16x16x32_bf16 v[108:111], a[156:159], v[188:191], v[108:111]
    ds_read_b128 v[172:175], v211 offset:11264
    buffer_load_dwordx4 a[156:159], v1, s[4:7], s86 offen offset:3072 sc1
    s_waitcnt vmcnt(61)
    v_mfma_f32_16x16x32_bf16 v[112:115], a[160:163], v[176:179], v[112:115]
    v_cvt_pk_bf16_f32 v202, v36, v37
    v_cvt_pk_bf16_f32 v203, v38, v39
    v_mfma_f32_16x16x32_bf16 v[116:119], a[160:163], v[180:183], v[116:119]
    v_permlane16_swap_b32 v200, v202
    v_permlane16_swap_b32 v201, v203
    v_mfma_f32_16x16x32_bf16 v[120:123], a[160:163], v[184:187], v[120:123]
    buffer_store_dwordx4 v[200:203], v215, s[4:7], s44 offen sc1
    v_cvt_pk_bf16_f32 v204, v40, v41
    v_mfma_f32_16x16x32_bf16 v[124:127], a[160:163], v[188:191], v[124:127]
    s_add_u32 s86, s87, 286720
    buffer_load_dwordx4 a[160:163], v1, s[4:7], s86 offen offset:0 sc1
    s_waitcnt vmcnt(62)
    v_mfma_f32_16x16x32_bf16 v[128:131], a[164:167], v[176:179], v[128:131]
    v_cvt_pk_bf16_f32 v205, v42, v43
    v_cvt_pk_bf16_f32 v206, v44, v45
    v_mfma_f32_16x16x32_bf16 v[132:135], a[164:167], v[180:183], v[132:135]
    v_cvt_pk_bf16_f32 v207, v46, v47
    v_permlane16_swap_b32 v204, v206
    v_mfma_f32_16x16x32_bf16 v[136:139], a[164:167], v[184:187], v[136:139]
    v_permlane16_swap_b32 v205, v207
    buffer_store_dwordx4 v[204:207], v216, s[4:7], s44 offen sc1
    v_mfma_f32_16x16x32_bf16 v[140:143], a[164:167], v[188:191], v[140:143]
    buffer_load_dwordx4 a[164:167], v1, s[4:7], s86 offen offset:1024 sc1
    s_waitcnt lgkmcnt(0)
    s_waitcnt vmcnt(63)
    v_mfma_f32_16x16x32_bf16 v[96:99], a[168:171], v[160:163], v[96:99]
    ds_read_b128 v[176:179], v211 offset:12288
    s_add_u32 s44, s94, 2
    s_and_b32 s44, s44, 7
    s_add_u32 s44, s44, s88
    s_lshl_b32 s44, s44, 16
    s_add_u32 s44, s44, s89
    v_mfma_f32_16x16x32_bf16 v[100:103], a[168:171], v[164:167], v[100:103]
    ds_read_b128 v[180:183], v211 offset:13312
    v_cvt_pk_bf16_f32 v192, v48, v49
    v_mfma_f32_16x16x32_bf16 v[104:107], a[168:171], v[168:171], v[104:107]
    ds_read_b128 v[184:187], v211 offset:14336
    v_cvt_pk_bf16_f32 v193, v50, v51
    v_mfma_f32_16x16x32_bf16 v[108:111], a[168:171], v[172:175], v[108:111]
    ds_read_b128 v[188:191], v211 offset:15360
    buffer_load_dwordx4 a[168:171], v1, s[4:7], s86 offen offset:2048 sc1
    s_waitcnt vmcnt(63)
    v_mfma_f32_16x16x32_bf16 v[112:115], a[172:175], v[160:163], v[112:115]
    v_cvt_pk_bf16_f32 v194, v52, v53
    v_cvt_pk_bf16_f32 v195, v54, v55
    v_mfma_f32_16x16x32_bf16 v[116:119], a[172:175], v[164:167], v[116:119]
    v_permlane16_swap_b32 v192, v194
    v_permlane16_swap_b32 v193, v195
    v_mfma_f32_16x16x32_bf16 v[120:123], a[172:175], v[168:171], v[120:123]
    buffer_store_dwordx4 v[192:195], v215, s[4:7], s44 offen sc1
    v_cvt_pk_bf16_f32 v196, v56, v57
    v_mfma_f32_16x16x32_bf16 v[124:127], a[172:175], v[172:175], v[124:127]
    buffer_load_dwordx4 a[172:175], v1, s[4:7], s86 offen offset:3072 sc1
    s_waitcnt vmcnt(63)
    v_mfma_f32_16x16x32_bf16 v[128:131], a[176:179], v[160:163], v[128:131]
    v_cvt_pk_bf16_f32 v197, v58, v59
    v_cvt_pk_bf16_f32 v198, v60, v61
    v_mfma_f32_16x16x32_bf16 v[132:135], a[176:179], v[164:167], v[132:135]
    v_cvt_pk_bf16_f32 v199, v62, v63
    v_permlane16_swap_b32 v196, v198
    v_mfma_f32_16x16x32_bf16 v[136:139], a[176:179], v[168:171], v[136:139]
    v_permlane16_swap_b32 v197, v199
    buffer_store_dwordx4 v[196:199], v216, s[4:7], s44 offen sc1
    v_mfma_f32_16x16x32_bf16 v[140:143], a[176:179], v[172:175], v[140:143]
    s_add_u32 s86, s87, 290816
    buffer_load_dwordx4 a[176:179], v1, s[4:7], s86 offen offset:0 sc1
    s_waitcnt lgkmcnt(0)
    s_waitcnt vmcnt(63)
    v_mfma_f32_16x16x32_bf16 v[96:99], a[180:183], v[176:179], v[96:99]
    ds_read_b128 v[160:163], v211 offset:16384
    v_mfma_f32_16x16x32_bf16 v[100:103], a[180:183], v[180:183], v[100:103]
    ds_read_b128 v[164:167], v211 offset:17408
    v_mfma_f32_16x16x32_bf16 v[104:107], a[180:183], v[184:187], v[104:107]
    ds_read_b128 v[168:171], v211 offset:18432
    v_mfma_f32_16x16x32_bf16 v[108:111], a[180:183], v[188:191], v[108:111]
    ds_read_b128 v[172:175], v211 offset:19456
    buffer_load_dwordx4 a[180:183], v1, s[4:7], s86 offen offset:1024 sc1
    s_waitcnt vmcnt(63)
    v_mfma_f32_16x16x32_bf16 v[112:115], a[184:187], v[176:179], v[112:115]
    v_mfma_f32_16x16x32_bf16 v[116:119], a[184:187], v[180:183], v[116:119]
    v_mfma_f32_16x16x32_bf16 v[120:123], a[184:187], v[184:187], v[120:123]
    v_mfma_f32_16x16x32_bf16 v[124:127], a[184:187], v[188:191], v[124:127]
    buffer_load_dwordx4 a[184:187], v1, s[4:7], s86 offen offset:2048 sc1
    s_waitcnt vmcnt(63)
    v_mfma_f32_16x16x32_bf16 v[128:131], a[188:191], v[176:179], v[128:131]
    v_mfma_f32_16x16x32_bf16 v[132:135], a[188:191], v[180:183], v[132:135]
    v_mfma_f32_16x16x32_bf16 v[136:139], a[188:191], v[184:187], v[136:139]
    v_mfma_f32_16x16x32_bf16 v[140:143], a[188:191], v[188:191], v[140:143]
    buffer_load_dwordx4 a[188:191], v1, s[4:7], s86 offen offset:3072 sc1
    s_waitcnt lgkmcnt(0)
    s_waitcnt vmcnt(63)
    v_mfma_f32_16x16x32_bf16 v[96:99], a[192:195], v[160:163], v[96:99]
    ds_read_b128 v[176:179], v211 offset:20480
    v_mfma_f32_16x16x32_bf16 v[100:103], a[192:195], v[164:167], v[100:103]
    ds_read_b128 v[180:183], v211 offset:21504
    v_mfma_f32_16x16x32_bf16 v[104:107], a[192:195], v[168:171], v[104:107]
    ds_read_b128 v[184:187], v211 offset:22528
    v_mfma_f32_16x16x32_bf16 v[108:111], a[192:195], v[172:175], v[108:111]
    ds_read_b128 v[188:191], v211 offset:23552
    s_add_u32 s86, s87, 294912
    buffer_load_dwordx4 a[192:195], v1, s[4:7], s86 offen offset:0 sc1
    s_waitcnt vmcnt(63)
    v_mfma_f32_16x16x32_bf16 v[112:115], a[196:199], v[160:163], v[112:115]
    v_mfma_f32_16x16x32_bf16 v[116:119], a[196:199], v[164:167], v[116:119]
    v_mfma_f32_16x16x32_bf16 v[120:123], a[196:199], v[168:171], v[120:123]
    v_mfma_f32_16x16x32_bf16 v[124:127], a[196:199], v[172:175], v[124:127]
    buffer_load_dwordx4 a[196:199], v1, s[4:7], s86 offen offset:1024 sc1
    s_waitcnt vmcnt(63)
    v_mfma_f32_16x16x32_bf16 v[128:131], a[200:203], v[160:163], v[128:131]
    v_mfma_f32_16x16x32_bf16 v[132:135], a[200:203], v[164:167], v[132:135]
    v_mfma_f32_16x16x32_bf16 v[136:139], a[200:203], v[168:171], v[136:139]
    v_mfma_f32_16x16x32_bf16 v[140:143], a[200:203], v[172:175], v[140:143]
    buffer_load_dwordx4 a[200:203], v1, s[4:7], s86 offen offset:2048 sc1
    s_waitcnt lgkmcnt(0)
    s_waitcnt vmcnt(63)
    v_mfma_f32_16x16x32_bf16 v[96:99], a[204:207], v[176:179], v[96:99]
    ds_read_b128 v[160:163], v211 offset:24576
    v_mfma_f32_16x16x32_bf16 v[100:103], a[204:207], v[180:183], v[100:103]
    ds_read_b128 v[164:167], v211 offset:25600
    v_mfma_f32_16x16x32_bf16 v[104:107], a[204:207], v[184:187], v[104:107]
    ds_read_b128 v[168:171], v211 offset:26624
    v_mfma_f32_16x16x32_bf16 v[108:111], a[204:207], v[188:191], v[108:111]
    ds_read_b128 v[172:175], v211 offset:27648
    buffer_load_dwordx4 a[204:207], v1, s[4:7], s86 offen offset:3072 sc1
    s_waitcnt vmcnt(63)
    v_mfma_f32_16x16x32_bf16 v[112:115], a[208:211], v[176:179], v[112:115]
    v_mfma_f32_16x16x32_bf16 v[116:119], a[208:211], v[180:183], v[116:119]
    v_mfma_f32_16x16x32_bf16 v[120:123], a[208:211], v[184:187], v[120:123]
    v_mfma_f32_16x16x32_bf16 v[124:127], a[208:211], v[188:191], v[124:127]
    s_add_u32 s86, s87, 299008
    buffer_load_dwordx4 a[208:211], v1, s[4:7], s86 offen offset:0 sc1
    s_waitcnt vmcnt(63)
    v_mfma_f32_16x16x32_bf16 v[128:131], a[212:215], v[176:179], v[128:131]
    v_mfma_f32_16x16x32_bf16 v[132:135], a[212:215], v[180:183], v[132:135]
    v_mfma_f32_16x16x32_bf16 v[136:139], a[212:215], v[184:187], v[136:139]
    v_mfma_f32_16x16x32_bf16 v[140:143], a[212:215], v[188:191], v[140:143]
    buffer_load_dwordx4 a[212:215], v1, s[4:7], s86 offen offset:1024 sc1
    s_waitcnt lgkmcnt(0)
    s_waitcnt vmcnt(63)
    v_mfma_f32_16x16x32_bf16 v[96:99], a[216:219], v[160:163], v[96:99]
    ds_read_b128 v[176:179], v211 offset:28672
    v_mfma_f32_16x16x32_bf16 v[100:103], a[216:219], v[164:167], v[100:103]
    ds_read_b128 v[180:183], v211 offset:29696
    v_mfma_f32_16x16x32_bf16 v[104:107], a[216:219], v[168:171], v[104:107]
    ds_read_b128 v[184:187], v211 offset:30720
    v_mfma_f32_16x16x32_bf16 v[108:111], a[216:219], v[172:175], v[108:111]
    ds_read_b128 v[188:191], v211 offset:31744
    buffer_load_dwordx4 a[216:219], v1, s[4:7], s86 offen offset:2048 sc1
    s_waitcnt vmcnt(63)
    v_mfma_f32_16x16x32_bf16 v[112:115], a[220:223], v[160:163], v[112:115]
    v_mfma_f32_16x16x32_bf16 v[116:119], a[220:223], v[164:167], v[116:119]
    v_mfma_f32_16x16x32_bf16 v[120:123], a[220:223], v[168:171], v[120:123]
    v_mfma_f32_16x16x32_bf16 v[124:127], a[220:223], v[172:175], v[124:127]
    buffer_load_dwordx4 a[220:223], v1, s[4:7], s86 offen offset:3072 sc1
    s_waitcnt vmcnt(63)
    v_mfma_f32_16x16x32_bf16 v[128:131], a[224:227], v[160:163], v[128:131]
    v_mfma_f32_16x16x32_bf16 v[132:135], a[224:227], v[164:167], v[132:135]
    v_mfma_f32_16x16x32_bf16 v[136:139], a[224:227], v[168:171], v[136:139]
    v_mfma_f32_16x16x32_bf16 v[140:143], a[224:227], v[172:175], v[140:143]
    s_add_u32 s86, s87, 303104
    buffer_load_dwordx4 a[224:227], v1, s[4:7], s86 offen offset:0 sc1
    s_waitcnt lgkmcnt(0)
    s_waitcnt vmcnt(63)
    v_mfma_f32_16x16x32_bf16 v[96:99], a[228:231], v[176:179], v[96:99]
    ds_read_b128 v[160:163], v212 offset:0
    v_mfma_f32_16x16x32_bf16 v[100:103], a[228:231], v[180:183], v[100:103]
    ds_read_b128 v[164:167], v212 offset:1024
    v_mfma_f32_16x16x32_bf16 v[104:107], a[228:231], v[184:187], v[104:107]
    ds_read_b128 v[168:171], v212 offset:2048
    v_mfma_f32_16x16x32_bf16 v[108:111], a[228:231], v[188:191], v[108:111]
    ds_read_b128 v[172:175], v212 offset:3072
    buffer_load_dwordx4 a[228:231], v1, s[4:7], s86 offen offset:1024 sc1
    s_waitcnt vmcnt(63)
    v_mfma_f32_16x16x32_bf16 v[112:115], a[232:235], v[176:179], v[112:115]
    v_mfma_f32_16x16x32_bf16 v[116:119], a[232:235], v[180:183], v[116:119]
    v_mfma_f32_16x16x32_bf16 v[120:123], a[232:235], v[184:187], v[120:123]
    v_mfma_f32_16x16x32_bf16 v[124:127], a[232:235], v[188:191], v[124:127]
    buffer_load_dwordx4 a[232:235], v1, s[4:7], s86 offen offset:2048 sc1
    s_waitcnt vmcnt(63)
    v_mfma_f32_16x16x32_bf16 v[128:131], a[236:239], v[176:179], v[128:131]
    v_mfma_f32_16x16x32_bf16 v[132:135], a[236:239], v[180:183], v[132:135]
    v_mfma_f32_16x16x32_bf16 v[136:139], a[236:239], v[184:187], v[136:139]
    v_mfma_f32_16x16x32_bf16 v[140:143], a[236:239], v[188:191], v[140:143]
    buffer_load_dwordx4 a[236:239], v1, s[4:7], s86 offen offset:3072 sc1
    s_waitcnt lgkmcnt(0)
    s_waitcnt vmcnt(63)
    v_mfma_f32_16x16x32_bf16 v[96:99], a[0:3], v[160:163], v[96:99]
    ds_read_b128 v[176:179], v212 offset:4096
    v_mfma_f32_16x16x32_bf16 v[100:103], a[0:3], v[164:167], v[100:103]
    ds_read_b128 v[180:183], v212 offset:5120
    v_mfma_f32_16x16x32_bf16 v[104:107], a[0:3], v[168:171], v[104:107]
    ds_read_b128 v[184:187], v212 offset:6144
    v_mfma_f32_16x16x32_bf16 v[108:111], a[0:3], v[172:175], v[108:111]
    ds_read_b128 v[188:191], v212 offset:7168
    s_add_u32 s86, s87, 307200
    buffer_load_dwordx4 a[0:3], v1, s[4:7], s86 offen offset:0 sc1
    s_waitcnt vmcnt(63)
    v_mfma_f32_16x16x32_bf16 v[112:115], a[4:7], v[160:163], v[112:115]
    v_mfma_f32_16x16x32_bf16 v[116:119], a[4:7], v[164:167], v[116:119]
    v_mfma_f32_16x16x32_bf16 v[120:123], a[4:7], v[168:171], v[120:123]
    v_mfma_f32_16x16x32_bf16 v[124:127], a[4:7], v[172:175], v[124:127]
    buffer_load_dwordx4 a[4:7], v1, s[4:7], s86 offen offset:1024 sc1
    s_waitcnt vmcnt(63)
    v_mfma_f32_16x16x32_bf16 v[128:131], a[8:11], v[160:163], v[128:131]
    v_mfma_f32_16x16x32_bf16 v[132:135], a[8:11], v[164:167], v[132:135]
    v_mfma_f32_16x16x32_bf16 v[136:139], a[8:11], v[168:171], v[136:139]
    v_mfma_f32_16x16x32_bf16 v[140:143], a[8:11], v[172:175], v[140:143]
    buffer_load_dwordx4 a[8:11], v1, s[4:7], s86 offen offset:2048 sc1
    s_waitcnt lgkmcnt(0)
    s_waitcnt vmcnt(63)
    v_mfma_f32_16x16x32_bf16 v[96:99], a[12:15], v[176:179], v[96:99]
    ds_read_b128 v[160:163], v211 offset:32768
    v_mfma_f32_16x16x32_bf16 v[100:103], a[12:15], v[180:183], v[100:103]
    ds_read_b128 v[164:167], v211 offset:33792
    v_mfma_f32_16x16x32_bf16 v[104:107], a[12:15], v[184:187], v[104:107]
    ds_read_b128 v[168:171], v211 offset:34816
    v_mfma_f32_16x16x32_bf16 v[108:111], a[12:15], v[188:191], v[108:111]
    ds_read_b128 v[172:175], v211 offset:35840
    buffer_load_dwordx4 a[12:15], v1, s[4:7], s86 offen offset:3072 sc1
    s_waitcnt vmcnt(63)
    v_mfma_f32_16x16x32_bf16 v[112:115], a[16:19], v[176:179], v[112:115]
    v_mfma_f32_16x16x32_bf16 v[116:119], a[16:19], v[180:183], v[116:119]
    v_mfma_f32_16x16x32_bf16 v[120:123], a[16:19], v[184:187], v[120:123]
    v_mfma_f32_16x16x32_bf16 v[124:127], a[16:19], v[188:191], v[124:127]
    s_add_u32 s86, s87, 311296
    buffer_load_dwordx4 a[16:19], v1, s[4:7], s86 offen offset:0 sc1
    s_waitcnt vmcnt(63)
    v_mfma_f32_16x16x32_bf16 v[128:131], a[20:23], v[176:179], v[128:131]
    v_mfma_f32_16x16x32_bf16 v[132:135], a[20:23], v[180:183], v[132:135]
    v_mfma_f32_16x16x32_bf16 v[136:139], a[20:23], v[184:187], v[136:139]
    v_mfma_f32_16x16x32_bf16 v[140:143], a[20:23], v[188:191], v[140:143]
    buffer_load_dwordx4 a[20:23], v1, s[4:7], s86 offen offset:1024 sc1
    s_waitcnt lgkmcnt(0)
    s_waitcnt vmcnt(63)
    v_mfma_f32_16x16x32_bf16 v[96:99], a[24:27], v[160:163], v[96:99]
    ds_read_b128 v[176:179], v211 offset:36864
    v_mfma_f32_16x16x32_bf16 v[100:103], a[24:27], v[164:167], v[100:103]
    ds_read_b128 v[180:183], v211 offset:37888
    v_mfma_f32_16x16x32_bf16 v[104:107], a[24:27], v[168:171], v[104:107]
    ds_read_b128 v[184:187], v211 offset:38912
    v_mfma_f32_16x16x32_bf16 v[108:111], a[24:27], v[172:175], v[108:111]
    ds_read_b128 v[188:191], v211 offset:39936
    buffer_load_dwordx4 a[24:27], v1, s[4:7], s86 offen offset:2048 sc1
    s_waitcnt vmcnt(63)
    v_mfma_f32_16x16x32_bf16 v[112:115], a[28:31], v[160:163], v[112:115]
    v_mfma_f32_16x16x32_bf16 v[116:119], a[28:31], v[164:167], v[116:119]
    v_mfma_f32_16x16x32_bf16 v[120:123], a[28:31], v[168:171], v[120:123]
    v_mfma_f32_16x16x32_bf16 v[124:127], a[28:31], v[172:175], v[124:127]
    buffer_load_dwordx4 a[28:31], v1, s[4:7], s86 offen offset:3072 sc1
    s_waitcnt vmcnt(63)
    v_mfma_f32_16x16x32_bf16 v[128:131], a[32:35], v[160:163], v[128:131]
    v_mfma_f32_16x16x32_bf16 v[132:135], a[32:35], v[164:167], v[132:135]
    v_mfma_f32_16x16x32_bf16 v[136:139], a[32:35], v[168:171], v[136:139]
    v_mfma_f32_16x16x32_bf16 v[140:143], a[32:35], v[172:175], v[140:143]
    s_add_u32 s86, s87, 315392
    buffer_load_dwordx4 a[32:35], v1, s[4:7], s86 offen offset:0 sc1
    s_waitcnt lgkmcnt(0)
    s_waitcnt vmcnt(63)
    v_mfma_f32_16x16x32_bf16 v[96:99], a[36:39], v[176:179], v[96:99]
    ds_read_b128 v[160:163], v211 offset:40960
    v_mfma_f32_16x16x32_bf16 v[100:103], a[36:39], v[180:183], v[100:103]
    ds_read_b128 v[164:167], v211 offset:41984
    v_mfma_f32_16x16x32_bf16 v[104:107], a[36:39], v[184:187], v[104:107]
    ds_read_b128 v[168:171], v211 offset:43008
    v_mfma_f32_16x16x32_bf16 v[108:111], a[36:39], v[188:191], v[108:111]
    ds_read_b128 v[172:175], v211 offset:44032
    buffer_load_dwordx4 a[36:39], v1, s[4:7], s86 offen offset:1024 sc1
    s_waitcnt vmcnt(63)
    v_mfma_f32_16x16x32_bf16 v[112:115], a[40:43], v[176:179], v[112:115]
    v_mfma_f32_16x16x32_bf16 v[116:119], a[40:43], v[180:183], v[116:119]
    v_mfma_f32_16x16x32_bf16 v[120:123], a[40:43], v[184:187], v[120:123]
    v_mfma_f32_16x16x32_bf16 v[124:127], a[40:43], v[188:191], v[124:127]
    buffer_load_dwordx4 a[40:43], v1, s[4:7], s86 offen offset:2048 sc1
    s_waitcnt vmcnt(63)
    v_mfma_f32_16x16x32_bf16 v[128:131], a[44:47], v[176:179], v[128:131]
    v_mfma_f32_16x16x32_bf16 v[132:135], a[44:47], v[180:183], v[132:135]
    v_mfma_f32_16x16x32_bf16 v[136:139], a[44:47], v[184:187], v[136:139]
    v_mfma_f32_16x16x32_bf16 v[140:143], a[44:47], v[188:191], v[140:143]
    buffer_load_dwordx4 a[44:47], v1, s[4:7], s86 offen offset:3072 sc1
    s_waitcnt lgkmcnt(0)
    s_waitcnt vmcnt(63)
    v_mfma_f32_16x16x32_bf16 v[96:99], a[48:51], v[160:163], v[96:99]
    v_and_b32 v233, 31, v0
    v_lshrrev_b32 v48, 2, v233
    v_add_u32 v49, 4, v233
    v_and_b32 v49, 31, v49
    v_cmp_eq_u32 vcc, s94, v48
    s_nop 1
    v_cndmask_b32 v233, v233, v49, vcc
    v_lshlrev_b32 v233, 2, v233
    s_add_u32 s44, s94, 7
    v_bfe_u32 v48, v0, 2, 1
    v_sub_u32 v48, s44, v48
    v_and_b32 v48, 7, v48
    v_and_b32 v49, 3, v0
    v_lshl_add_u32 v48, v48, 2, v49
    s_lshl_b32 s44, s94, 5
    v_add_u32 v48, s44, v48
    v_add_u32 v49, 256, v0
    v_cmp_gt_u32 vcc, 32, v0
    s_nop 1
    v_cndmask_b32 v232, v48, v49, vcc
    v_lshlrev_b32 v232, 2, v232
    s_lshl_b32 s90, s88, 7
    s_add_u32 s90, s90, 13312
    s_lshl_b32 s91, s94, 7
    s_add_u32 s91, s91, s90
    s_movk_i32 s92, 8
    v_mfma_f32_16x16x32_bf16 v[100:103], a[48:51], v[164:167], v[100:103]
    ds_read_b128 v[176:179], v211 offset:45056
    v_mfma_f32_16x16x32_bf16 v[104:107], a[48:51], v[168:171], v[104:107]
    ds_read_b128 v[180:183], v211 offset:46080
    v_mfma_f32_16x16x32_bf16 v[108:111], a[48:51], v[172:175], v[108:111]
    ds_read_b128 v[184:187], v211 offset:47104
    s_add_u32 s86, s87, 319488
    buffer_load_dwordx4 a[48:51], v1, s[4:7], s86 offen offset:0 sc1
    s_waitcnt vmcnt(63)
    v_mfma_f32_16x16x32_bf16 v[112:115], a[52:55], v[160:163], v[112:115]
    ds_read_b128 v[188:191], v211 offset:48128
    v_mfma_f32_16x16x32_bf16 v[116:119], a[52:55], v[164:167], v[116:119]
    v_mfma_f32_16x16x32_bf16 v[120:123], a[52:55], v[168:171], v[120:123]
    v_mfma_f32_16x16x32_bf16 v[124:127], a[52:55], v[172:175], v[124:127]
    buffer_load_dwordx4 a[52:55], v1, s[4:7], s86 offen offset:1024 sc1
    s_waitcnt vmcnt(63)
    v_mfma_f32_16x16x32_bf16 v[128:131], a[56:59], v[160:163], v[128:131]
    v_mfma_f32_16x16x32_bf16 v[132:135], a[56:59], v[164:167], v[132:135]
    v_mfma_f32_16x16x32_bf16 v[136:139], a[56:59], v[168:171], v[136:139]
    v_mfma_f32_16x16x32_bf16 v[140:143], a[56:59], v[172:175], v[140:143]
    buffer_load_dwordx4 a[56:59], v1, s[4:7], s86 offen offset:2048 sc1
    s_waitcnt lgkmcnt(0)
    s_waitcnt vmcnt(63)
    v_mfma_f32_16x16x32_bf16 v[96:99], a[60:63], v[176:179], v[96:99]
    ds_read_b128 v[160:163], v211 offset:49152
    v_mfma_f32_16x16x32_bf16 v[100:103], a[60:63], v[180:183], v[100:103]
    ds_read_b128 v[164:167], v211 offset:50176
    v_mfma_f32_16x16x32_bf16 v[104:107], a[60:63], v[184:187], v[104:107]
    ds_read_b128 v[168:171], v211 offset:51200
    v_mfma_f32_16x16x32_bf16 v[108:111], a[60:63], v[188:191], v[108:111]
    ds_read_b128 v[172:175], v211 offset:52224
    buffer_load_dwordx4 a[60:63], v1, s[4:7], s86 offen offset:3072 sc1
    s_waitcnt vmcnt(63)
    v_mfma_f32_16x16x32_bf16 v[112:115], a[64:67], v[176:179], v[112:115]
    v_mfma_f32_16x16x32_bf16 v[116:119], a[64:67], v[180:183], v[116:119]
    v_mfma_f32_16x16x32_bf16 v[120:123], a[64:67], v[184:187], v[120:123]
    v_mfma_f32_16x16x32_bf16 v[124:127], a[64:67], v[188:191], v[124:127]
    s_add_u32 s86, s87, 323584
    buffer_load_dwordx4 a[64:67], v1, s[4:7], s86 offen offset:0 sc1
    s_waitcnt vmcnt(63)
    v_mfma_f32_16x16x32_bf16 v[128:131], a[68:71], v[176:179], v[128:131]
    v_mfma_f32_16x16x32_bf16 v[132:135], a[68:71], v[180:183], v[132:135]
    v_mfma_f32_16x16x32_bf16 v[136:139], a[68:71], v[184:187], v[136:139]
    v_mfma_f32_16x16x32_bf16 v[140:143], a[68:71], v[188:191], v[140:143]
    buffer_load_dwordx4 a[68:71], v1, s[4:7], s86 offen offset:1024 sc1
    s_waitcnt lgkmcnt(0)
    s_waitcnt vmcnt(63)
    v_mfma_f32_16x16x32_bf16 v[96:99], a[72:75], v[160:163], v[96:99]
    ds_read_b128 v[176:179], v211 offset:53248
    v_mfma_f32_16x16x32_bf16 v[100:103], a[72:75], v[164:167], v[100:103]
    ds_read_b128 v[180:183], v211 offset:54272
    v_mfma_f32_16x16x32_bf16 v[104:107], a[72:75], v[168:171], v[104:107]
    ds_read_b128 v[184:187], v211 offset:55296
    v_mfma_f32_16x16x32_bf16 v[108:111], a[72:75], v[172:175], v[108:111]
    ds_read_b128 v[188:191], v211 offset:56320
    buffer_load_dwordx4 a[72:75], v1, s[4:7], s86 offen offset:2048 sc1
    s_waitcnt vmcnt(63)
    v_mfma_f32_16x16x32_bf16 v[112:115], a[76:79], v[160:163], v[112:115]
    v_mfma_f32_16x16x32_bf16 v[116:119], a[76:79], v[164:167], v[116:119]
    v_mfma_f32_16x16x32_bf16 v[120:123], a[76:79], v[168:171], v[120:123]
    v_mfma_f32_16x16x32_bf16 v[124:127], a[76:79], v[172:175], v[124:127]
    buffer_load_dwordx4 a[76:79], v1, s[4:7], s86 offen offset:3072 sc1
    s_waitcnt vmcnt(63)
    v_mfma_f32_16x16x32_bf16 v[128:131], a[80:83], v[160:163], v[128:131]
    v_mfma_f32_16x16x32_bf16 v[132:135], a[80:83], v[164:167], v[132:135]
    v_mfma_f32_16x16x32_bf16 v[136:139], a[80:83], v[168:171], v[136:139]
    v_mfma_f32_16x16x32_bf16 v[140:143], a[80:83], v[172:175], v[140:143]
    s_add_u32 s86, s87, 327680
    buffer_load_dwordx4 a[80:83], v1, s[4:7], s86 offen offset:0 sc1
    s_waitcnt lgkmcnt(0)
    s_waitcnt vmcnt(63)
    v_mfma_f32_16x16x32_bf16 v[96:99], a[84:87], v[176:179], v[96:99]
    ds_read_b128 v[160:163], v211 offset:57344
    v_mfma_f32_16x16x32_bf16 v[100:103], a[84:87], v[180:183], v[100:103]
    ds_read_b128 v[164:167], v211 offset:58368
    v_mfma_f32_16x16x32_bf16 v[104:107], a[84:87], v[184:187], v[104:107]
    ds_read_b128 v[168:171], v211 offset:59392
    v_mfma_f32_16x16x32_bf16 v[108:111], a[84:87], v[188:191], v[108:111]
    ds_read_b128 v[172:175], v211 offset:60416
    buffer_load_dwordx4 a[84:87], v1, s[4:7], s86 offen offset:1024 sc1
    s_waitcnt vmcnt(63)
    v_mfma_f32_16x16x32_bf16 v[112:115], a[88:91], v[176:179], v[112:115]
    v_mfma_f32_16x16x32_bf16 v[116:119], a[88:91], v[180:183], v[116:119]
    v_mfma_f32_16x16x32_bf16 v[120:123], a[88:91], v[184:187], v[120:123]
    v_mfma_f32_16x16x32_bf16 v[124:127], a[88:91], v[188:191], v[124:127]
    buffer_load_dwordx4 a[88:91], v1, s[4:7], s86 offen offset:2048 sc1
    s_waitcnt vmcnt(63)
    v_mfma_f32_16x16x32_bf16 v[128:131], a[92:95], v[176:179], v[128:131]
    v_mfma_f32_16x16x32_bf16 v[132:135], a[92:95], v[180:183], v[132:135]
    v_mfma_f32_16x16x32_bf16 v[136:139], a[92:95], v[184:187], v[136:139]
    v_mfma_f32_16x16x32_bf16 v[140:143], a[92:95], v[188:191], v[140:143]
    buffer_load_dwordx4 a[92:95], v1, s[4:7], s86 offen offset:3072 sc1
    s_waitcnt lgkmcnt(0)
    s_waitcnt vmcnt(63)
    v_mfma_f32_16x16x32_bf16 v[96:99], a[96:99], v[160:163], v[96:99]
    ds_read_b128 v[176:179], v211 offset:61440
    v_mfma_f32_16x16x32_bf16 v[100:103], a[96:99], v[164:167], v[100:103]
    ds_read_b128 v[180:183], v211 offset:62464
    v_mfma_f32_16x16x32_bf16 v[104:107], a[96:99], v[168:171], v[104:107]
    ds_read_b128 v[184:187], v211 offset:63488
    v_mfma_f32_16x16x32_bf16 v[108:111], a[96:99], v[172:175], v[108:111]
    ds_read_b128 v[188:191], v211 offset:64512
    s_waitcnt vmcnt(63)
    v_mfma_f32_16x16x32_bf16 v[112:115], a[100:103], v[160:163], v[112:115]
    v_mfma_f32_16x16x32_bf16 v[116:119], a[100:103], v[164:167], v[116:119]
    v_mfma_f32_16x16x32_bf16 v[120:123], a[100:103], v[168:171], v[120:123]
    v_mfma_f32_16x16x32_bf16 v[124:127], a[100:103], v[172:175], v[124:127]
    s_waitcnt vmcnt(63)
    v_mfma_f32_16x16x32_bf16 v[128:131], a[104:107], v[160:163], v[128:131]
    v_mfma_f32_16x16x32_bf16 v[132:135], a[104:107], v[164:167], v[132:135]
    v_mfma_f32_16x16x32_bf16 v[136:139], a[104:107], v[168:171], v[136:139]
    v_mfma_f32_16x16x32_bf16 v[140:143], a[104:107], v[172:175], v[140:143]
    s_waitcnt lgkmcnt(0)
    s_waitcnt vmcnt(62)
    v_mfma_f32_16x16x32_bf16 v[96:99], a[108:111], v[176:179], v[96:99]
    ds_read_b128 v[160:163], v211 offset:0
    v_mfma_f32_16x16x32_bf16 v[100:103], a[108:111], v[180:183], v[100:103]
    ds_read_b128 v[164:167], v211 offset:1024
    v_mfma_f32_16x16x32_bf16 v[104:107], a[108:111], v[184:187], v[104:107]
    ds_read_b128 v[168:171], v211 offset:2048
    v_mfma_f32_16x16x32_bf16 v[108:111], a[108:111], v[188:191], v[108:111]
    ds_read_b128 v[172:175], v211 offset:3072
    s_waitcnt vmcnt(61)
    v_mfma_f32_16x16x32_bf16 v[112:115], a[112:115], v[176:179], v[112:115]
    v_mfma_f32_16x16x32_bf16 v[116:119], a[112:115], v[180:183], v[116:119]
    v_mfma_f32_16x16x32_bf16 v[120:123], a[112:115], v[184:187], v[120:123]
    v_mfma_f32_16x16x32_bf16 v[124:127], a[112:115], v[188:191], v[124:127]
    s_waitcnt vmcnt(60)
    v_mfma_f32_16x16x32_bf16 v[128:131], a[116:119], v[176:179], v[128:131]
    v_mfma_f32_16x16x32_bf16 v[132:135], a[116:119], v[180:183], v[132:135]
    v_mfma_f32_16x16x32_bf16 v[136:139], a[116:119], v[184:187], v[136:139]
    v_mfma_f32_16x16x32_bf16 v[140:143], a[116:119], v[188:191], v[140:143]
    s_waitcnt lgkmcnt(0)
    s_waitcnt vmcnt(59)
    v_mfma_f32_16x16x32_bf16 v[16:19], a[120:123], v[160:163], 0
    ds_read_b128 v[176:179], v211 offset:4096
    s_add_u32 s44, s94, 3
    s_and_b32 s44, s44, 7
    s_add_u32 s44, s44, s88
    s_lshl_b32 s44, s44, 16
    s_add_u32 s44, s44, s89
    v_mfma_f32_16x16x32_bf16 v[20:23], a[120:123], v[164:167], 0
    ds_read_b128 v[180:183], v211 offset:5120
    v_cvt_pk_bf16_f32 v192, v96, v97
    v_mfma_f32_16x16x32_bf16 v[24:27], a[120:123], v[168:171], 0
    ds_read_b128 v[184:187], v211 offset:6144
    v_cvt_pk_bf16_f32 v193, v98, v99
    v_mfma_f32_16x16x32_bf16 v[28:31], a[120:123], v[172:175], 0
    ds_read_b128 v[188:191], v211 offset:7168
    s_waitcnt vmcnt(58)
    v_mfma_f32_16x16x32_bf16 v[32:35], a[124:127], v[160:163], 0
    v_cvt_pk_bf16_f32 v194, v100, v101
    v_cvt_pk_bf16_f32 v195, v102, v103
    v_mfma_f32_16x16x32_bf16 v[36:39], a[124:127], v[164:167], 0
    v_permlane16_swap_b32 v192, v194
    v_permlane16_swap_b32 v193, v195
    v_mfma_f32_16x16x32_bf16 v[40:43], a[124:127], v[168:171], 0
    buffer_store_dwordx4 v[192:195], v215, s[4:7], s44 offen sc1
    v_cvt_pk_bf16_f32 v196, v104, v105
    v_mfma_f32_16x16x32_bf16 v[44:47], a[124:127], v[172:175], 0
    v_cvt_pk_bf16_f32 v197, v106, v107
    s_waitcnt lgkmcnt(0)
    s_waitcnt vmcnt(58)
    v_mfma_f32_16x16x32_bf16 v[16:19], a[128:131], v[176:179], v[16:19]
    ds_read_b128 v[160:163], v211 offset:8192
    v_cvt_pk_bf16_f32 v198, v108, v109
    v_mfma_f32_16x16x32_bf16 v[20:23], a[128:131], v[180:183], v[20:23]
    ds_read_b128 v[164:167], v211 offset:9216
    v_cvt_pk_bf16_f32 v199, v110, v111
    v_mfma_f32_16x16x32_bf16 v[24:27], a[128:131], v[184:187], v[24:27]
    ds_read_b128 v[168:171], v211 offset:10240
    v_permlane16_swap_b32 v196, v198
    v_mfma_f32_16x16x32_bf16 v[28:31], a[128:131], v[188:191], v[28:31]
    ds_read_b128 v[172:175], v211 offset:11264
    s_waitcnt vmcnt(57)
    v_mfma_f32_16x16x32_bf16 v[32:35], a[132:135], v[176:179], v[32:35]
    v_permlane16_swap_b32 v197, v199
    buffer_store_dwordx4 v[196:199], v216, s[4:7], s44 offen sc1
    v_mfma_f32_16x16x32_bf16 v[36:39], a[132:135], v[180:183], v[36:39]
    s_add_u32 s44, s94, 4
    s_and_b32 s44, s44, 7
    s_add_u32 s44, s44, s88
    s_lshl_b32 s44, s44, 16
    s_add_u32 s44, s44, s89
    v_cvt_pk_bf16_f32 v200, v112, v113
    v_mfma_f32_16x16x32_bf16 v[40:43], a[132:135], v[184:187], v[40:43]
    v_cvt_pk_bf16_f32 v201, v114, v115
    v_cvt_pk_bf16_f32 v202, v116, v117
    v_mfma_f32_16x16x32_bf16 v[44:47], a[132:135], v[188:191], v[44:47]
    v_cvt_pk_bf16_f32 v203, v118, v119
    s_waitcnt lgkmcnt(0)
    s_waitcnt vmcnt(57)
    v_mfma_f32_16x16x32_bf16 v[16:19], a[136:139], v[160:163], v[16:19]
    ds_read_b128 v[176:179], v211 offset:12288
    v_permlane16_swap_b32 v200, v202
    v_mfma_f32_16x16x32_bf16 v[20:23], a[136:139], v[164:167], v[20:23]
    ds_read_b128 v[180:183], v211 offset:13312
    v_permlane16_swap_b32 v201, v203
    v_mfma_f32_16x16x32_bf16 v[24:27], a[136:139], v[168:171], v[24:27]
    ds_read_b128 v[184:187], v211 offset:14336
    buffer_store_dwordx4 v[200:203], v215, s[4:7], s44 offen sc1
    v_mfma_f32_16x16x32_bf16 v[28:31], a[136:139], v[172:175], v[28:31]
    ds_read_b128 v[188:191], v211 offset:15360
    s_waitcnt vmcnt(57)
    v_mfma_f32_16x16x32_bf16 v[32:35], a[140:143], v[160:163], v[32:35]
    v_cvt_pk_bf16_f32 v204, v120, v121
    v_cvt_pk_bf16_f32 v205, v122, v123
    v_mfma_f32_16x16x32_bf16 v[36:39], a[140:143], v[164:167], v[36:39]
    v_cvt_pk_bf16_f32 v206, v124, v125
    v_cvt_pk_bf16_f32 v207, v126, v127
    v_mfma_f32_16x16x32_bf16 v[40:43], a[140:143], v[168:171], v[40:43]
    v_permlane16_swap_b32 v204, v206
    v_permlane16_swap_b32 v205, v207
    v_mfma_f32_16x16x32_bf16 v[44:47], a[140:143], v[172:175], v[44:47]
    buffer_store_dwordx4 v[204:207], v216, s[4:7], s44 offen sc1
    s_waitcnt lgkmcnt(0)
    s_waitcnt vmcnt(57)
    v_mfma_f32_16x16x32_bf16 v[16:19], a[144:147], v[176:179], v[16:19]
    ds_read_b128 v[160:163], v211 offset:16384
    s_add_u32 s44, s94, 5
    s_and_b32 s44, s44, 7
    s_add_u32 s44, s44, s88
    s_lshl_b32 s44, s44, 16
    s_add_u32 s44, s44, s89
    v_mfma_f32_16x16x32_bf16 v[20:23], a[144:147], v[180:183], v[20:23]
    ds_read_b128 v[164:167], v211 offset:17408
    v_cvt_pk_bf16_f32 v192, v128, v129
    v_mfma_f32_16x16x32_bf16 v[24:27], a[144:147], v[184:187], v[24:27]
    ds_read_b128 v[168:171], v211 offset:18432
    v_cvt_pk_bf16_f32 v193, v130, v131
    v_mfma_f32_16x16x32_bf16 v[28:31], a[144:147], v[188:191], v[28:31]
    ds_read_b128 v[172:175], v211 offset:19456
    s_waitcnt vmcnt(55)
    v_mfma_f32_16x16x32_bf16 v[32:35], a[148:151], v[176:179], v[32:35]
    v_cvt_pk_bf16_f32 v194, v132, v133
    v_cvt_pk_bf16_f32 v195, v134, v135
    v_mfma_f32_16x16x32_bf16 v[36:39], a[148:151], v[180:183], v[36:39]
    v_permlane16_swap_b32 v192, v194
    v_permlane16_swap_b32 v193, v195
    v_mfma_f32_16x16x32_bf16 v[40:43], a[148:151], v[184:187], v[40:43]
    buffer_store_dwordx4 v[192:195], v215, s[4:7], s44 offen sc1
    v_cvt_pk_bf16_f32 v196, v136, v137
    v_mfma_f32_16x16x32_bf16 v[44:47], a[148:151], v[188:191], v[44:47]
    v_cvt_pk_bf16_f32 v197, v138, v139
    s_waitcnt lgkmcnt(0)
    s_waitcnt vmcnt(54)
    v_mfma_f32_16x16x32_bf16 v[16:19], a[152:155], v[160:163], v[16:19]
    ds_read_b128 v[176:179], v211 offset:20480
    v_cvt_pk_bf16_f32 v198, v140, v141
    v_mfma_f32_16x16x32_bf16 v[20:23], a[152:155], v[164:167], v[20:23]
    ds_read_b128 v[180:183], v211 offset:21504
    v_cvt_pk_bf16_f32 v199, v142, v143
    v_mfma_f32_16x16x32_bf16 v[24:27], a[152:155], v[168:171], v[24:27]
    ds_read_b128 v[184:187], v211 offset:22528
    v_permlane16_swap_b32 v196, v198
    v_mfma_f32_16x16x32_bf16 v[28:31], a[152:155], v[172:175], v[28:31]
    ds_read_b128 v[188:191], v211 offset:23552
    s_waitcnt vmcnt(53)
    v_mfma_f32_16x16x32_bf16 v[32:35], a[156:159], v[160:163], v[32:35]
    v_permlane16_swap_b32 v197, v199
    buffer_store_dwordx4 v[196:199], v216, s[4:7], s44 offen sc1
    v_mfma_f32_16x16x32_bf16 v[36:39], a[156:159], v[164:167], v[36:39]
    v_mfma_f32_16x16x32_bf16 v[40:43], a[156:159], v[168:171], v[40:43]
    v_mfma_f32_16x16x32_bf16 v[44:47], a[156:159], v[172:175], v[44:47]
    s_waitcnt lgkmcnt(0)
    s_waitcnt vmcnt(52)
    v_mfma_f32_16x16x32_bf16 v[16:19], a[160:163], v[176:179], v[16:19]
    ds_read_b128 v[160:163], v211 offset:24576
    v_mfma_f32_16x16x32_bf16 v[20:23], a[160:163], v[180:183], v[20:23]
    ds_read_b128 v[164:167], v211 offset:25600
    v_mfma_f32_16x16x32_bf16 v[24:27], a[160:163], v[184:187], v[24:27]
    ds_read_b128 v[168:171], v211 offset:26624
    v_mfma_f32_16x16x32_bf16 v[28:31], a[160:163], v[188:191], v[28:31]
    ds_read_b128 v[172:175], v211 offset:27648
    s_waitcnt vmcnt(50)
    v_mfma_f32_16x16x32_bf16 v[32:35], a[164:167], v[176:179], v[32:35]
    v_mfma_f32_16x16x32_bf16 v[36:39], a[164:167], v[180:183], v[36:39]
    v_mfma_f32_16x16x32_bf16 v[40:43], a[164:167], v[184:187], v[40:43]
    v_mfma_f32_16x16x32_bf16 v[44:47], a[164:167], v[188:191], v[44:47]
    s_waitcnt lgkmcnt(0)
    s_waitcnt vmcnt(49)
    v_mfma_f32_16x16x32_bf16 v[16:19], a[168:171], v[160:163], v[16:19]
    s_waitcnt vmcnt(46)
    s_mov_b64 exec, 1
    s_add_u32 s45, s88, 8
    s_lshl_b32 s45, s45, 7
    s_add_u32 s45, s45, s49
    buffer_store_dword v14, v6, s[4:7], s45 offen sc1
    s_add_u32 s45, s94, 1
    s_and_b32 s45, s45, 7
    s_add_u32 s45, s45, s88
    s_lshl_b32 s45, s45, 7
    s_add_u32 s45, s45, s49
    buffer_store_dword v14, v6, s[4:7], s45 offen sc1
    s_add_u32 s45, s94, 2
    s_and_b32 s45, s45, 7
    s_add_u32 s45, s45, s88
    s_lshl_b32 s45, s45, 7
    s_add_u32 s45, s45, s49
    buffer_store_dword v14, v6, s[4:7], s45 offen sc1
    s_mov_b64 exec, -1
    v_mfma_f32_16x16x32_bf16 v[20:23], a[168:171], v[164:167], v[20:23]
    ds_read_b128 v[176:179], v211 offset:28672
    v_mfma_f32_16x16x32_bf16 v[24:27], a[168:171], v[168:171], v[24:27]
    ds_read_b128 v[180:183], v211 offset:29696
    v_mfma_f32_16x16x32_bf16 v[28:31], a[168:171], v[172:175], v[28:31]
    ds_read_b128 v[184:187], v211 offset:30720
    v_mfma_f32_16x16x32_bf16 v[32:35], a[172:175], v[160:163], v[32:35]
    ds_read_b128 v[188:191], v211 offset:31744
    v_mfma_f32_16x16x32_bf16 v[36:39], a[172:175], v[164:167], v[36:39]
    v_mfma_f32_16x16x32_bf16 v[40:43], a[172:175], v[168:171], v[40:43]
    v_mfma_f32_16x16x32_bf16 v[44:47], a[172:175], v[172:175], v[44:47]
    s_waitcnt lgkmcnt(0)
    s_waitcnt vmcnt(48)
    v_mfma_f32_16x16x32_bf16 v[16:19], a[176:179], v[176:179], v[16:19]
    ds_read_b128 v[160:163], v212 offset:0
    v_mfma_f32_16x16x32_bf16 v[20:23], a[176:179], v[180:183], v[20:23]
    ds_read_b128 v[164:167], v212 offset:1024
    v_mfma_f32_16x16x32_bf16 v[24:27], a[176:179], v[184:187], v[24:27]
    ds_read_b128 v[168:171], v212 offset:2048
    v_mfma_f32_16x16x32_bf16 v[28:31], a[176:179], v[188:191], v[28:31]
    ds_read_b128 v[172:175], v212 offset:3072
    s_waitcnt vmcnt(47)
    v_mfma_f32_16x16x32_bf16 v[32:35], a[180:183], v[176:179], v[32:35]
    v_mfma_f32_16x16x32_bf16 v[36:39], a[180:183], v[180:183], v[36:39]
    v_mfma_f32_16x16x32_bf16 v[40:43], a[180:183], v[184:187], v[40:43]
    v_mfma_f32_16x16x32_bf16 v[44:47], a[180:183], v[188:191], v[44:47]
    s_waitcnt lgkmcnt(0)
    s_waitcnt vmcnt(46)
    v_mfma_f32_16x16x32_bf16 v[16:19], a[184:187], v[160:163], v[16:19]
    ds_read_b128 v[176:179], v212 offset:4096
    v_mfma_f32_16x16x32_bf16 v[20:23], a[184:187], v[164:167], v[20:23]
    ds_read_b128 v[180:183], v212 offset:5120
    v_mfma_f32_16x16x32_bf16 v[24:27], a[184:187], v[168:171], v[24:27]
    ds_read_b128 v[184:187], v212 offset:6144
    v_mfma_f32_16x16x32_bf16 v[28:31], a[184:187], v[172:175], v[28:31]
    ds_read_b128 v[188:191], v212 offset:7168
    s_waitcnt vmcnt(45)
    v_mfma_f32_16x16x32_bf16 v[32:35], a[188:191], v[160:163], v[32:35]
    v_mfma_f32_16x16x32_bf16 v[36:39], a[188:191], v[164:167], v[36:39]
    v_mfma_f32_16x16x32_bf16 v[40:43], a[188:191], v[168:171], v[40:43]
    v_mfma_f32_16x16x32_bf16 v[44:47], a[188:191], v[172:175], v[44:47]
    s_waitcnt lgkmcnt(0)
    s_waitcnt vmcnt(44)
    v_mfma_f32_16x16x32_bf16 v[16:19], a[192:195], v[176:179], v[16:19]
    ds_read_b128 v[160:163], v211 offset:32768
    v_mfma_f32_16x16x32_bf16 v[20:23], a[192:195], v[180:183], v[20:23]
    ds_read_b128 v[164:167], v211 offset:33792
    v_mfma_f32_16x16x32_bf16 v[24:27], a[192:195], v[184:187], v[24:27]
    ds_read_b128 v[168:171], v211 offset:34816
    v_mfma_f32_16x16x32_bf16 v[28:31], a[192:195], v[188:191], v[28:31]
    ds_read_b128 v[172:175], v211 offset:35840
    s_waitcnt vmcnt(43)
    v_mfma_f32_16x16x32_bf16 v[32:35], a[196:199], v[176:179], v[32:35]
    v_mfma_f32_16x16x32_bf16 v[36:39], a[196:199], v[180:183], v[36:39]
    v_mfma_f32_16x16x32_bf16 v[40:43], a[196:199], v[184:187], v[40:43]
    v_mfma_f32_16x16x32_bf16 v[44:47], a[196:199], v[188:191], v[44:47]
    s_waitcnt lgkmcnt(0)
    s_waitcnt vmcnt(42)
    v_mfma_f32_16x16x32_bf16 v[16:19], a[200:203], v[160:163], v[16:19]
    ds_read_b128 v[176:179], v211 offset:36864
    v_mfma_f32_16x16x32_bf16 v[20:23], a[200:203], v[164:167], v[20:23]
    ds_read_b128 v[180:183], v211 offset:37888
    v_mfma_f32_16x16x32_bf16 v[24:27], a[200:203], v[168:171], v[24:27]
    ds_read_b128 v[184:187], v211 offset:38912
    v_mfma_f32_16x16x32_bf16 v[28:31], a[200:203], v[172:175], v[28:31]
    ds_read_b128 v[188:191], v211 offset:39936
    s_waitcnt vmcnt(41)
    v_mfma_f32_16x16x32_bf16 v[32:35], a[204:207], v[160:163], v[32:35]
    v_mfma_f32_16x16x32_bf16 v[36:39], a[204:207], v[164:167], v[36:39]
    v_mfma_f32_16x16x32_bf16 v[40:43], a[204:207], v[168:171], v[40:43]
    v_mfma_f32_16x16x32_bf16 v[44:47], a[204:207], v[172:175], v[44:47]
    s_waitcnt lgkmcnt(0)
    s_waitcnt vmcnt(40)
    v_mfma_f32_16x16x32_bf16 v[16:19], a[208:211], v[176:179], v[16:19]
    ds_read_b128 v[160:163], v211 offset:40960
    v_mfma_f32_16x16x32_bf16 v[20:23], a[208:211], v[180:183], v[20:23]
    ds_read_b128 v[164:167], v211 offset:41984
    v_mfma_f32_16x16x32_bf16 v[24:27], a[208:211], v[184:187], v[24:27]
    ds_read_b128 v[168:171], v211 offset:43008
    v_mfma_f32_16x16x32_bf16 v[28:31], a[208:211], v[188:191], v[28:31]
    ds_read_b128 v[172:175], v211 offset:44032
    s_waitcnt vmcnt(39)
    v_mfma_f32_16x16x32_bf16 v[32:35], a[212:215], v[176:179], v[32:35]
    v_mfma_f32_16x16x32_bf16 v[36:39], a[212:215], v[180:183], v[36:39]
    v_mfma_f32_16x16x32_bf16 v[40:43], a[212:215], v[184:187], v[40:43]
    v_mfma_f32_16x16x32_bf16 v[44:47], a[212:215], v[188:191], v[44:47]
    s_waitcnt lgkmcnt(0)
    s_waitcnt vmcnt(38)
    v_mfma_f32_16x16x32_bf16 v[16:19], a[216:219], v[160:163], v[16:19]
    ds_read_b128 v[176:179], v211 offset:45056
    v_mfma_f32_16x16x32_bf16 v[20:23], a[216:219], v[164:167], v[20:23]
    ds_read_b128 v[180:183], v211 offset:46080
    v_mfma_f32_16x16x32_bf16 v[24:27], a[216:219], v[168:171], v[24:27]
    ds_read_b128 v[184:187], v211 offset:47104
    v_mfma_f32_16x16x32_bf16 v[28:31], a[216:219], v[172:175], v[28:31]
    ds_read_b128 v[188:191], v211 offset:48128
    s_waitcnt vmcnt(37)
    v_mfma_f32_16x16x32_bf16 v[32:35], a[220:223], v[160:163], v[32:35]
    v_mfma_f32_16x16x32_bf16 v[36:39], a[220:223], v[164:167], v[36:39]
    v_mfma_f32_16x16x32_bf16 v[40:43], a[220:223], v[168:171], v[40:43]
    v_mfma_f32_16x16x32_bf16 v[44:47], a[220:223], v[172:175], v[44:47]
    s_waitcnt lgkmcnt(0)
    s_waitcnt vmcnt(36)
    v_mfma_f32_16x16x32_bf16 v[16:19], a[224:227], v[176:179], v[16:19]
    ds_read_b128 v[160:163], v211 offset:49152
    v_mfma_f32_16x16x32_bf16 v[20:23], a[224:227], v[180:183], v[20:23]
    ds_read_b128 v[164:167], v211 offset:50176
    v_mfma_f32_16x16x32_bf16 v[24:27], a[224:227], v[184:187], v[24:27]
    ds_read_b128 v[168:171], v211 offset:51200
    v_mfma_f32_16x16x32_bf16 v[28:31], a[224:227], v[188:191], v[28:31]
    ds_read_b128 v[172:175], v211 offset:52224
    s_waitcnt vmcnt(35)
    v_mfma_f32_16x16x32_bf16 v[32:35], a[228:231], v[176:179], v[32:35]
    v_mfma_f32_16x16x32_bf16 v[36:39], a[228:231], v[180:183], v[36:39]
    v_mfma_f32_16x16x32_bf16 v[40:43], a[228:231], v[184:187], v[40:43]
    v_mfma_f32_16x16x32_bf16 v[44:47], a[228:231], v[188:191], v[44:47]
    s_waitcnt lgkmcnt(0)
    s_waitcnt vmcnt(34)
    v_mfma_f32_16x16x32_bf16 v[16:19], a[232:235], v[160:163], v[16:19]
    s_lshl_b32 s44, s94, 13
    s_add_u32 s44, s44, s48
    s_add_u32 s45, s44, 4096
    buffer_load_dwordx2 v[144:145], v5, s[4:7], s44 offen offset:0 sc1
    buffer_load_dwordx2 v[146:147], v5, s[4:7], s44 offen offset:512 sc1
    buffer_load_dwordx2 v[148:149], v5, s[4:7], s45 offen offset:0 sc1
    buffer_load_dwordx2 v[150:151], v5, s[4:7], s45 offen offset:512 sc1
    v_mfma_f32_16x16x32_bf16 v[20:23], a[232:235], v[164:167], v[20:23]
    ds_read_b128 v[176:179], v211 offset:53248
    v_mfma_f32_16x16x32_bf16 v[24:27], a[232:235], v[168:171], v[24:27]
    ds_read_b128 v[180:183], v211 offset:54272
    v_mfma_f32_16x16x32_bf16 v[28:31], a[232:235], v[172:175], v[28:31]
    ds_read_b128 v[184:187], v211 offset:55296
    s_waitcnt vmcnt(37)
    v_mfma_f32_16x16x32_bf16 v[32:35], a[236:239], v[160:163], v[32:35]
    ds_read_b128 v[188:191], v211 offset:56320
    v_mfma_f32_16x16x32_bf16 v[36:39], a[236:239], v[164:167], v[36:39]
    v_mfma_f32_16x16x32_bf16 v[40:43], a[236:239], v[168:171], v[40:43]
    v_mfma_f32_16x16x32_bf16 v[44:47], a[236:239], v[172:175], v[44:47]
    s_waitcnt lgkmcnt(0)
    s_waitcnt vmcnt(36)
    v_mfma_f32_16x16x32_bf16 v[16:19], a[0:3], v[176:179], v[16:19]
    ds_read_b128 v[160:163], v211 offset:57344
    v_mfma_f32_16x16x32_bf16 v[20:23], a[0:3], v[180:183], v[20:23]
    ds_read_b128 v[164:167], v211 offset:58368
    v_mfma_f32_16x16x32_bf16 v[24:27], a[0:3], v[184:187], v[24:27]
    ds_read_b128 v[168:171], v211 offset:59392
    v_mfma_f32_16x16x32_bf16 v[28:31], a[0:3], v[188:191], v[28:31]
    ds_read_b128 v[172:175], v211 offset:60416
    s_waitcnt vmcnt(35)
    v_mfma_f32_16x16x32_bf16 v[32:35], a[4:7], v[176:179], v[32:35]
    v_mfma_f32_16x16x32_bf16 v[36:39], a[4:7], v[180:183], v[36:39]
    v_mfma_f32_16x16x32_bf16 v[40:43], a[4:7], v[184:187], v[40:43]
    v_mfma_f32_16x16x32_bf16 v[44:47], a[4:7], v[188:191], v[44:47]
    s_waitcnt lgkmcnt(0)
    s_waitcnt vmcnt(34)
    v_mfma_f32_16x16x32_bf16 v[16:19], a[8:11], v[160:163], v[16:19]
    ds_read_b128 v[176:179], v211 offset:61440
    v_mfma_f32_16x16x32_bf16 v[20:23], a[8:11], v[164:167], v[20:23]
    ds_read_b128 v[180:183], v211 offset:62464
    v_mfma_f32_16x16x32_bf16 v[24:27], a[8:11], v[168:171], v[24:27]
    ds_read_b128 v[184:187], v211 offset:63488
    v_mfma_f32_16x16x32_bf16 v[28:31], a[8:11], v[172:175], v[28:31]
    ds_read_b128 v[188:191], v211 offset:64512
    s_waitcnt vmcnt(33)
    v_mfma_f32_16x16x32_bf16 v[32:35], a[12:15], v[160:163], v[32:35]
    v_mfma_f32_16x16x32_bf16 v[36:39], a[12:15], v[164:167], v[36:39]
    v_mfma_f32_16x16x32_bf16 v[40:43], a[12:15], v[168:171], v[40:43]
    v_mfma_f32_16x16x32_bf16 v[44:47], a[12:15], v[172:175], v[44:47]
    s_waitcnt lgkmcnt(0)
    s_waitcnt vmcnt(32)
    v_mfma_f32_16x16x32_bf16 v[16:19], a[16:19], v[176:179], v[16:19]
    ds_read_b128 v[160:163], v211 offset:0
    v_mfma_f32_16x16x32_bf16 v[20:23], a[16:19], v[180:183], v[20:23]
    ds_read_b128 v[164:167], v211 offset:1024
    v_mfma_f32_16x16x32_bf16 v[24:27], a[16:19], v[184:187], v[24:27]
    ds_read_b128 v[168:171], v211 offset:2048
    v_mfma_f32_16x16x32_bf16 v[28:31], a[16:19], v[188:191], v[28:31]
    ds_read_b128 v[172:175], v211 offset:3072
    s_waitcnt vmcnt(31)
    v_mfma_f32_16x16x32_bf16 v[32:35], a[20:23], v[176:179], v[32:35]
    v_mfma_f32_16x16x32_bf16 v[36:39], a[20:23], v[180:183], v[36:39]
    v_mfma_f32_16x16x32_bf16 v[40:43], a[20:23], v[184:187], v[40:43]
    v_mfma_f32_16x16x32_bf16 v[44:47], a[20:23], v[188:191], v[44:47]
    s_waitcnt lgkmcnt(0)
    s_waitcnt vmcnt(30)
    v_mfma_f32_16x16x32_bf16 v[96:99], a[24:27], v[160:163], 0
    ds_read_b128 v[176:179], v211 offset:4096
    s_add_u32 s44, s94, 6
    s_and_b32 s44, s44, 7
    s_add_u32 s44, s44, s88
    s_lshl_b32 s44, s44, 16
    s_add_u32 s44, s44, s89
    v_cvt_pk_bf16_f32 v192, v16, v17
    v_cvt_pk_bf16_f32 v193, v18, v19
    v_cvt_pk_bf16_f32 v194, v20, v21
    v_mfma_f32_16x16x32_bf16 v[100:103], a[24:27], v[164:167], 0
    ds_read_b128 v[180:183], v211 offset:5120
    v_cvt_pk_bf16_f32 v195, v22, v23
    v_permlane16_swap_b32 v192, v194
    s_nop 0
    v_permlane16_swap_b32 v193, v195
    buffer_store_dwordx4 v[192:195], v215, s[4:7], s44 offen sc1
    v_mfma_f32_16x16x32_bf16 v[104:107], a[24:27], v[168:171], 0
    ds_read_b128 v[184:187], v211 offset:6144
    v_cvt_pk_bf16_f32 v196, v24, v25
    v_cvt_pk_bf16_f32 v197, v26, v27
    v_cvt_pk_bf16_f32 v198, v28, v29
    v_cvt_pk_bf16_f32 v199, v30, v31
    v_mfma_f32_16x16x32_bf16 v[108:111], a[24:27], v[172:175], 0
    ds_read_b128 v[188:191], v211 offset:7168
    v_permlane16_swap_b32 v196, v198
    v_permlane16_swap_b32 v197, v199
    buffer_store_dwordx4 v[196:199], v216, s[4:7], s44 offen sc1
    s_waitcnt lgkmcnt(0)
    s_waitcnt vmcnt(31)
    v_mfma_f32_16x16x32_bf16 v[96:99], a[28:31], v[176:179], v[96:99]
    ds_read_b128 v[160:163], v211 offset:8192
    s_add_u32 s44, s94, 7
    s_and_b32 s44, s44, 7
    s_add_u32 s44, s44, s88
    s_lshl_b32 s44, s44, 16
    s_add_u32 s44, s44, s89
    v_cvt_pk_bf16_f32 v200, v32, v33
    v_cvt_pk_bf16_f32 v201, v34, v35
    v_cvt_pk_bf16_f32 v202, v36, v37
    v_mfma_f32_16x16x32_bf16 v[100:103], a[28:31], v[180:183], v[100:103]
    ds_read_b128 v[164:167], v211 offset:9216
    v_cvt_pk_bf16_f32 v203, v38, v39
    v_permlane16_swap_b32 v200, v202
    s_nop 0
    v_permlane16_swap_b32 v201, v203
    buffer_store_dwordx4 v[200:203], v215, s[4:7], s44 offen sc1
    v_mfma_f32_16x16x32_bf16 v[104:107], a[28:31], v[184:187], v[104:107]
    ds_read_b128 v[168:171], v211 offset:10240
    v_cvt_pk_bf16_f32 v204, v40, v41
    v_cvt_pk_bf16_f32 v205, v42, v43
    v_cvt_pk_bf16_f32 v206, v44, v45
    v_cvt_pk_bf16_f32 v207, v46, v47
    v_mfma_f32_16x16x32_bf16 v[108:111], a[28:31], v[188:191], v[108:111]
    ds_read_b128 v[172:175], v211 offset:11264
    v_permlane16_swap_b32 v204, v206
    v_permlane16_swap_b32 v205, v207
    buffer_store_dwordx4 v[204:207], v216, s[4:7], s44 offen sc1
    s_waitcnt lgkmcnt(0)
    s_waitcnt vmcnt(32)
    v_mfma_f32_16x16x32_bf16 v[96:99], a[32:35], v[160:163], v[96:99]
    ds_read_b128 v[176:179], v211 offset:12288
    v_mfma_f32_16x16x32_bf16 v[100:103], a[32:35], v[164:167], v[100:103]
    ds_read_b128 v[180:183], v211 offset:13312
    v_mfma_f32_16x16x32_bf16 v[104:107], a[32:35], v[168:171], v[104:107]
    ds_read_b128 v[184:187], v211 offset:14336
    v_mfma_f32_16x16x32_bf16 v[108:111], a[32:35], v[172:175], v[108:111]
    ds_read_b128 v[188:191], v211 offset:15360
    s_waitcnt lgkmcnt(0)
    s_waitcnt vmcnt(31)
    v_mfma_f32_16x16x32_bf16 v[96:99], a[36:39], v[176:179], v[96:99]
    ds_read_b128 v[160:163], v211 offset:16384
    v_mfma_f32_16x16x32_bf16 v[100:103], a[36:39], v[180:183], v[100:103]
    ds_read_b128 v[164:167], v211 offset:17408
    v_mfma_f32_16x16x32_bf16 v[104:107], a[36:39], v[184:187], v[104:107]
    ds_read_b128 v[168:171], v211 offset:18432
    v_mfma_f32_16x16x32_bf16 v[108:111], a[36:39], v[188:191], v[108:111]
    ds_read_b128 v[172:175], v211 offset:19456
    s_waitcnt lgkmcnt(0)
    s_waitcnt vmcnt(30)
    v_mfma_f32_16x16x32_bf16 v[96:99], a[40:43], v[160:163], v[96:99]
    ds_read_b128 v[176:179], v211 offset:20480
    v_mfma_f32_16x16x32_bf16 v[100:103], a[40:43], v[164:167], v[100:103]
    ds_read_b128 v[180:183], v211 offset:21504
    v_mfma_f32_16x16x32_bf16 v[104:107], a[40:43], v[168:171], v[104:107]
    ds_read_b128 v[184:187], v211 offset:22528
    v_mfma_f32_16x16x32_bf16 v[108:111], a[40:43], v[172:175], v[108:111]
    ds_read_b128 v[188:191], v211 offset:23552
    s_waitcnt lgkmcnt(0)
    s_waitcnt vmcnt(29)
    v_mfma_f32_16x16x32_bf16 v[96:99], a[44:47], v[176:179], v[96:99]
    ds_read_b128 v[160:163], v211 offset:24576
    v_mfma_f32_16x16x32_bf16 v[100:103], a[44:47], v[180:183], v[100:103]
    ds_read_b128 v[164:167], v211 offset:25600
    v_mfma_f32_16x16x32_bf16 v[104:107], a[44:47], v[184:187], v[104:107]
    ds_read_b128 v[168:171], v211 offset:26624
    v_mfma_f32_16x16x32_bf16 v[108:111], a[44:47], v[188:191], v[108:111]
    ds_read_b128 v[172:175], v211 offset:27648
    s_waitcnt lgkmcnt(0)
    s_waitcnt vmcnt(28)
    v_mfma_f32_16x16x32_bf16 v[96:99], a[48:51], v[160:163], v[96:99]
    ds_read_b128 v[176:179], v211 offset:28672
    v_mfma_f32_16x16x32_bf16 v[100:103], a[48:51], v[164:167], v[100:103]
    ds_read_b128 v[180:183], v211 offset:29696
    v_mfma_f32_16x16x32_bf16 v[104:107], a[48:51], v[168:171], v[104:107]
    ds_read_b128 v[184:187], v211 offset:30720
    v_mfma_f32_16x16x32_bf16 v[108:111], a[48:51], v[172:175], v[108:111]
    ds_read_b128 v[188:191], v211 offset:31744
    s_waitcnt lgkmcnt(0)
    s_waitcnt vmcnt(27)
    v_mfma_f32_16x16x32_bf16 v[96:99], a[52:55], v[176:179], v[96:99]
    buffer_load_dword v60, v232, s[4:7], s90 offen sc1
    v_mfma_f32_16x16x32_bf16 v[100:103], a[52:55], v[180:183], v[100:103]
    ds_read_b128 v[160:163], v212 offset:0
    v_mfma_f32_16x16x32_bf16 v[104:107], a[52:55], v[184:187], v[104:107]
    ds_read_b128 v[164:167], v212 offset:1024
    v_mfma_f32_16x16x32_bf16 v[108:111], a[52:55], v[188:191], v[108:111]
    ds_read_b128 v[168:171], v212 offset:2048
    ds_read_b128 v[172:175], v212 offset:3072
    s_waitcnt lgkmcnt(0)
    s_waitcnt vmcnt(27)
    v_mfma_f32_16x16x32_bf16 v[96:99], a[56:59], v[160:163], v[96:99]
    s_waitcnt vmcnt(1)
    s_mov_b64 exec, 1
    s_add_u32 s45, s94, 3
    s_and_b32 s45, s45, 7
    s_add_u32 s45, s45, s88
    s_lshl_b32 s45, s45, 7
    s_add_u32 s45, s45, s49
    buffer_store_dword v14, v6, s[4:7], s45 offen sc1
    s_add_u32 s45, s94, 4
    s_and_b32 s45, s45, 7
    s_add_u32 s45, s45, s88
    s_lshl_b32 s45, s45, 7
    s_add_u32 s45, s45, s49
    buffer_store_dword v14, v6, s[4:7], s45 offen sc1
    s_add_u32 s45, s94, 5
    s_and_b32 s45, s45, 7
    s_add_u32 s45, s45, s88
    s_lshl_b32 s45, s45, 7
    s_add_u32 s45, s45, s49
    buffer_store_dword v14, v6, s[4:7], s45 offen sc1
    s_add_u32 s45, s94, 6
    s_and_b32 s45, s45, 7
    s_add_u32 s45, s45, s88
    s_lshl_b32 s45, s45, 7
    s_add_u32 s45, s45, s49
    buffer_store_dword v14, v6, s[4:7], s45 offen sc1
    s_add_u32 s45, s94, 7
    s_and_b32 s45, s45, 7
    s_add_u32 s45, s45, s88
    s_lshl_b32 s45, s45, 7
    s_add_u32 s45, s45, s49
    buffer_store_dword v14, v6, s[4:7], s45 offen sc1
    s_mov_b64 exec, -1
    s_waitcnt vmcnt(5)
    v_cmp_ne_u32 vcc, 1, v60
    s_cbranch_vccz ok_54
    s_mov_b32 s52, 0
poll_55:
    buffer_load_dword v60, v232, s[4:7], s90 offen sc1
    s_waitcnt vmcnt(0)
    v_cmp_ne_u32 vcc, 1, v60
    s_cbranch_vccz pdone_56
    s_add_u32 s52, s52, 1
    s_cmp_lt_u32 s52, 20000
    s_cbranch_scc1 poll_55
pdone_56:
ok_54:
    s_add_u32 s46, s88, s94
    s_lshl_b32 s46, s46, 16
    s_lshl_b32 s45, s40, 11
    s_add_u32 s46, s46, s45
    s_add_u32 s46, s46, 19922944
    s_add_u32 s44, s94, 7
    s_and_b32 s44, s44, 7
    s_lshl_b32 s44, s44, 13
    s_add_u32 s44, s44, s46
    buffer_load_dwordx4 v[48:51], v1, s[4:7], s44 offen offset:0 sc1
    buffer_load_dwordx4 v[52:55], v1, s[4:7], s44 offen offset:1024 sc1
    s_add_u32 s44, s94, 6
    s_and_b32 s44, s44, 7
    s_lshl_b32 s44, s44, 13
    s_add_u32 s44, s44, s46
    buffer_load_dwordx4 v[56:59], v1, s[4:7], s44 offen offset:0 sc1
    buffer_load_dwordx4 v[60:63], v1, s[4:7], s44 offen offset:1024 sc1
    s_lshl_b32 s44, s40, 1
    s_cmp_lg_u32 s44, s94
    s_cbranch_scc1 n8_57
    s_lshl_b32 s44, s92, 13
    s_add_u32 s44, s44, s48
    s_add_u32 s45, s44, 4096
    buffer_load_dwordx2 v[152:153], v5, s[4:7], s44 offen offset:0 sc1
    buffer_load_dwordx2 v[154:155], v5, s[4:7], s44 offen offset:512 sc1
    buffer_load_dwordx2 v[156:157], v5, s[4:7], s45 offen offset:0 sc1
    buffer_load_dwordx2 v[158:159], v5, s[4:7], s45 offen offset:512 sc1
    s_add_u32 s46, s88, s92
    s_lshl_b32 s46, s46, 16
    s_lshl_b32 s45, s40, 11
    s_add_u32 s46, s46, s45
    s_add_u32 s46, s46, 19922944
    s_add_u32 s44, s94, 0
    s_and_b32 s44, s44, 7
    s_lshl_b32 s44, s44, 13
    s_add_u32 s44, s44, s46
    buffer_load_dwordx4 a[96:99], v1, s[4:7], s44 offen offset:0 sc1
    buffer_load_dwordx4 a[100:103], v1, s[4:7], s44 offen offset:1024 sc1
    s_add_u32 s44, s94, 1
    s_and_b32 s44, s44, 7
    s_lshl_b32 s44, s44, 13
    s_add_u32 s44, s44, s46
    buffer_load_dwordx4 a[104:107], v1, s[4:7], s44 offen offset:0 sc1
    buffer_load_dwordx4 a[108:111], v1, s[4:7], s44 offen offset:1024 sc1
    s_add_u32 s44, s94, 2
    s_and_b32 s44, s44, 7
    s_lshl_b32 s44, s44, 13
    s_add_u32 s44, s44, s46
    buffer_load_dwordx4 a[112:115], v1, s[4:7], s44 offen offset:0 sc1
    buffer_load_dwordx4 a[116:119], v1, s[4:7], s44 offen offset:1024 sc1
    s_add_u32 s44, s94, 3
    s_and_b32 s44, s44, 7
    s_lshl_b32 s44, s44, 13
    s_add_u32 s44, s44, s46
    buffer_load_dwordx4 a[120:123], v1, s[4:7], s44 offen offset:0 sc1
    buffer_load_dwordx4 a[124:127], v1, s[4:7], s44 offen offset:1024 sc1
    s_add_u32 s44, s94, 4
    s_and_b32 s44, s44, 7
    s_lshl_b32 s44, s44, 13
    s_add_u32 s44, s44, s46
    buffer_load_dwordx4 a[128:131], v1, s[4:7], s44 offen offset:0 sc1
    buffer_load_dwordx4 a[132:135], v1, s[4:7], s44 offen offset:1024 sc1
    s_add_u32 s44, s94, 5
    s_and_b32 s44, s44, 7
    s_lshl_b32 s44, s44, 13
    s_add_u32 s44, s44, s46
    buffer_load_dwordx4 a[136:139], v1, s[4:7], s44 offen offset:0 sc1
    buffer_load_dwordx4 a[140:143], v1, s[4:7], s44 offen offset:1024 sc1
    s_add_u32 s44, s94, 6
    s_and_b32 s44, s44, 7
    s_lshl_b32 s44, s44, 13
    s_add_u32 s44, s44, s46
    buffer_load_dwordx4 a[144:147], v1, s[4:7], s44 offen offset:0 sc1
    buffer_load_dwordx4 a[148:151], v1, s[4:7], s44 offen offset:1024 sc1
    s_add_u32 s44, s94, 7
    s_and_b32 s44, s44, 7
    s_lshl_b32 s44, s44, 13
    s_add_u32 s44, s44, s46
    buffer_load_dwordx4 a[152:155], v1, s[4:7], s44 offen offset:0 sc1
    buffer_load_dwordx4 a[156:159], v1, s[4:7], s44 offen offset:1024 sc1
n8_57:
    v_mfma_f32_16x16x32_bf16 v[100:103], a[56:59], v[164:167], v[100:103]
    ds_read_b128 v[176:179], v212 offset:4096
    v_mfma_f32_16x16x32_bf16 v[104:107], a[56:59], v[168:171], v[104:107]
    ds_read_b128 v[180:183], v212 offset:5120
    v_mfma_f32_16x16x32_bf16 v[108:111], a[56:59], v[172:175], v[108:111]
    ds_read_b128 v[184:187], v212 offset:6144
    ds_read_b128 v[188:191], v212 offset:7168
    s_waitcnt lgkmcnt(0)
    v_mfma_f32_16x16x32_bf16 v[96:99], a[60:63], v[176:179], v[96:99]
    ds_read_b128 v[160:163], v211 offset:32768
    v_mfma_f32_16x16x32_bf16 v[100:103], a[60:63], v[180:183], v[100:103]
    ds_read_b128 v[164:167], v211 offset:33792
    v_mfma_f32_16x16x32_bf16 v[104:107], a[60:63], v[184:187], v[104:107]
    ds_read_b128 v[168:171], v211 offset:34816
    v_mfma_f32_16x16x32_bf16 v[108:111], a[60:63], v[188:191], v[108:111]
    ds_read_b128 v[172:175], v211 offset:35840
    s_waitcnt lgkmcnt(0)
    v_mfma_f32_16x16x32_bf16 v[96:99], a[64:67], v[160:163], v[96:99]
    ds_read_b128 v[176:179], v211 offset:36864
    v_mfma_f32_16x16x32_bf16 v[100:103], a[64:67], v[164:167], v[100:103]
    ds_read_b128 v[180:183], v211 offset:37888
    v_mfma_f32_16x16x32_bf16 v[104:107], a[64:67], v[168:171], v[104:107]
    ds_read_b128 v[184:187], v211 offset:38912
    v_mfma_f32_16x16x32_bf16 v[108:111], a[64:67], v[172:175], v[108:111]
    ds_read_b128 v[188:191], v211 offset:39936
    s_waitcnt lgkmcnt(0)
    v_mfma_f32_16x16x32_bf16 v[96:99], a[68:71], v[176:179], v[96:99]
    ds_read_b128 v[160:163], v211 offset:40960
    v_mfma_f32_16x16x32_bf16 v[100:103], a[68:71], v[180:183], v[100:103]
    ds_read_b128 v[164:167], v211 offset:41984
    v_mfma_f32_16x16x32_bf16 v[104:107], a[68:71], v[184:187], v[104:107]
    ds_read_b128 v[168:171], v211 offset:43008
    v_mfma_f32_16x16x32_bf16 v[108:111], a[68:71], v[188:191], v[108:111]
    ds_read_b128 v[172:175], v211 offset:44032
    s_waitcnt lgkmcnt(0)
    v_mfma_f32_16x16x32_bf16 v[96:99], a[72:75], v[160:163], v[96:99]
    ds_read_b128 v[176:179], v211 offset:45056
    v_mfma_f32_16x16x32_bf16 v[100:103], a[72:75], v[164:167], v[100:103]
    ds_read_b128 v[180:183], v211 offset:46080
    v_mfma_f32_16x16x32_bf16 v[104:107], a[72:75], v[168:171], v[104:107]
    ds_read_b128 v[184:187], v211 offset:47104
    v_mfma_f32_16x16x32_bf16 v[108:111], a[72:75], v[172:175], v[108:111]
    ds_read_b128 v[188:191], v211 offset:48128
    s_waitcnt lgkmcnt(0)
    v_mfma_f32_16x16x32_bf16 v[96:99], a[76:79], v[176:179], v[96:99]
    ds_read_b128 v[160:163], v211 offset:49152
    v_mfma_f32_16x16x32_bf16 v[100:103], a[76:79], v[180:183], v[100:103]
    ds_read_b128 v[164:167], v211 offset:50176
    v_mfma_f32_16x16x32_bf16 v[104:107], a[76:79], v[184:187], v[104:107]
    ds_read_b128 v[168:171], v211 offset:51200
    v_mfma_f32_16x16x32_bf16 v[108:111], a[76:79], v[188:191], v[108:111]
    ds_read_b128 v[172:175], v211 offset:52224
    s_waitcnt lgkmcnt(0)
    v_mfma_f32_16x16x32_bf16 v[96:99], a[80:83], v[160:163], v[96:99]
    ds_read_b128 v[176:179], v211 offset:53248
    v_mfma_f32_16x16x32_bf16 v[100:103], a[80:83], v[164:167], v[100:103]
    ds_read_b128 v[180:183], v211 offset:54272
    v_mfma_f32_16x16x32_bf16 v[104:107], a[80:83], v[168:171], v[104:107]
    ds_read_b128 v[184:187], v211 offset:55296
    v_mfma_f32_16x16x32_bf16 v[108:111], a[80:83], v[172:175], v[108:111]
    ds_read_b128 v[188:191], v211 offset:56320
    s_waitcnt lgkmcnt(0)
    v_mfma_f32_16x16x32_bf16 v[96:99], a[84:87], v[176:179], v[96:99]
    ds_read_b128 v[160:163], v211 offset:57344
    v_mfma_f32_16x16x32_bf16 v[100:103], a[84:87], v[180:183], v[100:103]
    ds_read_b128 v[164:167], v211 offset:58368
    v_mfma_f32_16x16x32_bf16 v[104:107], a[84:87], v[184:187], v[104:107]
    ds_read_b128 v[168:171], v211 offset:59392
    v_mfma_f32_16x16x32_bf16 v[108:111], a[84:87], v[188:191], v[108:111]
    ds_read_b128 v[172:175], v211 offset:60416
    s_waitcnt lgkmcnt(0)
    v_mfma_f32_16x16x32_bf16 v[96:99], a[88:91], v[160:163], v[96:99]
    ds_read_b128 v[176:179], v211 offset:61440
    v_mfma_f32_16x16x32_bf16 v[100:103], a[88:91], v[164:167], v[100:103]
    ds_read_b128 v[180:183], v211 offset:62464
    v_mfma_f32_16x16x32_bf16 v[104:107], a[88:91], v[168:171], v[104:107]
    ds_read_b128 v[184:187], v211 offset:63488
    v_mfma_f32_16x16x32_bf16 v[108:111], a[88:91], v[172:175], v[108:111]
    ds_read_b128 v[188:191], v211 offset:64512
    s_waitcnt lgkmcnt(0)
    v_mfma_f32_16x16x32_bf16 v[96:99], a[92:95], v[176:179], v[96:99]
    v_mfma_f32_16x16x32_bf16 v[100:103], a[92:95], v[180:183], v[100:103]
    v_mfma_f32_16x16x32_bf16 v[104:107], a[92:95], v[184:187], v[104:107]
    v_mfma_f32_16x16x32_bf16 v[108:111], a[92:95], v[188:191], v[108:111]
    s_nop 4
    ds_write_b128 v217, v[96:99] offset:0
    ds_write_b128 v217, v[100:103] offset:4096
    ds_write_b128 v217, v[104:107] offset:8192
    ds_write_b128 v217, v[108:111] offset:12288
    v_mfma_f32_16x16x16_bf16 v[32:35], v[208:209], v[144:145], 0
    v_mfma_f32_16x16x16_bf16 v[36:39], v[208:209], v[146:147], 0
    v_mfma_f32_16x16x16_bf16 v[40:43], v[208:209], v[148:149], 0
    v_mfma_f32_16x16x16_bf16 v[44:47], v[208:209], v[150:151], 0
    s_mul_i32 s44, s40, 3072
    v_add_u32 v217, s44, v217
    s_waitcnt lgkmcnt(0)
    s_barrier
    ds_read_b128 v[160:163], v217 offset:0
    ds_read_b128 v[164:167], v217 offset:1024
    ds_read_b128 v[168:171], v217 offset:2048
    ds_read_b128 v[172:175], v217 offset:3072
    s_waitcnt vmcnt(3)
    v_mfma_f32_16x16x16_bf16 v[16:19], v[208:209], v[48:49], 0
    v_mfma_f32_16x16x16_bf16 v[20:23], v[208:209], v[50:51], 0
    s_waitcnt vmcnt(2)
    v_mfma_f32_16x16x16_bf16 v[24:27], v[208:209], v[52:53], 0
    v_mfma_f32_16x16x16_bf16 v[28:31], v[208:209], v[54:55], 0
    s_waitcnt vmcnt(1)
    v_mfma_f32_16x16x16_bf16 v[16:19], v[208:209], v[56:57], v[16:19]
    v_mfma_f32_16x16x16_bf16 v[20:23], v[208:209], v[58:59], v[20:23]
    s_waitcnt vmcnt(0)
    v_mfma_f32_16x16x16_bf16 v[24:27], v[208:209], v[60:61], v[24:27]
    v_mfma_f32_16x16x16_bf16 v[28:31], v[208:209], v[62:63], v[28:31]
    s_waitcnt lgkmcnt(0)
    v_fma_f32 v32, v160, v218, v32
    v_fma_f32 v33, v161, v218, v33
    v_fma_f32 v34, v162, v218, v34
    v_fma_f32 v35, v163, v218, v35
    v_fma_f32 v36, v164, v218, v36
    v_fma_f32 v37, v165, v218, v37
    v_fma_f32 v38, v166, v218, v38
    v_fma_f32 v39, v167, v218, v39
    v_fma_f32 v40, v168, v218, v40
    v_fma_f32 v41, v169, v218, v41
    v_fma_f32 v42, v170, v218, v42
    v_fma_f32 v43, v171, v218, v43
    v_fma_f32 v44, v172, v218, v44
    v_fma_f32 v45, v173, v218, v45
    v_fma_f32 v46, v174, v218, v46
    v_fma_f32 v47, v175, v218, v47
    s_add_u32 s46, s88, s94
    s_lshl_b32 s46, s46, 16
    s_lshl_b32 s45, s40, 11
    s_add_u32 s46, s46, s45
    s_add_u32 s46, s46, 19922944
    s_lshr_b32 s47, s94, 1
    s_add_u32 s47, s47, 1
    s_and_b32 s47, s47, 3
    s_cmp_lg_u32 s40, s47
    s_cbranch_scc1 p1_58
    s_mov_b32 s52, 0
poll_59:
    buffer_load_dword v60, v233, s[4:7], s91 offen sc1
    s_waitcnt vmcnt(0)
    v_cmp_ne_u32 vcc, 1, v60
    s_cbranch_vccz pdone_60
    s_add_u32 s52, s52, 1
    s_cmp_lt_u32 s52, 20000
    s_cbranch_scc1 poll_59
pdone_60:
p1_58:
    s_barrier
    s_add_u32 s44, s94, 5
    s_and_b32 s44, s44, 7
    s_lshl_b32 s44, s44, 13
    s_add_u32 s44, s44, s46
    buffer_load_dwordx4 v[64:67], v1, s[4:7], s44 offen offset:0 sc1
    buffer_load_dwordx4 v[68:71], v1, s[4:7], s44 offen offset:1024 sc1
    s_add_u32 s44, s94, 4
    s_and_b32 s44, s44, 7
    s_lshl_b32 s44, s44, 13
    s_add_u32 s44, s44, s46
    buffer_load_dwordx4 v[72:75], v1, s[4:7], s44 offen offset:0 sc1
    buffer_load_dwordx4 v[76:79], v1, s[4:7], s44 offen offset:1024 sc1
    s_add_u32 s44, s94, 3
    s_and_b32 s44, s44, 7
    s_lshl_b32 s44, s44, 13
    s_add_u32 s44, s44, s46
    buffer_load_dwordx4 v[80:83], v1, s[4:7], s44 offen offset:0 sc1
    buffer_load_dwordx4 v[84:87], v1, s[4:7], s44 offen offset:1024 sc1
    s_add_u32 s44, s94, 2
    s_and_b32 s44, s44, 7
    s_lshl_b32 s44, s44, 13
    s_add_u32 s44, s44, s46
    buffer_load_dwordx4 v[88:91], v1, s[4:7], s44 offen offset:0 sc1
    buffer_load_dwordx4 v[92:95], v1, s[4:7], s44 offen offset:1024 sc1
    s_add_u32 s44, s94, 1
    s_and_b32 s44, s44, 7
    s_lshl_b32 s44, s44, 13
    s_add_u32 s44, s44, s46
    buffer_load_dwordx4 v[96:99], v1, s[4:7], s44 offen offset:0 sc1
    buffer_load_dwordx4 v[100:103], v1, s[4:7], s44 offen offset:1024 sc1
    s_lshl_b32 s44, s40, 1
    s_cmp_lg_u32 s44, s94
    s_cbranch_scc1 n8_61
    s_waitcnt vmcnt(10)
    v_mfma_f32_16x16x16_bf16 v[176:179], v[208:209], v[152:153], 0
    v_mfma_f32_16x16x16_bf16 v[180:183], v[208:209], v[154:155], 0
    v_mfma_f32_16x16x16_bf16 v[184:187], v[208:209], v[156:157], 0
    v_mfma_f32_16x16x16_bf16 v[188:191], v[208:209], v[158:159], 0
    s_waitcnt vmcnt(10)
    v_mfma_f32_16x16x16_bf16 v[112:115], v[208:209], a[96:97], 0
    v_mfma_f32_16x16x16_bf16 v[116:119], v[208:209], a[98:99], 0
    s_waitcnt vmcnt(10)
    v_mfma_f32_16x16x16_bf16 v[120:123], v[208:209], a[100:101], 0
    v_mfma_f32_16x16x16_bf16 v[124:127], v[208:209], a[102:103], 0
    s_waitcnt vmcnt(10)
    v_mfma_f32_16x16x16_bf16 v[112:115], v[208:209], a[104:105], v[112:115]
    v_mfma_f32_16x16x16_bf16 v[116:119], v[208:209], a[106:107], v[116:119]
    s_waitcnt vmcnt(10)
    v_mfma_f32_16x16x16_bf16 v[120:123], v[208:209], a[108:109], v[120:123]
    v_mfma_f32_16x16x16_bf16 v[124:127], v[208:209], a[110:111], v[124:127]
    s_waitcnt vmcnt(10)
    v_mfma_f32_16x16x16_bf16 v[112:115], v[208:209], a[112:113], v[112:115]
    v_mfma_f32_16x16x16_bf16 v[116:119], v[208:209], a[114:115], v[116:119]
    s_waitcnt vmcnt(10)
    v_mfma_f32_16x16x16_bf16 v[120:123], v[208:209], a[116:117], v[120:123]
    v_mfma_f32_16x16x16_bf16 v[124:127], v[208:209], a[118:119], v[124:127]
    s_waitcnt vmcnt(10)
    v_mfma_f32_16x16x16_bf16 v[112:115], v[208:209], a[120:121], v[112:115]
    v_mfma_f32_16x16x16_bf16 v[116:119], v[208:209], a[122:123], v[116:119]
    s_waitcnt vmcnt(10)
    v_mfma_f32_16x16x16_bf16 v[120:123], v[208:209], a[124:125], v[120:123]
    v_mfma_f32_16x16x16_bf16 v[124:127], v[208:209], a[126:127], v[124:127]
    s_waitcnt vmcnt(10)
    v_mfma_f32_16x16x16_bf16 v[112:115], v[208:209], a[128:129], v[112:115]
    v_mfma_f32_16x16x16_bf16 v[116:119], v[208:209], a[130:131], v[116:119]
    s_waitcnt vmcnt(10)
    v_mfma_f32_16x16x16_bf16 v[120:123], v[208:209], a[132:133], v[120:123]
    v_mfma_f32_16x16x16_bf16 v[124:127], v[208:209], a[134:135], v[124:127]
    s_waitcnt vmcnt(10)
    v_mfma_f32_16x16x16_bf16 v[112:115], v[208:209], a[136:137], v[112:115]
    v_mfma_f32_16x16x16_bf16 v[116:119], v[208:209], a[138:139], v[116:119]
    s_waitcnt vmcnt(10)
    v_mfma_f32_16x16x16_bf16 v[120:123], v[208:209], a[140:141], v[120:123]
    v_mfma_f32_16x16x16_bf16 v[124:127], v[208:209], a[142:143], v[124:127]
    s_waitcnt vmcnt(10)
    v_mfma_f32_16x16x16_bf16 v[112:115], v[208:209], a[144:145], v[112:115]
    v_mfma_f32_16x16x16_bf16 v[116:119], v[208:209], a[146:147], v[116:119]
    s_waitcnt vmcnt(10)
    v_mfma_f32_16x16x16_bf16 v[120:123], v[208:209], a[148:149], v[120:123]
    v_mfma_f32_16x16x16_bf16 v[124:127], v[208:209], a[150:151], v[124:127]
    s_waitcnt vmcnt(10)
    v_mfma_f32_16x16x16_bf16 v[112:115], v[208:209], a[152:153], v[112:115]
    v_mfma_f32_16x16x16_bf16 v[116:119], v[208:209], a[154:155], v[116:119]
    s_waitcnt vmcnt(10)
    v_mfma_f32_16x16x16_bf16 v[120:123], v[208:209], a[156:157], v[120:123]
    v_mfma_f32_16x16x16_bf16 v[124:127], v[208:209], a[158:159], v[124:127]
    s_nop 4
    v_permlane16_swap_b32 v112, v116
    v_permlane16_swap_b32 v113, v117
    v_permlane16_swap_b32 v114, v118
    v_permlane16_swap_b32 v115, v119
    v_permlane16_swap_b32 v120, v124
    v_permlane16_swap_b32 v121, v125
    v_permlane16_swap_b32 v122, v126
    v_permlane16_swap_b32 v123, v127
    v_fma_f32 v112, v112, v218, v176
    v_fma_f32 v113, v113, v218, v177
    v_fma_f32 v114, v114, v218, v178
    v_fma_f32 v115, v115, v218, v179
    v_fma_f32 v116, v116, v218, v180
    v_fma_f32 v117, v117, v218, v181
    v_fma_f32 v118, v118, v218, v182
    v_fma_f32 v119, v119, v218, v183
    v_fma_f32 v120, v120, v218, v184
    v_fma_f32 v121, v121, v218, v185
    v_fma_f32 v122, v122, v218, v186
    v_fma_f32 v123, v123, v218, v187
    v_fma_f32 v124, v124, v218, v188
    v_fma_f32 v125, v125, v218, v189
    v_fma_f32 v126, v126, v218, v190
    v_fma_f32 v127, v127, v218, v191
    v_cvt_pk_bf16_f32 v128, v112, v116
    v_cvt_pk_bf16_f32 v129, v120, v124
    v_cvt_pk_bf16_f32 v130, v113, v117
    v_cvt_pk_bf16_f32 v131, v121, v125
    v_cvt_pk_bf16_f32 v132, v114, v118
    v_cvt_pk_bf16_f32 v133, v122, v126
    v_cvt_pk_bf16_f32 v134, v115, v119
    v_cvt_pk_bf16_f32 v135, v123, v127
n8_61:
    s_waitcnt vmcnt(9)
    v_mfma_f32_16x16x16_bf16 v[16:19], v[208:209], v[64:65], v[16:19]
    v_mfma_f32_16x16x16_bf16 v[20:23], v[208:209], v[66:67], v[20:23]
    s_waitcnt vmcnt(8)
    v_mfma_f32_16x16x16_bf16 v[24:27], v[208:209], v[68:69], v[24:27]
    v_mfma_f32_16x16x16_bf16 v[28:31], v[208:209], v[70:71], v[28:31]
    s_waitcnt vmcnt(7)
    v_mfma_f32_16x16x16_bf16 v[16:19], v[208:209], v[72:73], v[16:19]
    v_mfma_f32_16x16x16_bf16 v[20:23], v[208:209], v[74:75], v[20:23]
    s_waitcnt vmcnt(6)
    v_mfma_f32_16x16x16_bf16 v[24:27], v[208:209], v[76:77], v[24:27]
    v_mfma_f32_16x16x16_bf16 v[28:31], v[208:209], v[78:79], v[28:31]
    s_waitcnt vmcnt(5)
    v_mfma_f32_16x16x16_bf16 v[16:19], v[208:209], v[80:81], v[16:19]
    v_mfma_f32_16x16x16_bf16 v[20:23], v[208:209], v[82:83], v[20:23]
    s_waitcnt vmcnt(4)
    v_mfma_f32_16x16x16_bf16 v[24:27], v[208:209], v[84:85], v[24:27]
    v_mfma_f32_16x16x16_bf16 v[28:31], v[208:209], v[86:87], v[28:31]
    s_waitcnt vmcnt(3)
    v_mfma_f32_16x16x16_bf16 v[16:19], v[208:209], v[88:89], v[16:19]
    v_mfma_f32_16x16x16_bf16 v[20:23], v[208:209], v[90:91], v[20:23]
    s_waitcnt vmcnt(2)
    v_mfma_f32_16x16x16_bf16 v[24:27], v[208:209], v[92:93], v[24:27]
    v_mfma_f32_16x16x16_bf16 v[28:31], v[208:209], v[94:95], v[28:31]
    s_waitcnt vmcnt(1)
    v_mfma_f32_16x16x16_bf16 v[16:19], v[208:209], v[96:97], v[16:19]
    v_mfma_f32_16x16x16_bf16 v[20:23], v[208:209], v[98:99], v[20:23]
    s_waitcnt vmcnt(0)
    v_mfma_f32_16x16x16_bf16 v[24:27], v[208:209], v[100:101], v[24:27]
    v_mfma_f32_16x16x16_bf16 v[28:31], v[208:209], v[102:103], v[28:31]
    s_nop 4
    v_permlane16_swap_b32 v16, v20
    v_permlane16_swap_b32 v17, v21
    v_permlane16_swap_b32 v18, v22
    v_permlane16_swap_b32 v19, v23
    v_permlane16_swap_b32 v24, v28
    v_permlane16_swap_b32 v25, v29
    v_permlane16_swap_b32 v26, v30
    v_permlane16_swap_b32 v27, v31
    v_fma_f32 v16, v16, v218, v32
    v_fma_f32 v17, v17, v218, v33
    v_fma_f32 v18, v18, v218, v34
    v_fma_f32 v19, v19, v218, v35
    v_fma_f32 v20, v20, v218, v36
    v_fma_f32 v21, v21, v218, v37
    v_fma_f32 v22, v22, v218, v38
    v_fma_f32 v23, v23, v218, v39
    v_fma_f32 v24, v24, v218, v40
    v_fma_f32 v25, v25, v218, v41
    v_fma_f32 v26, v26, v218, v42
    v_fma_f32 v27, v27, v218, v43
    v_fma_f32 v28, v28, v218, v44
    v_fma_f32 v29, v29, v218, v45
    v_fma_f32 v30, v30, v218, v46
    v_fma_f32 v31, v31, v218, v47
    v_cvt_pk_bf16_f32 v140, v16, v20
    v_cvt_pk_bf16_f32 v141, v24, v28
    v_cvt_pk_bf16_f32 v142, v17, v21
    v_cvt_pk_bf16_f32 v143, v25, v29
    s_lshl_b32 s44, s94, 7
    buffer_store_dwordx4 v[140:143], v7, s[32:35], s44 offen offset:0
    v_cvt_pk_bf16_f32 v144, v18, v22
    v_cvt_pk_bf16_f32 v145, v26, v30
    v_cvt_pk_bf16_f32 v146, v19, v23
    v_cvt_pk_bf16_f32 v147, v27, v31
    buffer_store_dwordx4 v[144:147], v7, s[32:35], s44 offen offset:16
    s_lshl_b32 s44, s40, 1
    s_cmp_lg_u32 s44, s94
    s_cbranch_scc1 n8_62
    s_lshl_b32 s44, s92, 7
    buffer_store_dwordx4 v[128:131], v7, s[32:35], s44 offen offset:0
    buffer_store_dwordx4 v[132:135], v7, s[32:35], s44 offen offset:16
n8_62:
    s_waitcnt vmcnt(0)
L_end:
    s_endpgm
.section .rodata,"a"
.p2align 6
.amdhsa_kernel sequential_preLN__linear_attn_block__dense_activation_relu__prompt_kernel
  .amdhsa_next_free_vgpr 512
  .amdhsa_next_free_sgpr 102
  .amdhsa_accum_offset 256
  .amdhsa_group_segment_fixed_size 0
  .amdhsa_kernarg_size 72
  .amdhsa_user_sgpr_count 2
  .amdhsa_user_sgpr_kernarg_segment_ptr 1
  .amdhsa_system_sgpr_workgroup_id_x 1
.end_amdhsa_kernel
```
